```python
import torch

def _softmax(x, axis=-1):
    return torch.softmax(x, dim=axis)
def _gelu(x):
    return torch.nn.functional.gelu(x, approximate="tanh")
def _silu(x):
    return torch.nn.functional.silu(x)
def _sigmoid(x):
    return torch.sigmoid(x)
def _layernorm(x, axis=-1, eps=1e-5):
    m = x.mean(dim=axis, keepdim=True)
    v = x.var(dim=axis, keepdim=True, unbiased=False)
    return (x - m) / torch.sqrt(v + eps)
def _scatter_add(tgt, idx, src, axis=0):
    return tgt.clone().index_add_(axis, idx, src)
def _segment_sum(src, seg, n):
    out = torch.zeros((n,) + src.shape[1:], dtype=src.dtype)
    return out.index_add_(0, seg, src)
def _pad(x, pw):
    flat = tuple(v for pair in reversed(pw) for v in pair)
    return torch.nn.functional.pad(x, flat)

kernel_name = 'interleave_layers__sliding_block__moe_arch_mod__prompt'

def setup_inputs():

    _w = (lambda a: (lambda t: t.to(torch.bfloat16) if t.is_floating_point() else t)(torch.as_tensor(a)))
    def _A_setup():
        B, S, D = 1, 2048, 512
        return {
            "x": _w((lambda *s: torch.randn(*s, dtype=torch.bfloat16) * 0.05)(B, S, D)),
            "wqkv": _w((lambda *s: torch.randn(*s, dtype=torch.bfloat16) * 0.05)(D, 3 * D)),
            "wo": _w((lambda *s: torch.randn(*s, dtype=torch.bfloat16) * 0.05)(D, D)),
        }
    _A_in = _A_setup()

    def _B_setup():
        B, S, D, F, C = 1, 2048, 512, 1792, 1
        return {
            "x": _w((lambda *s: torch.randn(*s, dtype=torch.bfloat16) * 0.05)(B, S, D)),
            "w_r": _w((lambda *s: torch.randn(*s, dtype=torch.bfloat16) * 0.05)(D)),
            "w_gate": _w((lambda *s: torch.randn(*s, dtype=torch.bfloat16) * 0.05)(D, F)),
            "w_up": _w((lambda *s: torch.randn(*s, dtype=torch.bfloat16) * 0.05)(D, F)),
            "w_down": _w((lambda *s: torch.randn(*s, dtype=torch.bfloat16) * 0.05)(F, D)),
        }
    _B_in = _B_setup()

    return {
        "A_x": _A_in["x"],
        "A_wqkv": _A_in["wqkv"],
        "A_wo": _A_in["wo"],
        "B_x": _B_in["x"],
        "B_w_r": _B_in["w_r"],
        "B_w_gate": _B_in["w_gate"],
        "B_w_up": _B_in["w_up"],
        "B_w_down": _B_in["w_down"],
    }

def reference(A_x, A_wqkv, A_wo, B_x, B_w_r, B_w_gate, B_w_up, B_w_down):
    def _A_ref(x, wqkv, wo):
        B, S, D = x.shape
        H = 32; Dh = D // H; W = 256
        qkv = (lambda x, *d: x.permute(*d))((x @ wqkv).reshape(B, S, 3, H, Dh), 2, 0, 3, 1, 4)
        q, k, v = qkv[0], qkv[1], qkv[2]
        scores = torch.einsum("bhqd,bhkd->bhqk", q, k) * (Dh ** -0.5)
        idx = torch.arange(S)
        mask = (idx[:, None] - idx[None, :] >= 0) & (idx[:, None] - idx[None, :] < W)
        scores = torch.where(mask[None, None], scores, -1e9)
        p = _softmax(scores, axis=-1)
        o = torch.einsum("bhqk,bhkd->bhqd", p, v)
        return (lambda x, *d: x.permute(*d))(o, 0, 2, 1, 3).reshape(B, S, D) @ wo

    def _B_ref(x, w_r, w_gate, w_up, w_down):
        B, S, D = x.shape
        C = 1
        r = x @ w_r
        idx = torch.argsort(-r, axis=-1)[:, :C]
        idx_e = (lambda x, n, axis: torch.repeat_interleave(x, n, dim=axis))(idx.reshape(B, C, 1), D, axis=2)
        x_sel = (lambda x, i, axis: torch.take_along_dim(x, i, dim=axis))(x, idx_e, axis=1)
        g = _silu(x_sel @ w_gate)
        u = x_sel @ w_up
        y = (g * u) @ w_down
        r_sel = _sigmoid((lambda x, i, axis: torch.take_along_dim(x, i, dim=axis))(r, idx, axis=1))
        y = y * r_sel.reshape(B, C, 1)
        b_off = (torch.arange(B) * S).reshape(B, 1)
        flat_idx = (idx + b_off).reshape(B * C)
        zero = (x * 0.0).reshape(B * S, D)
        upd = _scatter_add(zero, flat_idx, y.reshape(B * C, D), axis=0)
        return x + upd.reshape(B, S, D)

    x = A_x
    x = x + _A_ref(_layernorm(x, axis=-1), A_wqkv, A_wo)
    x = x + _B_ref(_layernorm(x, axis=-1), B_w_r, B_w_gate, B_w_up, B_w_down)
    x = x + _A_ref(_layernorm(x, axis=-1), A_wqkv, A_wo)
    x = x + _B_ref(_layernorm(x, axis=-1), B_w_r, B_w_gate, B_w_up, B_w_down)
    return x
```

```asm
; @launch kernel=qkv1_kernel grid=(256,1,1) block=(768,1,1) lds=144896
; @launch kernel=attn1_kernel grid=(256,1,1) block=(512,1,1) lds=36864
; @launch kernel=wo1_kernel grid=(256,1,1) block=(256,1,1) lds=131072
; @launch kernel=qkv2_kernel grid=(248,1,1) block=(512,1,1) lds=133632
; @launch kernel=attn2_kernel grid=(304,1,1) block=(512,1,1) lds=36864
; @launch kernel=wo2_kernel grid=(256,1,1) block=(256,1,1) lds=131072
; @launch kernel=tail_kernel grid=(184,1,1) block=(512,1,1) lds=104768
; @launch kernel=fin_kernel grid=(8,1,1) block=(64,1,1) lds=0
.amdgcn_target "amdgcn-amd-amdhsa--gfx950"
.text
.globl qkv1_kernel
.p2align 8
.type qkv1_kernel,@function
qkv1_kernel:
  s_cmp_ge_u32 s2, 256
  s_cbranch_scc1 qkv1_kernel_end
  s_load_dwordx4 s[4:7], s[0:1], 0
  s_load_dwordx2 s[20:21], s[0:1], 80
  v_lshrrev_b32 v2, 6, v0
  v_and_b32 v1, 63, v0
  v_readfirstlane_b32 s22, v2
  s_and_b32 s27, s2, 7
  s_lshr_b32 s28, s2, 3
  s_lshr_b32 s23, s27, 1
  s_lshl_b32 s23, s23, 2
  s_and_b32 s29, s28, 3
  s_add_u32 s23, s23, s29
  s_and_b32 s24, s27, 1
  s_lshl_b32 s24, s24, 3
  s_lshr_b32 s29, s28, 2
  s_add_u32 s24, s24, s29
  s_cmp_ge_u32 s22, 8
  s_cbranch_scc1 qkv1_kernel_loader
  s_and_b32 s25, s22, 3
  v_and_b32 v5, 31, v1
  v_lshrrev_b32 v6, 5, v1
  v_bfe_u32 v7, v5, 1, 3
  s_lshl_b32 s26, s25, 12
  v_lshlrev_b32 v8, 7, v5
  v_add_u32 v8, s26, v8
  s_cmp_lt_u32 s22, 4
  s_cselect_b32 s29, s22, 0
  s_add_u32 s30, s29, 0
  s_and_b32 s30, s30, 3
  s_lshl_b32 s31, s30, 1
  v_add_u32 v9, s31, v6
  v_xor_b32 v9, v9, v7
  v_lshl_add_u32 v112, v9, 4, v8
  s_add_u32 s30, s29, 1
  s_and_b32 s30, s30, 3
  s_lshl_b32 s31, s30, 1
  v_add_u32 v9, s31, v6
  v_xor_b32 v9, v9, v7
  v_lshl_add_u32 v113, v9, 4, v8
  s_add_u32 s30, s29, 2
  s_and_b32 s30, s30, 3
  s_lshl_b32 s31, s30, 1
  v_add_u32 v9, s31, v6
  v_xor_b32 v9, v9, v7
  v_lshl_add_u32 v114, v9, 4, v8
  s_add_u32 s30, s29, 3
  s_and_b32 s30, s30, 3
  s_lshl_b32 s31, s30, 1
  v_add_u32 v9, s31, v6
  v_xor_b32 v9, v9, v7
  v_lshl_add_u32 v115, v9, 4, v8
  v_bfe_u32 v7, v1, 2, 2
  v_lshl_add_u32 v7, v6, 3, v7
  v_mul_u32_u24 v7, 192, v7
  v_bfe_u32 v8, v1, 4, 1
  v_lshl_add_u32 v7, v8, 5, v7
  v_and_b32 v8, 1, v1
  v_lshl_add_u32 v7, v8, 4, v7
  v_bfe_u32 v8, v1, 1, 1
  v_lshl_add_u32 v7, v8, 3, v7
  s_add_u32 s30, s29, 0
  s_and_b32 s30, s30, 3
  s_mul_i32 s30, s30, 3072
  v_add_u32 v116, s30, v7
  s_add_u32 s30, s29, 1
  s_and_b32 s30, s30, 3
  s_mul_i32 s30, s30, 3072
  v_add_u32 v117, s30, v7
  s_add_u32 s30, s29, 2
  s_and_b32 s30, s30, 3
  s_mul_i32 s30, s30, 3072
  v_add_u32 v118, s30, v7
  s_add_u32 s30, s29, 3
  s_and_b32 s30, s30, 3
  s_mul_i32 s30, s30, 3072
  v_add_u32 v119, s30, v7
  s_cmp_ge_u32 s22, 4
  s_cbranch_scc1 qkv1_kernel_stats
  v_and_b32 v9, 31, v1
  v_mov_b32 v10, 0x3f803f80
  v_cmp_eq_u32 s[30:31], 0, v9
  s_nop 1
  v_cndmask_b32 v136, 0, v10, s[30:31]
  v_mov_b32 v137, v136
  v_mov_b32 v138, v136
  v_mov_b32 v139, v136
  v_cmp_eq_u32 s[30:31], 1, v9
  s_nop 1
  v_cndmask_b32 v140, 0, v10, s[30:31]
  v_mov_b32 v141, v140
  v_mov_b32 v142, v140
  v_mov_b32 v143, v140
  v_cmp_eq_u32 s[30:31], 2, v9
  s_nop 1
  v_cndmask_b32 v144, 0, v10, s[30:31]
  v_mov_b32 v145, v144
  v_mov_b32 v146, v144
  v_mov_b32 v147, v144
  v_mov_b32 v8, 0
  v_lshlrev_b32 v10, 2, v0
  v_add_u32 v10, 143360, v10
  v_cmp_gt_u32 vcc, 96, v0
  s_nop 0
  s_and_saveexec_b64 s[28:29], vcc
  ds_write_b32 v10, v8
  s_mov_b64 exec, s[28:29]
  s_waitcnt lgkmcnt(0)
  s_mov_b32 s52, s20
  s_and_b32 s53, s21, 0xffff
  s_mov_b32 s54, 0x10000000
  s_mov_b32 s55, 0x20000
  s_barrier
  ds_read_b128 v[100:103], v112 offset:0
  ds_read_b64_tr_b16 v[64:65], v116 offset:16384
  ds_read_b64_tr_b16 v[66:67], v116 offset:17152
  ds_read_b64_tr_b16 v[68:69], v116 offset:16448
  ds_read_b64_tr_b16 v[70:71], v116 offset:17216
  ds_read_b64_tr_b16 v[72:73], v116 offset:16512
  ds_read_b64_tr_b16 v[74:75], v116 offset:17280
  ds_read_b128 v[104:107], v113 offset:0
  ds_read_b64_tr_b16 v[76:77], v117 offset:16384
  ds_read_b64_tr_b16 v[78:79], v117 offset:17152
  ds_read_b64_tr_b16 v[80:81], v117 offset:16448
  ds_read_b64_tr_b16 v[82:83], v117 offset:17216
  ds_read_b64_tr_b16 v[84:85], v117 offset:16512
  ds_read_b64_tr_b16 v[86:87], v117 offset:17280
  s_waitcnt lgkmcnt(7)
  v_mfma_f32_32x32x16_bf16 v[16:31], v[64:67], v[100:103], 0
  ds_read_b128 v[108:111], v114 offset:0
  ds_read_b64_tr_b16 v[88:89], v118 offset:16384
  ds_read_b64_tr_b16 v[90:91], v118 offset:17152
  v_mfma_f32_32x32x16_bf16 v[32:47], v[68:71], v[100:103], 0
  ds_read_b64_tr_b16 v[92:93], v118 offset:16448
  ds_read_b64_tr_b16 v[94:95], v118 offset:17216
  v_mfma_f32_32x32x16_bf16 v[48:63], v[100:103], v[72:75], 0
  ds_read_b64_tr_b16 v[96:97], v118 offset:16512
  ds_read_b64_tr_b16 v[98:99], v118 offset:17280
  v_mfma_f32_32x32x16_bf16 v[120:135], v[136:139], v[64:67], 0
  v_mfma_f32_32x32x16_bf16 v[120:135], v[140:143], v[68:71], v[120:135]
  v_mfma_f32_32x32x16_bf16 v[120:135], v[144:147], v[72:75], v[120:135]
  s_waitcnt lgkmcnt(7)
  v_mfma_f32_32x32x16_bf16 v[16:31], v[76:79], v[104:107], v[16:31]
  ds_read_b128 v[100:103], v115 offset:0
  ds_read_b64_tr_b16 v[64:65], v119 offset:16384
  ds_read_b64_tr_b16 v[66:67], v119 offset:17152
  v_mfma_f32_32x32x16_bf16 v[32:47], v[80:83], v[104:107], v[32:47]
  ds_read_b64_tr_b16 v[68:69], v119 offset:16448
  ds_read_b64_tr_b16 v[70:71], v119 offset:17216
  v_mfma_f32_32x32x16_bf16 v[48:63], v[104:107], v[84:87], v[48:63]
  ds_read_b64_tr_b16 v[72:73], v119 offset:16512
  ds_read_b64_tr_b16 v[74:75], v119 offset:17280
  s_waitcnt lgkmcnt(7)
  s_barrier
  v_mfma_f32_32x32x16_bf16 v[16:31], v[88:91], v[108:111], v[16:31]
  ds_read_b128 v[104:107], v112 offset:28672
  ds_read_b64_tr_b16 v[76:77], v116 offset:45056
  ds_read_b64_tr_b16 v[78:79], v116 offset:45824
  v_mfma_f32_32x32x16_bf16 v[32:47], v[92:95], v[108:111], v[32:47]
  ds_read_b64_tr_b16 v[80:81], v116 offset:45120
  ds_read_b64_tr_b16 v[82:83], v116 offset:45888
  v_mfma_f32_32x32x16_bf16 v[48:63], v[108:111], v[96:99], v[48:63]
  ds_read_b64_tr_b16 v[84:85], v116 offset:45184
  ds_read_b64_tr_b16 v[86:87], v116 offset:45952
  s_waitcnt lgkmcnt(7)
  v_mfma_f32_32x32x16_bf16 v[16:31], v[64:67], v[100:103], v[16:31]
  ds_read_b128 v[108:111], v113 offset:28672
  ds_read_b64_tr_b16 v[88:89], v117 offset:45056
  ds_read_b64_tr_b16 v[90:91], v117 offset:45824
  v_mfma_f32_32x32x16_bf16 v[32:47], v[68:71], v[100:103], v[32:47]
  ds_read_b64_tr_b16 v[92:93], v117 offset:45120
  ds_read_b64_tr_b16 v[94:95], v117 offset:45888
  v_mfma_f32_32x32x16_bf16 v[48:63], v[100:103], v[72:75], v[48:63]
  ds_read_b64_tr_b16 v[96:97], v117 offset:45184
  ds_read_b64_tr_b16 v[98:99], v117 offset:45952
  s_waitcnt lgkmcnt(7)
  v_mfma_f32_32x32x16_bf16 v[16:31], v[76:79], v[104:107], v[16:31]
  ds_read_b128 v[100:103], v114 offset:28672
  ds_read_b64_tr_b16 v[64:65], v118 offset:45056
  ds_read_b64_tr_b16 v[66:67], v118 offset:45824
  v_mfma_f32_32x32x16_bf16 v[32:47], v[80:83], v[104:107], v[32:47]
  ds_read_b64_tr_b16 v[68:69], v118 offset:45120
  ds_read_b64_tr_b16 v[70:71], v118 offset:45888
  v_mfma_f32_32x32x16_bf16 v[48:63], v[104:107], v[84:87], v[48:63]
  ds_read_b64_tr_b16 v[72:73], v118 offset:45184
  ds_read_b64_tr_b16 v[74:75], v118 offset:45952
  v_mfma_f32_32x32x16_bf16 v[120:135], v[136:139], v[76:79], v[120:135]
  v_mfma_f32_32x32x16_bf16 v[120:135], v[140:143], v[80:83], v[120:135]
  v_mfma_f32_32x32x16_bf16 v[120:135], v[144:147], v[84:87], v[120:135]
  s_waitcnt lgkmcnt(7)
  v_mfma_f32_32x32x16_bf16 v[16:31], v[88:91], v[108:111], v[16:31]
  ds_read_b128 v[104:107], v115 offset:28672
  ds_read_b64_tr_b16 v[76:77], v119 offset:45056
  ds_read_b64_tr_b16 v[78:79], v119 offset:45824
  v_mfma_f32_32x32x16_bf16 v[32:47], v[92:95], v[108:111], v[32:47]
  ds_read_b64_tr_b16 v[80:81], v119 offset:45120
  ds_read_b64_tr_b16 v[82:83], v119 offset:45888
  v_mfma_f32_32x32x16_bf16 v[48:63], v[108:111], v[96:99], v[48:63]
  ds_read_b64_tr_b16 v[84:85], v119 offset:45184
  ds_read_b64_tr_b16 v[86:87], v119 offset:45952
  s_waitcnt lgkmcnt(7)
  s_barrier
  v_add_u32 v112, 0xe000, v112
  v_add_u32 v113, 0xe000, v113
  v_add_u32 v114, 0xe000, v114
  v_add_u32 v115, 0xe000, v115
  v_add_u32 v116, 0xe000, v116
  v_add_u32 v117, 0xe000, v117
  v_add_u32 v118, 0xe000, v118
  v_add_u32 v119, 0xe000, v119
  v_mfma_f32_32x32x16_bf16 v[16:31], v[64:67], v[100:103], v[16:31]
  ds_read_b128 v[108:111], v112 offset:0
  ds_read_b64_tr_b16 v[88:89], v116 offset:16384
  ds_read_b64_tr_b16 v[90:91], v116 offset:17152
  v_mfma_f32_32x32x16_bf16 v[32:47], v[68:71], v[100:103], v[32:47]
  ds_read_b64_tr_b16 v[92:93], v116 offset:16448
  ds_read_b64_tr_b16 v[94:95], v116 offset:17216
  v_mfma_f32_32x32x16_bf16 v[48:63], v[100:103], v[72:75], v[48:63]
  ds_read_b64_tr_b16 v[96:97], v116 offset:16512
  ds_read_b64_tr_b16 v[98:99], v116 offset:17280
  s_waitcnt lgkmcnt(7)
  v_mfma_f32_32x32x16_bf16 v[16:31], v[76:79], v[104:107], v[16:31]
  ds_read_b128 v[100:103], v113 offset:0
  ds_read_b64_tr_b16 v[64:65], v117 offset:16384
  ds_read_b64_tr_b16 v[66:67], v117 offset:17152
  v_mfma_f32_32x32x16_bf16 v[32:47], v[80:83], v[104:107], v[32:47]
  ds_read_b64_tr_b16 v[68:69], v117 offset:16448
  ds_read_b64_tr_b16 v[70:71], v117 offset:17216
  v_mfma_f32_32x32x16_bf16 v[48:63], v[104:107], v[84:87], v[48:63]
  ds_read_b64_tr_b16 v[72:73], v117 offset:16512
  ds_read_b64_tr_b16 v[74:75], v117 offset:17280
  s_waitcnt lgkmcnt(7)
  v_mfma_f32_32x32x16_bf16 v[16:31], v[88:91], v[108:111], v[16:31]
  ds_read_b128 v[104:107], v114 offset:0
  ds_read_b64_tr_b16 v[76:77], v118 offset:16384
  ds_read_b64_tr_b16 v[78:79], v118 offset:17152
  v_mfma_f32_32x32x16_bf16 v[32:47], v[92:95], v[108:111], v[32:47]
  ds_read_b64_tr_b16 v[80:81], v118 offset:16448
  ds_read_b64_tr_b16 v[82:83], v118 offset:17216
  v_mfma_f32_32x32x16_bf16 v[48:63], v[108:111], v[96:99], v[48:63]
  ds_read_b64_tr_b16 v[84:85], v118 offset:16512
  ds_read_b64_tr_b16 v[86:87], v118 offset:17280
  v_mfma_f32_32x32x16_bf16 v[120:135], v[136:139], v[88:91], v[120:135]
  v_mfma_f32_32x32x16_bf16 v[120:135], v[140:143], v[92:95], v[120:135]
  v_mfma_f32_32x32x16_bf16 v[120:135], v[144:147], v[96:99], v[120:135]
  s_waitcnt lgkmcnt(7)
  v_mfma_f32_32x32x16_bf16 v[16:31], v[64:67], v[100:103], v[16:31]
  ds_read_b128 v[108:111], v115 offset:0
  ds_read_b64_tr_b16 v[88:89], v119 offset:16384
  ds_read_b64_tr_b16 v[90:91], v119 offset:17152
  v_mfma_f32_32x32x16_bf16 v[32:47], v[68:71], v[100:103], v[32:47]
  ds_read_b64_tr_b16 v[92:93], v119 offset:16448
  ds_read_b64_tr_b16 v[94:95], v119 offset:17216
  v_mfma_f32_32x32x16_bf16 v[48:63], v[100:103], v[72:75], v[48:63]
  ds_read_b64_tr_b16 v[96:97], v119 offset:16512
  ds_read_b64_tr_b16 v[98:99], v119 offset:17280
  s_waitcnt lgkmcnt(7)
  s_barrier
  v_mfma_f32_32x32x16_bf16 v[16:31], v[76:79], v[104:107], v[16:31]
  ds_read_b128 v[100:103], v112 offset:28672
  ds_read_b64_tr_b16 v[64:65], v116 offset:45056
  ds_read_b64_tr_b16 v[66:67], v116 offset:45824
  v_mfma_f32_32x32x16_bf16 v[32:47], v[80:83], v[104:107], v[32:47]
  ds_read_b64_tr_b16 v[68:69], v116 offset:45120
  ds_read_b64_tr_b16 v[70:71], v116 offset:45888
  v_mfma_f32_32x32x16_bf16 v[48:63], v[104:107], v[84:87], v[48:63]
  ds_read_b64_tr_b16 v[72:73], v116 offset:45184
  ds_read_b64_tr_b16 v[74:75], v116 offset:45952
  s_waitcnt lgkmcnt(7)
  v_mfma_f32_32x32x16_bf16 v[16:31], v[88:91], v[108:111], v[16:31]
  ds_read_b128 v[104:107], v113 offset:28672
  ds_read_b64_tr_b16 v[76:77], v117 offset:45056
  ds_read_b64_tr_b16 v[78:79], v117 offset:45824
  v_mfma_f32_32x32x16_bf16 v[32:47], v[92:95], v[108:111], v[32:47]
  ds_read_b64_tr_b16 v[80:81], v117 offset:45120
  ds_read_b64_tr_b16 v[82:83], v117 offset:45888
  v_mfma_f32_32x32x16_bf16 v[48:63], v[108:111], v[96:99], v[48:63]
  ds_read_b64_tr_b16 v[84:85], v117 offset:45184
  ds_read_b64_tr_b16 v[86:87], v117 offset:45952
  s_waitcnt lgkmcnt(7)
  v_mfma_f32_32x32x16_bf16 v[16:31], v[64:67], v[100:103], v[16:31]
  ds_read_b128 v[108:111], v114 offset:28672
  ds_read_b64_tr_b16 v[88:89], v118 offset:45056
  ds_read_b64_tr_b16 v[90:91], v118 offset:45824
  v_mfma_f32_32x32x16_bf16 v[32:47], v[68:71], v[100:103], v[32:47]
  ds_read_b64_tr_b16 v[92:93], v118 offset:45120
  ds_read_b64_tr_b16 v[94:95], v118 offset:45888
  v_mfma_f32_32x32x16_bf16 v[48:63], v[100:103], v[72:75], v[48:63]
  ds_read_b64_tr_b16 v[96:97], v118 offset:45184
  ds_read_b64_tr_b16 v[98:99], v118 offset:45952
  v_mfma_f32_32x32x16_bf16 v[120:135], v[136:139], v[64:67], v[120:135]
  v_mfma_f32_32x32x16_bf16 v[120:135], v[140:143], v[68:71], v[120:135]
  v_mfma_f32_32x32x16_bf16 v[120:135], v[144:147], v[72:75], v[120:135]
  s_waitcnt lgkmcnt(7)
  v_mfma_f32_32x32x16_bf16 v[16:31], v[76:79], v[104:107], v[16:31]
  ds_read_b128 v[100:103], v115 offset:28672
  ds_read_b64_tr_b16 v[64:65], v119 offset:45056
  ds_read_b64_tr_b16 v[66:67], v119 offset:45824
  v_mfma_f32_32x32x16_bf16 v[32:47], v[80:83], v[104:107], v[32:47]
  ds_read_b64_tr_b16 v[68:69], v119 offset:45120
  ds_read_b64_tr_b16 v[70:71], v119 offset:45888
  v_mfma_f32_32x32x16_bf16 v[48:63], v[104:107], v[84:87], v[48:63]
  ds_read_b64_tr_b16 v[72:73], v119 offset:45184
  ds_read_b64_tr_b16 v[74:75], v119 offset:45952
  s_waitcnt lgkmcnt(7)
  s_barrier
  v_add_u32 v112, 0xe000, v112
  v_add_u32 v113, 0xe000, v113
  v_add_u32 v114, 0xe000, v114
  v_add_u32 v115, 0xe000, v115
  v_add_u32 v116, 0xe000, v116
  v_add_u32 v117, 0xe000, v117
  v_add_u32 v118, 0xe000, v118
  v_add_u32 v119, 0xe000, v119
  v_mfma_f32_32x32x16_bf16 v[16:31], v[88:91], v[108:111], v[16:31]
  ds_read_b128 v[104:107], v112 offset:0
  ds_read_b64_tr_b16 v[76:77], v116 offset:16384
  ds_read_b64_tr_b16 v[78:79], v116 offset:17152
  v_mfma_f32_32x32x16_bf16 v[32:47], v[92:95], v[108:111], v[32:47]
  ds_read_b64_tr_b16 v[80:81], v116 offset:16448
  ds_read_b64_tr_b16 v[82:83], v116 offset:17216
  v_mfma_f32_32x32x16_bf16 v[48:63], v[108:111], v[96:99], v[48:63]
  ds_read_b64_tr_b16 v[84:85], v116 offset:16512
  ds_read_b64_tr_b16 v[86:87], v116 offset:17280
  s_waitcnt lgkmcnt(7)
  v_mfma_f32_32x32x16_bf16 v[16:31], v[64:67], v[100:103], v[16:31]
  ds_read_b128 v[108:111], v113 offset:0
  ds_read_b64_tr_b16 v[88:89], v117 offset:16384
  ds_read_b64_tr_b16 v[90:91], v117 offset:17152
  v_mfma_f32_32x32x16_bf16 v[32:47], v[68:71], v[100:103], v[32:47]
  ds_read_b64_tr_b16 v[92:93], v117 offset:16448
  ds_read_b64_tr_b16 v[94:95], v117 offset:17216
  v_mfma_f32_32x32x16_bf16 v[48:63], v[100:103], v[72:75], v[48:63]
  ds_read_b64_tr_b16 v[96:97], v117 offset:16512
  ds_read_b64_tr_b16 v[98:99], v117 offset:17280
  s_waitcnt lgkmcnt(7)
  v_mfma_f32_32x32x16_bf16 v[16:31], v[76:79], v[104:107], v[16:31]
  ds_read_b128 v[100:103], v114 offset:0
  ds_read_b64_tr_b16 v[64:65], v118 offset:16384
  ds_read_b64_tr_b16 v[66:67], v118 offset:17152
  v_mfma_f32_32x32x16_bf16 v[32:47], v[80:83], v[104:107], v[32:47]
  ds_read_b64_tr_b16 v[68:69], v118 offset:16448
  ds_read_b64_tr_b16 v[70:71], v118 offset:17216
  v_mfma_f32_32x32x16_bf16 v[48:63], v[104:107], v[84:87], v[48:63]
  ds_read_b64_tr_b16 v[72:73], v118 offset:16512
  ds_read_b64_tr_b16 v[74:75], v118 offset:17280
  v_mfma_f32_32x32x16_bf16 v[120:135], v[136:139], v[76:79], v[120:135]
  v_mfma_f32_32x32x16_bf16 v[120:135], v[140:143], v[80:83], v[120:135]
  v_mfma_f32_32x32x16_bf16 v[120:135], v[144:147], v[84:87], v[120:135]
  s_waitcnt lgkmcnt(7)
  v_mfma_f32_32x32x16_bf16 v[16:31], v[88:91], v[108:111], v[16:31]
  ds_read_b128 v[104:107], v115 offset:0
  ds_read_b64_tr_b16 v[76:77], v119 offset:16384
  ds_read_b64_tr_b16 v[78:79], v119 offset:17152
  v_mfma_f32_32x32x16_bf16 v[32:47], v[92:95], v[108:111], v[32:47]
  ds_read_b64_tr_b16 v[80:81], v119 offset:16448
  ds_read_b64_tr_b16 v[82:83], v119 offset:17216
  v_mfma_f32_32x32x16_bf16 v[48:63], v[108:111], v[96:99], v[48:63]
  ds_read_b64_tr_b16 v[84:85], v119 offset:16512
  ds_read_b64_tr_b16 v[86:87], v119 offset:17280
  s_waitcnt lgkmcnt(7)
  s_barrier
  v_add_u32 v112, 0xfffe4000, v112
  v_add_u32 v113, 0xfffe4000, v113
  v_add_u32 v114, 0xfffe4000, v114
  v_add_u32 v115, 0xfffe4000, v115
  v_add_u32 v116, 0xfffe4000, v116
  v_add_u32 v117, 0xfffe4000, v117
  v_add_u32 v118, 0xfffe4000, v118
  v_add_u32 v119, 0xfffe4000, v119
  v_mfma_f32_32x32x16_bf16 v[16:31], v[64:67], v[100:103], v[16:31]
  ds_read_b128 v[108:111], v112 offset:0
  ds_read_b64_tr_b16 v[88:89], v116 offset:16384
  ds_read_b64_tr_b16 v[90:91], v116 offset:17152
  v_mfma_f32_32x32x16_bf16 v[32:47], v[68:71], v[100:103], v[32:47]
  ds_read_b64_tr_b16 v[92:93], v116 offset:16448
  ds_read_b64_tr_b16 v[94:95], v116 offset:17216
  v_mfma_f32_32x32x16_bf16 v[48:63], v[100:103], v[72:75], v[48:63]
  ds_read_b64_tr_b16 v[96:97], v116 offset:16512
  ds_read_b64_tr_b16 v[98:99], v116 offset:17280
  s_waitcnt lgkmcnt(7)
  v_mfma_f32_32x32x16_bf16 v[16:31], v[76:79], v[104:107], v[16:31]
  ds_read_b128 v[100:103], v113 offset:0
  ds_read_b64_tr_b16 v[64:65], v117 offset:16384
  ds_read_b64_tr_b16 v[66:67], v117 offset:17152
  v_mfma_f32_32x32x16_bf16 v[32:47], v[80:83], v[104:107], v[32:47]
  ds_read_b64_tr_b16 v[68:69], v117 offset:16448
  ds_read_b64_tr_b16 v[70:71], v117 offset:17216
  v_mfma_f32_32x32x16_bf16 v[48:63], v[104:107], v[84:87], v[48:63]
  ds_read_b64_tr_b16 v[72:73], v117 offset:16512
  ds_read_b64_tr_b16 v[74:75], v117 offset:17280
  s_waitcnt lgkmcnt(7)
  v_mfma_f32_32x32x16_bf16 v[16:31], v[88:91], v[108:111], v[16:31]
  ds_read_b128 v[104:107], v114 offset:0
  ds_read_b64_tr_b16 v[76:77], v118 offset:16384
  ds_read_b64_tr_b16 v[78:79], v118 offset:17152
  v_mfma_f32_32x32x16_bf16 v[32:47], v[92:95], v[108:111], v[32:47]
  ds_read_b64_tr_b16 v[80:81], v118 offset:16448
  ds_read_b64_tr_b16 v[82:83], v118 offset:17216
  v_mfma_f32_32x32x16_bf16 v[48:63], v[108:111], v[96:99], v[48:63]
  ds_read_b64_tr_b16 v[84:85], v118 offset:16512
  ds_read_b64_tr_b16 v[86:87], v118 offset:17280
  v_mfma_f32_32x32x16_bf16 v[120:135], v[136:139], v[88:91], v[120:135]
  v_mfma_f32_32x32x16_bf16 v[120:135], v[140:143], v[92:95], v[120:135]
  v_mfma_f32_32x32x16_bf16 v[120:135], v[144:147], v[96:99], v[120:135]
  s_waitcnt lgkmcnt(7)
  v_mfma_f32_32x32x16_bf16 v[16:31], v[64:67], v[100:103], v[16:31]
  ds_read_b128 v[108:111], v115 offset:0
  ds_read_b64_tr_b16 v[88:89], v119 offset:16384
  ds_read_b64_tr_b16 v[90:91], v119 offset:17152
  v_mfma_f32_32x32x16_bf16 v[32:47], v[68:71], v[100:103], v[32:47]
  ds_read_b64_tr_b16 v[92:93], v119 offset:16448
  ds_read_b64_tr_b16 v[94:95], v119 offset:17216
  v_mfma_f32_32x32x16_bf16 v[48:63], v[100:103], v[72:75], v[48:63]
  ds_read_b64_tr_b16 v[96:97], v119 offset:16512
  ds_read_b64_tr_b16 v[98:99], v119 offset:17280
  s_waitcnt lgkmcnt(7)
  s_barrier
  v_mfma_f32_32x32x16_bf16 v[16:31], v[76:79], v[104:107], v[16:31]
  ds_read_b128 v[100:103], v112 offset:28672
  ds_read_b64_tr_b16 v[64:65], v116 offset:45056
  ds_read_b64_tr_b16 v[66:67], v116 offset:45824
  v_mfma_f32_32x32x16_bf16 v[32:47], v[80:83], v[104:107], v[32:47]
  ds_read_b64_tr_b16 v[68:69], v116 offset:45120
  ds_read_b64_tr_b16 v[70:71], v116 offset:45888
  v_mfma_f32_32x32x16_bf16 v[48:63], v[104:107], v[84:87], v[48:63]
  ds_read_b64_tr_b16 v[72:73], v116 offset:45184
  ds_read_b64_tr_b16 v[74:75], v116 offset:45952
  s_waitcnt lgkmcnt(7)
  v_mfma_f32_32x32x16_bf16 v[16:31], v[88:91], v[108:111], v[16:31]
  ds_read_b128 v[104:107], v113 offset:28672
  ds_read_b64_tr_b16 v[76:77], v117 offset:45056
  ds_read_b64_tr_b16 v[78:79], v117 offset:45824
  v_mfma_f32_32x32x16_bf16 v[32:47], v[92:95], v[108:111], v[32:47]
  ds_read_b64_tr_b16 v[80:81], v117 offset:45120
  ds_read_b64_tr_b16 v[82:83], v117 offset:45888
  v_mfma_f32_32x32x16_bf16 v[48:63], v[108:111], v[96:99], v[48:63]
  ds_read_b64_tr_b16 v[84:85], v117 offset:45184
  ds_read_b64_tr_b16 v[86:87], v117 offset:45952
  s_waitcnt lgkmcnt(7)
  v_mfma_f32_32x32x16_bf16 v[16:31], v[64:67], v[100:103], v[16:31]
  ds_read_b128 v[108:111], v114 offset:28672
  ds_read_b64_tr_b16 v[88:89], v118 offset:45056
  ds_read_b64_tr_b16 v[90:91], v118 offset:45824
  v_mfma_f32_32x32x16_bf16 v[32:47], v[68:71], v[100:103], v[32:47]
  ds_read_b64_tr_b16 v[92:93], v118 offset:45120
  ds_read_b64_tr_b16 v[94:95], v118 offset:45888
  v_mfma_f32_32x32x16_bf16 v[48:63], v[100:103], v[72:75], v[48:63]
  ds_read_b64_tr_b16 v[96:97], v118 offset:45184
  ds_read_b64_tr_b16 v[98:99], v118 offset:45952
  v_mfma_f32_32x32x16_bf16 v[120:135], v[136:139], v[64:67], v[120:135]
  v_mfma_f32_32x32x16_bf16 v[120:135], v[140:143], v[68:71], v[120:135]
  v_mfma_f32_32x32x16_bf16 v[120:135], v[144:147], v[72:75], v[120:135]
  s_waitcnt lgkmcnt(7)
  v_mfma_f32_32x32x16_bf16 v[16:31], v[76:79], v[104:107], v[16:31]
  ds_read_b128 v[100:103], v115 offset:28672
  ds_read_b64_tr_b16 v[64:65], v119 offset:45056
  ds_read_b64_tr_b16 v[66:67], v119 offset:45824
  v_mfma_f32_32x32x16_bf16 v[32:47], v[80:83], v[104:107], v[32:47]
  ds_read_b64_tr_b16 v[68:69], v119 offset:45120
  ds_read_b64_tr_b16 v[70:71], v119 offset:45888
  v_mfma_f32_32x32x16_bf16 v[48:63], v[104:107], v[84:87], v[48:63]
  ds_read_b64_tr_b16 v[72:73], v119 offset:45184
  ds_read_b64_tr_b16 v[74:75], v119 offset:45952
  s_waitcnt lgkmcnt(7)
  s_barrier
  v_add_u32 v112, 0xe000, v112
  v_add_u32 v113, 0xe000, v113
  v_add_u32 v114, 0xe000, v114
  v_add_u32 v115, 0xe000, v115
  v_add_u32 v116, 0xe000, v116
  v_add_u32 v117, 0xe000, v117
  v_add_u32 v118, 0xe000, v118
  v_add_u32 v119, 0xe000, v119
  v_mfma_f32_32x32x16_bf16 v[16:31], v[88:91], v[108:111], v[16:31]
  ds_read_b128 v[104:107], v112 offset:0
  ds_read_b64_tr_b16 v[76:77], v116 offset:16384
  ds_read_b64_tr_b16 v[78:79], v116 offset:17152
  v_mfma_f32_32x32x16_bf16 v[32:47], v[92:95], v[108:111], v[32:47]
  ds_read_b64_tr_b16 v[80:81], v116 offset:16448
  ds_read_b64_tr_b16 v[82:83], v116 offset:17216
  v_mfma_f32_32x32x16_bf16 v[48:63], v[108:111], v[96:99], v[48:63]
  ds_read_b64_tr_b16 v[84:85], v116 offset:16512
  ds_read_b64_tr_b16 v[86:87], v116 offset:17280
  s_waitcnt lgkmcnt(7)
  v_mfma_f32_32x32x16_bf16 v[16:31], v[64:67], v[100:103], v[16:31]
  ds_read_b128 v[108:111], v113 offset:0
  ds_read_b64_tr_b16 v[88:89], v117 offset:16384
  ds_read_b64_tr_b16 v[90:91], v117 offset:17152
  v_mfma_f32_32x32x16_bf16 v[32:47], v[68:71], v[100:103], v[32:47]
  ds_read_b64_tr_b16 v[92:93], v117 offset:16448
  ds_read_b64_tr_b16 v[94:95], v117 offset:17216
  v_mfma_f32_32x32x16_bf16 v[48:63], v[100:103], v[72:75], v[48:63]
  ds_read_b64_tr_b16 v[96:97], v117 offset:16512
  ds_read_b64_tr_b16 v[98:99], v117 offset:17280
  s_waitcnt lgkmcnt(7)
  v_mfma_f32_32x32x16_bf16 v[16:31], v[76:79], v[104:107], v[16:31]
  ds_read_b128 v[100:103], v114 offset:0
  ds_read_b64_tr_b16 v[64:65], v118 offset:16384
  ds_read_b64_tr_b16 v[66:67], v118 offset:17152
  v_mfma_f32_32x32x16_bf16 v[32:47], v[80:83], v[104:107], v[32:47]
  ds_read_b64_tr_b16 v[68:69], v118 offset:16448
  ds_read_b64_tr_b16 v[70:71], v118 offset:17216
  v_mfma_f32_32x32x16_bf16 v[48:63], v[104:107], v[84:87], v[48:63]
  ds_read_b64_tr_b16 v[72:73], v118 offset:16512
  ds_read_b64_tr_b16 v[74:75], v118 offset:17280
  v_mfma_f32_32x32x16_bf16 v[120:135], v[136:139], v[76:79], v[120:135]
  v_mfma_f32_32x32x16_bf16 v[120:135], v[140:143], v[80:83], v[120:135]
  v_mfma_f32_32x32x16_bf16 v[120:135], v[144:147], v[84:87], v[120:135]
  s_waitcnt lgkmcnt(7)
  v_mfma_f32_32x32x16_bf16 v[16:31], v[88:91], v[108:111], v[16:31]
  ds_read_b128 v[104:107], v115 offset:0
  ds_read_b64_tr_b16 v[76:77], v119 offset:16384
  ds_read_b64_tr_b16 v[78:79], v119 offset:17152
  v_mfma_f32_32x32x16_bf16 v[32:47], v[92:95], v[108:111], v[32:47]
  ds_read_b64_tr_b16 v[80:81], v119 offset:16448
  ds_read_b64_tr_b16 v[82:83], v119 offset:17216
  v_mfma_f32_32x32x16_bf16 v[48:63], v[108:111], v[96:99], v[48:63]
  ds_read_b64_tr_b16 v[84:85], v119 offset:16512
  ds_read_b64_tr_b16 v[86:87], v119 offset:17280
  s_waitcnt lgkmcnt(7)
  v_mfma_f32_32x32x16_bf16 v[16:31], v[64:67], v[100:103], v[16:31]
  v_mfma_f32_32x32x16_bf16 v[32:47], v[68:71], v[100:103], v[32:47]
  v_mfma_f32_32x32x16_bf16 v[48:63], v[100:103], v[72:75], v[48:63]
  s_waitcnt lgkmcnt(0)
  v_mfma_f32_32x32x16_bf16 v[16:31], v[76:79], v[104:107], v[16:31]
  v_mfma_f32_32x32x16_bf16 v[32:47], v[80:83], v[104:107], v[32:47]
  v_mfma_f32_32x32x16_bf16 v[48:63], v[104:107], v[84:87], v[48:63]
  v_lshlrev_b32 v8, 2, v1
  v_add_u32 v8, 143360, v8
  s_mov_b32 exec_hi, 0
  ds_add_f32 v8, v120 offset:0
  ds_add_f32 v8, v121 offset:128
  ds_add_f32 v8, v122 offset:256
  s_mov_b64 exec, -1
  s_waitcnt lgkmcnt(0)
  s_barrier
  s_lshl_b32 s27, s22, 8
  s_add_u32 s27, s27, 143872
  v_lshlrev_b32 v8, 4, v6
  v_add_u32 v11, s27, v8
  v_add_u32 v8, 143360, v8
  v_and_b32 v9, 31, v1
  v_lshlrev_b32 v9, 2, v9
  v_add_u32 v5, s27, v9
  v_add_u32 v9, 143360, v9
  ds_read_b32 v14, v5
  ds_read_b32 v15, v5 offset:128
  ds_read_b128 v[64:67], v8 offset:0
  ds_read_b128 v[68:71], v8 offset:32
  ds_read_b128 v[72:75], v8 offset:64
  ds_read_b128 v[76:79], v8 offset:96
  ds_read_b128 v[80:83], v8 offset:128
  ds_read_b128 v[84:87], v8 offset:160
  ds_read_b128 v[88:91], v8 offset:192
  ds_read_b128 v[92:95], v8 offset:224
  ds_read_b32 v13, v9 offset:256
  ds_read_b128 v[96:99], v11 offset:0
  ds_read_b128 v[100:103], v11 offset:32
  ds_read_b128 v[104:107], v11 offset:64
  ds_read_b128 v[108:111], v11 offset:96
  s_waitcnt lgkmcnt(9)
  v_mul_f32 v10, 0x3eb8aa3b, v15
  v_mul_f32 v12, v10, v14
  v_mul_f32 v14, v15, v14
  s_lshl_b32 s27, s23, 2
  s_add_u32 s27, s27, s22
  s_lshl_b32 s28, s24, 7
  s_add_u32 s28, s28, s27
  s_lshl_b32 s28, s28, 10
  v_lshlrev_b32 v8, 4, v1
  s_add_u32 s46, s28, 0x0
  s_add_u32 s47, s28, 0x10000
  s_add_u32 s48, s28, 0x200000
  s_add_u32 s49, s28, 0x210000
  s_add_u32 s50, s28, 0x400000
  v_mul_f32 v16, v10, v16
  v_fma_f32 v16, -v12, v64, v16
  v_mul_f32 v17, v10, v17
  v_fma_f32 v17, -v12, v65, v17
  v_mul_f32 v18, v10, v18
  v_fma_f32 v18, -v12, v66, v18
  v_mul_f32 v19, v10, v19
  v_fma_f32 v19, -v12, v67, v19
  v_mul_f32 v20, v10, v20
  v_fma_f32 v20, -v12, v68, v20
  v_mul_f32 v21, v10, v21
  v_fma_f32 v21, -v12, v69, v21
  v_mul_f32 v22, v10, v22
  v_fma_f32 v22, -v12, v70, v22
  v_mul_f32 v23, v10, v23
  v_fma_f32 v23, -v12, v71, v23
  v_mul_f32 v24, v10, v24
  v_fma_f32 v24, -v12, v72, v24
  v_mul_f32 v25, v10, v25
  v_fma_f32 v25, -v12, v73, v25
  v_mul_f32 v26, v10, v26
  v_fma_f32 v26, -v12, v74, v26
  v_mul_f32 v27, v10, v27
  v_fma_f32 v27, -v12, v75, v27
  v_mul_f32 v28, v10, v28
  v_fma_f32 v28, -v12, v76, v28
  v_mul_f32 v29, v10, v29
  v_fma_f32 v29, -v12, v77, v29
  v_mul_f32 v30, v10, v30
  v_fma_f32 v30, -v12, v78, v30
  v_mul_f32 v31, v10, v31
  v_fma_f32 v31, -v12, v79, v31
  s_waitcnt lgkmcnt(0)
  ds_read_b128 v[112:115], v11 offset:128
  ds_read_b128 v[116:119], v11 offset:160
  ds_read_b128 v[120:123], v11 offset:192
  ds_read_b128 v[124:127], v11 offset:224
  v_cvt_pk_bf16_f32 v64, v16, v17
  v_cvt_pk_bf16_f32 v65, v18, v19
  v_cvt_pk_bf16_f32 v66, v20, v21
  v_cvt_pk_bf16_f32 v67, v22, v23
  v_cvt_pk_bf16_f32 v68, v24, v25
  v_cvt_pk_bf16_f32 v69, v26, v27
  v_cvt_pk_bf16_f32 v70, v28, v29
  v_cvt_pk_bf16_f32 v71, v30, v31
  buffer_store_dwordx4 v[64:67], v8, s[52:55], s46 offen sc1
  buffer_store_dwordx4 v[68:71], v8, s[52:55], s47 offen sc1
  v_mul_f32 v32, v15, v32
  v_fma_f32 v32, -v14, v80, v32
  v_mul_f32 v33, v15, v33
  v_fma_f32 v33, -v14, v81, v33
  v_mul_f32 v34, v15, v34
  v_fma_f32 v34, -v14, v82, v34
  v_mul_f32 v35, v15, v35
  v_fma_f32 v35, -v14, v83, v35
  v_mul_f32 v36, v15, v36
  v_fma_f32 v36, -v14, v84, v36
  v_mul_f32 v37, v15, v37
  v_fma_f32 v37, -v14, v85, v37
  v_mul_f32 v38, v15, v38
  v_fma_f32 v38, -v14, v86, v38
  v_mul_f32 v39, v15, v39
  v_fma_f32 v39, -v14, v87, v39
  v_mul_f32 v40, v15, v40
  v_fma_f32 v40, -v14, v88, v40
  v_mul_f32 v41, v15, v41
  v_fma_f32 v41, -v14, v89, v41
  v_mul_f32 v42, v15, v42
  v_fma_f32 v42, -v14, v90, v42
  v_mul_f32 v43, v15, v43
  v_fma_f32 v43, -v14, v91, v43
  v_mul_f32 v44, v15, v44
  v_fma_f32 v44, -v14, v92, v44
  v_mul_f32 v45, v15, v45
  v_fma_f32 v45, -v14, v93, v45
  v_mul_f32 v46, v15, v46
  v_fma_f32 v46, -v14, v94, v46
  v_mul_f32 v47, v15, v47
  v_fma_f32 v47, -v14, v95, v47
  v_cvt_pk_bf16_f32 v72, v32, v33
  v_cvt_pk_bf16_f32 v73, v34, v35
  v_cvt_pk_bf16_f32 v74, v36, v37
  v_cvt_pk_bf16_f32 v75, v38, v39
  v_cvt_pk_bf16_f32 v76, v40, v41
  v_cvt_pk_bf16_f32 v77, v42, v43
  v_cvt_pk_bf16_f32 v78, v44, v45
  v_cvt_pk_bf16_f32 v79, v46, v47
  buffer_store_dwordx4 v[72:75], v8, s[52:55], s48 offen sc1
  buffer_store_dwordx4 v[76:79], v8, s[52:55], s49 offen sc1
  s_waitcnt lgkmcnt(0)
  v_fma_f32 v48, -v96, v13, v48
  v_mul_f32 v48, v112, v48
  v_fma_f32 v49, -v97, v13, v49
  v_mul_f32 v49, v113, v49
  v_fma_f32 v50, -v98, v13, v50
  v_mul_f32 v50, v114, v50
  v_fma_f32 v51, -v99, v13, v51
  v_mul_f32 v51, v115, v51
  v_fma_f32 v52, -v100, v13, v52
  v_mul_f32 v52, v116, v52
  v_fma_f32 v53, -v101, v13, v53
  v_mul_f32 v53, v117, v53
  v_fma_f32 v54, -v102, v13, v54
  v_mul_f32 v54, v118, v54
  v_fma_f32 v55, -v103, v13, v55
  v_mul_f32 v55, v119, v55
  v_fma_f32 v56, -v104, v13, v56
  v_mul_f32 v56, v120, v56
  v_fma_f32 v57, -v105, v13, v57
  v_mul_f32 v57, v121, v57
  v_fma_f32 v58, -v106, v13, v58
  v_mul_f32 v58, v122, v58
  v_fma_f32 v59, -v107, v13, v59
  v_mul_f32 v59, v123, v59
  v_fma_f32 v60, -v108, v13, v60
  v_mul_f32 v60, v124, v60
  v_fma_f32 v61, -v109, v13, v61
  v_mul_f32 v61, v125, v61
  v_fma_f32 v62, -v110, v13, v62
  v_mul_f32 v62, v126, v62
  v_fma_f32 v63, -v111, v13, v63
  v_mul_f32 v63, v127, v63
  v_cvt_pk_bf16_f32 v80, v48, v49
  v_cvt_pk_bf16_f32 v81, v50, v51
  v_cvt_pk_bf16_f32 v82, v52, v53
  v_cvt_pk_bf16_f32 v83, v54, v55
  v_cvt_pk_bf16_f32 v84, v56, v57
  v_cvt_pk_bf16_f32 v85, v58, v59
  v_cvt_pk_bf16_f32 v86, v60, v61
  v_cvt_pk_bf16_f32 v87, v62, v63
  v_bfe_u32 v9, v1, 4, 1
  v_lshlrev_b32 v9, 16, v9
  v_lshl_add_u32 v9, v6, 8, v9
  v_and_b32 v10, 15, v1
  v_lshl_add_u32 v9, v10, 4, v9
  buffer_store_dwordx4 v[80:83], v9, s[52:55], s50 offen sc1
  buffer_store_dwordx4 v[84:87], v9, s[52:55], s50 offen offset:512 sc1
  s_endpgm
qkv1_kernel_stats:
  v_mov_b32 v96, 0
  v_mov_b32 v97, 0
  v_mov_b32 v98, 0
  v_mov_b32 v99, 0
  s_barrier
  ds_read_b128 v[80:83], v112 offset:0
  ds_read_b128 v[84:87], v113 offset:0
  s_waitcnt lgkmcnt(1)
  ds_read_b128 v[88:91], v114 offset:0
  v_lshlrev_b32 v10, 16, v80
  v_and_b32 v11, 0xffff0000, v80
  v_add_f32 v96, v96, v10
  v_add_f32 v97, v97, v11
  v_fmac_f32 v98, v10, v10
  v_fmac_f32 v99, v11, v11
  v_lshlrev_b32 v10, 16, v81
  v_and_b32 v11, 0xffff0000, v81
  v_add_f32 v96, v96, v10
  v_add_f32 v97, v97, v11
  v_fmac_f32 v98, v10, v10
  v_fmac_f32 v99, v11, v11
  v_lshlrev_b32 v10, 16, v82
  v_and_b32 v11, 0xffff0000, v82
  v_add_f32 v96, v96, v10
  v_add_f32 v97, v97, v11
  v_fmac_f32 v98, v10, v10
  v_fmac_f32 v99, v11, v11
  v_lshlrev_b32 v10, 16, v83
  v_and_b32 v11, 0xffff0000, v83
  v_add_f32 v96, v96, v10
  v_add_f32 v97, v97, v11
  v_fmac_f32 v98, v10, v10
  v_fmac_f32 v99, v11, v11
  s_waitcnt lgkmcnt(1)
  ds_read_b128 v[80:83], v115 offset:0
  v_lshlrev_b32 v10, 16, v84
  v_and_b32 v11, 0xffff0000, v84
  v_add_f32 v96, v96, v10
  v_add_f32 v97, v97, v11
  v_fmac_f32 v98, v10, v10
  v_fmac_f32 v99, v11, v11
  v_lshlrev_b32 v10, 16, v85
  v_and_b32 v11, 0xffff0000, v85
  v_add_f32 v96, v96, v10
  v_add_f32 v97, v97, v11
  v_fmac_f32 v98, v10, v10
  v_fmac_f32 v99, v11, v11
  v_lshlrev_b32 v10, 16, v86
  v_and_b32 v11, 0xffff0000, v86
  v_add_f32 v96, v96, v10
  v_add_f32 v97, v97, v11
  v_fmac_f32 v98, v10, v10
  v_fmac_f32 v99, v11, v11
  v_lshlrev_b32 v10, 16, v87
  v_and_b32 v11, 0xffff0000, v87
  v_add_f32 v96, v96, v10
  v_add_f32 v97, v97, v11
  v_fmac_f32 v98, v10, v10
  v_fmac_f32 v99, v11, v11
  s_waitcnt lgkmcnt(1)
  s_barrier
  ds_read_b128 v[84:87], v112 offset:28672
  v_lshlrev_b32 v10, 16, v88
  v_and_b32 v11, 0xffff0000, v88
  v_add_f32 v96, v96, v10
  v_add_f32 v97, v97, v11
  v_fmac_f32 v98, v10, v10
  v_fmac_f32 v99, v11, v11
  v_lshlrev_b32 v10, 16, v89
  v_and_b32 v11, 0xffff0000, v89
  v_add_f32 v96, v96, v10
  v_add_f32 v97, v97, v11
  v_fmac_f32 v98, v10, v10
  v_fmac_f32 v99, v11, v11
  v_lshlrev_b32 v10, 16, v90
  v_and_b32 v11, 0xffff0000, v90
  v_add_f32 v96, v96, v10
  v_add_f32 v97, v97, v11
  v_fmac_f32 v98, v10, v10
  v_fmac_f32 v99, v11, v11
  v_lshlrev_b32 v10, 16, v91
  v_and_b32 v11, 0xffff0000, v91
  v_add_f32 v96, v96, v10
  v_add_f32 v97, v97, v11
  v_fmac_f32 v98, v10, v10
  v_fmac_f32 v99, v11, v11
  s_waitcnt lgkmcnt(1)
  ds_read_b128 v[88:91], v113 offset:28672
  v_lshlrev_b32 v10, 16, v80
  v_and_b32 v11, 0xffff0000, v80
  v_add_f32 v96, v96, v10
  v_add_f32 v97, v97, v11
  v_fmac_f32 v98, v10, v10
  v_fmac_f32 v99, v11, v11
  v_lshlrev_b32 v10, 16, v81
  v_and_b32 v11, 0xffff0000, v81
  v_add_f32 v96, v96, v10
  v_add_f32 v97, v97, v11
  v_fmac_f32 v98, v10, v10
  v_fmac_f32 v99, v11, v11
  v_lshlrev_b32 v10, 16, v82
  v_and_b32 v11, 0xffff0000, v82
  v_add_f32 v96, v96, v10
  v_add_f32 v97, v97, v11
  v_fmac_f32 v98, v10, v10
  v_fmac_f32 v99, v11, v11
  v_lshlrev_b32 v10, 16, v83
  v_and_b32 v11, 0xffff0000, v83
  v_add_f32 v96, v96, v10
  v_add_f32 v97, v97, v11
  v_fmac_f32 v98, v10, v10
  v_fmac_f32 v99, v11, v11
  s_waitcnt lgkmcnt(1)
  ds_read_b128 v[80:83], v114 offset:28672
  v_lshlrev_b32 v10, 16, v84
  v_and_b32 v11, 0xffff0000, v84
  v_add_f32 v96, v96, v10
  v_add_f32 v97, v97, v11
  v_fmac_f32 v98, v10, v10
  v_fmac_f32 v99, v11, v11
  v_lshlrev_b32 v10, 16, v85
  v_and_b32 v11, 0xffff0000, v85
  v_add_f32 v96, v96, v10
  v_add_f32 v97, v97, v11
  v_fmac_f32 v98, v10, v10
  v_fmac_f32 v99, v11, v11
  v_lshlrev_b32 v10, 16, v86
  v_and_b32 v11, 0xffff0000, v86
  v_add_f32 v96, v96, v10
  v_add_f32 v97, v97, v11
  v_fmac_f32 v98, v10, v10
  v_fmac_f32 v99, v11, v11
  v_lshlrev_b32 v10, 16, v87
  v_and_b32 v11, 0xffff0000, v87
  v_add_f32 v96, v96, v10
  v_add_f32 v97, v97, v11
  v_fmac_f32 v98, v10, v10
  v_fmac_f32 v99, v11, v11
  s_waitcnt lgkmcnt(1)
  ds_read_b128 v[84:87], v115 offset:28672
  v_lshlrev_b32 v10, 16, v88
  v_and_b32 v11, 0xffff0000, v88
  v_add_f32 v96, v96, v10
  v_add_f32 v97, v97, v11
  v_fmac_f32 v98, v10, v10
  v_fmac_f32 v99, v11, v11
  v_lshlrev_b32 v10, 16, v89
  v_and_b32 v11, 0xffff0000, v89
  v_add_f32 v96, v96, v10
  v_add_f32 v97, v97, v11
  v_fmac_f32 v98, v10, v10
  v_fmac_f32 v99, v11, v11
  v_lshlrev_b32 v10, 16, v90
  v_and_b32 v11, 0xffff0000, v90
  v_add_f32 v96, v96, v10
  v_add_f32 v97, v97, v11
  v_fmac_f32 v98, v10, v10
  v_fmac_f32 v99, v11, v11
  v_lshlrev_b32 v10, 16, v91
  v_and_b32 v11, 0xffff0000, v91
  v_add_f32 v96, v96, v10
  v_add_f32 v97, v97, v11
  v_fmac_f32 v98, v10, v10
  v_fmac_f32 v99, v11, v11
  s_waitcnt lgkmcnt(1)
  s_barrier
  v_add_u32 v112, 0xe000, v112
  v_add_u32 v113, 0xe000, v113
  v_add_u32 v114, 0xe000, v114
  v_add_u32 v115, 0xe000, v115
  ds_read_b128 v[88:91], v112 offset:0
  v_lshlrev_b32 v10, 16, v80
  v_and_b32 v11, 0xffff0000, v80
  v_add_f32 v96, v96, v10
  v_add_f32 v97, v97, v11
  v_fmac_f32 v98, v10, v10
  v_fmac_f32 v99, v11, v11
  v_lshlrev_b32 v10, 16, v81
  v_and_b32 v11, 0xffff0000, v81
  v_add_f32 v96, v96, v10
  v_add_f32 v97, v97, v11
  v_fmac_f32 v98, v10, v10
  v_fmac_f32 v99, v11, v11
  v_lshlrev_b32 v10, 16, v82
  v_and_b32 v11, 0xffff0000, v82
  v_add_f32 v96, v96, v10
  v_add_f32 v97, v97, v11
  v_fmac_f32 v98, v10, v10
  v_fmac_f32 v99, v11, v11
  v_lshlrev_b32 v10, 16, v83
  v_and_b32 v11, 0xffff0000, v83
  v_add_f32 v96, v96, v10
  v_add_f32 v97, v97, v11
  v_fmac_f32 v98, v10, v10
  v_fmac_f32 v99, v11, v11
  s_waitcnt lgkmcnt(1)
  ds_read_b128 v[80:83], v113 offset:0
  v_lshlrev_b32 v10, 16, v84
  v_and_b32 v11, 0xffff0000, v84
  v_add_f32 v96, v96, v10
  v_add_f32 v97, v97, v11
  v_fmac_f32 v98, v10, v10
  v_fmac_f32 v99, v11, v11
  v_lshlrev_b32 v10, 16, v85
  v_and_b32 v11, 0xffff0000, v85
  v_add_f32 v96, v96, v10
  v_add_f32 v97, v97, v11
  v_fmac_f32 v98, v10, v10
  v_fmac_f32 v99, v11, v11
  v_lshlrev_b32 v10, 16, v86
  v_and_b32 v11, 0xffff0000, v86
  v_add_f32 v96, v96, v10
  v_add_f32 v97, v97, v11
  v_fmac_f32 v98, v10, v10
  v_fmac_f32 v99, v11, v11
  v_lshlrev_b32 v10, 16, v87
  v_and_b32 v11, 0xffff0000, v87
  v_add_f32 v96, v96, v10
  v_add_f32 v97, v97, v11
  v_fmac_f32 v98, v10, v10
  v_fmac_f32 v99, v11, v11
  s_waitcnt lgkmcnt(1)
  ds_read_b128 v[84:87], v114 offset:0
  v_lshlrev_b32 v10, 16, v88
  v_and_b32 v11, 0xffff0000, v88
  v_add_f32 v96, v96, v10
  v_add_f32 v97, v97, v11
  v_fmac_f32 v98, v10, v10
  v_fmac_f32 v99, v11, v11
  v_lshlrev_b32 v10, 16, v89
  v_and_b32 v11, 0xffff0000, v89
  v_add_f32 v96, v96, v10
  v_add_f32 v97, v97, v11
  v_fmac_f32 v98, v10, v10
  v_fmac_f32 v99, v11, v11
  v_lshlrev_b32 v10, 16, v90
  v_and_b32 v11, 0xffff0000, v90
  v_add_f32 v96, v96, v10
  v_add_f32 v97, v97, v11
  v_fmac_f32 v98, v10, v10
  v_fmac_f32 v99, v11, v11
  v_lshlrev_b32 v10, 16, v91
  v_and_b32 v11, 0xffff0000, v91
  v_add_f32 v96, v96, v10
  v_add_f32 v97, v97, v11
  v_fmac_f32 v98, v10, v10
  v_fmac_f32 v99, v11, v11
  s_waitcnt lgkmcnt(1)
  ds_read_b128 v[88:91], v115 offset:0
  v_lshlrev_b32 v10, 16, v80
  v_and_b32 v11, 0xffff0000, v80
  v_add_f32 v96, v96, v10
  v_add_f32 v97, v97, v11
  v_fmac_f32 v98, v10, v10
  v_fmac_f32 v99, v11, v11
  v_lshlrev_b32 v10, 16, v81
  v_and_b32 v11, 0xffff0000, v81
  v_add_f32 v96, v96, v10
  v_add_f32 v97, v97, v11
  v_fmac_f32 v98, v10, v10
  v_fmac_f32 v99, v11, v11
  v_lshlrev_b32 v10, 16, v82
  v_and_b32 v11, 0xffff0000, v82
  v_add_f32 v96, v96, v10
  v_add_f32 v97, v97, v11
  v_fmac_f32 v98, v10, v10
  v_fmac_f32 v99, v11, v11
  v_lshlrev_b32 v10, 16, v83
  v_and_b32 v11, 0xffff0000, v83
  v_add_f32 v96, v96, v10
  v_add_f32 v97, v97, v11
  v_fmac_f32 v98, v10, v10
  v_fmac_f32 v99, v11, v11
  s_waitcnt lgkmcnt(1)
  s_barrier
  ds_read_b128 v[80:83], v112 offset:28672
  v_lshlrev_b32 v10, 16, v84
  v_and_b32 v11, 0xffff0000, v84
  v_add_f32 v96, v96, v10
  v_add_f32 v97, v97, v11
  v_fmac_f32 v98, v10, v10
  v_fmac_f32 v99, v11, v11
  v_lshlrev_b32 v10, 16, v85
  v_and_b32 v11, 0xffff0000, v85
  v_add_f32 v96, v96, v10
  v_add_f32 v97, v97, v11
  v_fmac_f32 v98, v10, v10
  v_fmac_f32 v99, v11, v11
  v_lshlrev_b32 v10, 16, v86
  v_and_b32 v11, 0xffff0000, v86
  v_add_f32 v96, v96, v10
  v_add_f32 v97, v97, v11
  v_fmac_f32 v98, v10, v10
  v_fmac_f32 v99, v11, v11
  v_lshlrev_b32 v10, 16, v87
  v_and_b32 v11, 0xffff0000, v87
  v_add_f32 v96, v96, v10
  v_add_f32 v97, v97, v11
  v_fmac_f32 v98, v10, v10
  v_fmac_f32 v99, v11, v11
  s_waitcnt lgkmcnt(1)
  ds_read_b128 v[84:87], v113 offset:28672
  v_lshlrev_b32 v10, 16, v88
  v_and_b32 v11, 0xffff0000, v88
  v_add_f32 v96, v96, v10
  v_add_f32 v97, v97, v11
  v_fmac_f32 v98, v10, v10
  v_fmac_f32 v99, v11, v11
  v_lshlrev_b32 v10, 16, v89
  v_and_b32 v11, 0xffff0000, v89
  v_add_f32 v96, v96, v10
  v_add_f32 v97, v97, v11
  v_fmac_f32 v98, v10, v10
  v_fmac_f32 v99, v11, v11
  v_lshlrev_b32 v10, 16, v90
  v_and_b32 v11, 0xffff0000, v90
  v_add_f32 v96, v96, v10
  v_add_f32 v97, v97, v11
  v_fmac_f32 v98, v10, v10
  v_fmac_f32 v99, v11, v11
  v_lshlrev_b32 v10, 16, v91
  v_and_b32 v11, 0xffff0000, v91
  v_add_f32 v96, v96, v10
  v_add_f32 v97, v97, v11
  v_fmac_f32 v98, v10, v10
  v_fmac_f32 v99, v11, v11
  s_waitcnt lgkmcnt(1)
  ds_read_b128 v[88:91], v114 offset:28672
  v_lshlrev_b32 v10, 16, v80
  v_and_b32 v11, 0xffff0000, v80
  v_add_f32 v96, v96, v10
  v_add_f32 v97, v97, v11
  v_fmac_f32 v98, v10, v10
  v_fmac_f32 v99, v11, v11
  v_lshlrev_b32 v10, 16, v81
  v_and_b32 v11, 0xffff0000, v81
  v_add_f32 v96, v96, v10
  v_add_f32 v97, v97, v11
  v_fmac_f32 v98, v10, v10
  v_fmac_f32 v99, v11, v11
  v_lshlrev_b32 v10, 16, v82
  v_and_b32 v11, 0xffff0000, v82
  v_add_f32 v96, v96, v10
  v_add_f32 v97, v97, v11
  v_fmac_f32 v98, v10, v10
  v_fmac_f32 v99, v11, v11
  v_lshlrev_b32 v10, 16, v83
  v_and_b32 v11, 0xffff0000, v83
  v_add_f32 v96, v96, v10
  v_add_f32 v97, v97, v11
  v_fmac_f32 v98, v10, v10
  v_fmac_f32 v99, v11, v11
  s_waitcnt lgkmcnt(1)
  ds_read_b128 v[80:83], v115 offset:28672
  v_lshlrev_b32 v10, 16, v84
  v_and_b32 v11, 0xffff0000, v84
  v_add_f32 v96, v96, v10
  v_add_f32 v97, v97, v11
  v_fmac_f32 v98, v10, v10
  v_fmac_f32 v99, v11, v11
  v_lshlrev_b32 v10, 16, v85
  v_and_b32 v11, 0xffff0000, v85
  v_add_f32 v96, v96, v10
  v_add_f32 v97, v97, v11
  v_fmac_f32 v98, v10, v10
  v_fmac_f32 v99, v11, v11
  v_lshlrev_b32 v10, 16, v86
  v_and_b32 v11, 0xffff0000, v86
  v_add_f32 v96, v96, v10
  v_add_f32 v97, v97, v11
  v_fmac_f32 v98, v10, v10
  v_fmac_f32 v99, v11, v11
  v_lshlrev_b32 v10, 16, v87
  v_and_b32 v11, 0xffff0000, v87
  v_add_f32 v96, v96, v10
  v_add_f32 v97, v97, v11
  v_fmac_f32 v98, v10, v10
  v_fmac_f32 v99, v11, v11
  s_waitcnt lgkmcnt(1)
  s_barrier
  v_add_u32 v112, 0xe000, v112
  v_add_u32 v113, 0xe000, v113
  v_add_u32 v114, 0xe000, v114
  v_add_u32 v115, 0xe000, v115
  ds_read_b128 v[84:87], v112 offset:0
  v_lshlrev_b32 v10, 16, v88
  v_and_b32 v11, 0xffff0000, v88
  v_add_f32 v96, v96, v10
  v_add_f32 v97, v97, v11
  v_fmac_f32 v98, v10, v10
  v_fmac_f32 v99, v11, v11
  v_lshlrev_b32 v10, 16, v89
  v_and_b32 v11, 0xffff0000, v89
  v_add_f32 v96, v96, v10
  v_add_f32 v97, v97, v11
  v_fmac_f32 v98, v10, v10
  v_fmac_f32 v99, v11, v11
  v_lshlrev_b32 v10, 16, v90
  v_and_b32 v11, 0xffff0000, v90
  v_add_f32 v96, v96, v10
  v_add_f32 v97, v97, v11
  v_fmac_f32 v98, v10, v10
  v_fmac_f32 v99, v11, v11
  v_lshlrev_b32 v10, 16, v91
  v_and_b32 v11, 0xffff0000, v91
  v_add_f32 v96, v96, v10
  v_add_f32 v97, v97, v11
  v_fmac_f32 v98, v10, v10
  v_fmac_f32 v99, v11, v11
  s_waitcnt lgkmcnt(1)
  ds_read_b128 v[88:91], v113 offset:0
  v_lshlrev_b32 v10, 16, v80
  v_and_b32 v11, 0xffff0000, v80
  v_add_f32 v96, v96, v10
  v_add_f32 v97, v97, v11
  v_fmac_f32 v98, v10, v10
  v_fmac_f32 v99, v11, v11
  v_lshlrev_b32 v10, 16, v81
  v_and_b32 v11, 0xffff0000, v81
  v_add_f32 v96, v96, v10
  v_add_f32 v97, v97, v11
  v_fmac_f32 v98, v10, v10
  v_fmac_f32 v99, v11, v11
  v_lshlrev_b32 v10, 16, v82
  v_and_b32 v11, 0xffff0000, v82
  v_add_f32 v96, v96, v10
  v_add_f32 v97, v97, v11
  v_fmac_f32 v98, v10, v10
  v_fmac_f32 v99, v11, v11
  v_lshlrev_b32 v10, 16, v83
  v_and_b32 v11, 0xffff0000, v83
  v_add_f32 v96, v96, v10
  v_add_f32 v97, v97, v11
  v_fmac_f32 v98, v10, v10
  v_fmac_f32 v99, v11, v11
  s_waitcnt lgkmcnt(1)
  ds_read_b128 v[80:83], v114 offset:0
  v_lshlrev_b32 v10, 16, v84
  v_and_b32 v11, 0xffff0000, v84
  v_add_f32 v96, v96, v10
  v_add_f32 v97, v97, v11
  v_fmac_f32 v98, v10, v10
  v_fmac_f32 v99, v11, v11
  v_lshlrev_b32 v10, 16, v85
  v_and_b32 v11, 0xffff0000, v85
  v_add_f32 v96, v96, v10
  v_add_f32 v97, v97, v11
  v_fmac_f32 v98, v10, v10
  v_fmac_f32 v99, v11, v11
  v_lshlrev_b32 v10, 16, v86
  v_and_b32 v11, 0xffff0000, v86
  v_add_f32 v96, v96, v10
  v_add_f32 v97, v97, v11
  v_fmac_f32 v98, v10, v10
  v_fmac_f32 v99, v11, v11
  v_lshlrev_b32 v10, 16, v87
  v_and_b32 v11, 0xffff0000, v87
  v_add_f32 v96, v96, v10
  v_add_f32 v97, v97, v11
  v_fmac_f32 v98, v10, v10
  v_fmac_f32 v99, v11, v11
  s_waitcnt lgkmcnt(1)
  ds_read_b128 v[84:87], v115 offset:0
  v_lshlrev_b32 v10, 16, v88
  v_and_b32 v11, 0xffff0000, v88
  v_add_f32 v96, v96, v10
  v_add_f32 v97, v97, v11
  v_fmac_f32 v98, v10, v10
  v_fmac_f32 v99, v11, v11
  v_lshlrev_b32 v10, 16, v89
  v_and_b32 v11, 0xffff0000, v89
  v_add_f32 v96, v96, v10
  v_add_f32 v97, v97, v11
  v_fmac_f32 v98, v10, v10
  v_fmac_f32 v99, v11, v11
  v_lshlrev_b32 v10, 16, v90
  v_and_b32 v11, 0xffff0000, v90
  v_add_f32 v96, v96, v10
  v_add_f32 v97, v97, v11
  v_fmac_f32 v98, v10, v10
  v_fmac_f32 v99, v11, v11
  v_lshlrev_b32 v10, 16, v91
  v_and_b32 v11, 0xffff0000, v91
  v_add_f32 v96, v96, v10
  v_add_f32 v97, v97, v11
  v_fmac_f32 v98, v10, v10
  v_fmac_f32 v99, v11, v11
  s_waitcnt lgkmcnt(1)
  s_barrier
  v_add_u32 v112, 0xfffe4000, v112
  v_add_u32 v113, 0xfffe4000, v113
  v_add_u32 v114, 0xfffe4000, v114
  v_add_u32 v115, 0xfffe4000, v115
  ds_read_b128 v[88:91], v112 offset:0
  v_lshlrev_b32 v10, 16, v80
  v_and_b32 v11, 0xffff0000, v80
  v_add_f32 v96, v96, v10
  v_add_f32 v97, v97, v11
  v_fmac_f32 v98, v10, v10
  v_fmac_f32 v99, v11, v11
  v_lshlrev_b32 v10, 16, v81
  v_and_b32 v11, 0xffff0000, v81
  v_add_f32 v96, v96, v10
  v_add_f32 v97, v97, v11
  v_fmac_f32 v98, v10, v10
  v_fmac_f32 v99, v11, v11
  v_lshlrev_b32 v10, 16, v82
  v_and_b32 v11, 0xffff0000, v82
  v_add_f32 v96, v96, v10
  v_add_f32 v97, v97, v11
  v_fmac_f32 v98, v10, v10
  v_fmac_f32 v99, v11, v11
  v_lshlrev_b32 v10, 16, v83
  v_and_b32 v11, 0xffff0000, v83
  v_add_f32 v96, v96, v10
  v_add_f32 v97, v97, v11
  v_fmac_f32 v98, v10, v10
  v_fmac_f32 v99, v11, v11
  s_waitcnt lgkmcnt(1)
  ds_read_b128 v[80:83], v113 offset:0
  v_lshlrev_b32 v10, 16, v84
  v_and_b32 v11, 0xffff0000, v84
  v_add_f32 v96, v96, v10
  v_add_f32 v97, v97, v11
  v_fmac_f32 v98, v10, v10
  v_fmac_f32 v99, v11, v11
  v_lshlrev_b32 v10, 16, v85
  v_and_b32 v11, 0xffff0000, v85
  v_add_f32 v96, v96, v10
  v_add_f32 v97, v97, v11
  v_fmac_f32 v98, v10, v10
  v_fmac_f32 v99, v11, v11
  v_lshlrev_b32 v10, 16, v86
  v_and_b32 v11, 0xffff0000, v86
  v_add_f32 v96, v96, v10
  v_add_f32 v97, v97, v11
  v_fmac_f32 v98, v10, v10
  v_fmac_f32 v99, v11, v11
  v_lshlrev_b32 v10, 16, v87
  v_and_b32 v11, 0xffff0000, v87
  v_add_f32 v96, v96, v10
  v_add_f32 v97, v97, v11
  v_fmac_f32 v98, v10, v10
  v_fmac_f32 v99, v11, v11
  s_waitcnt lgkmcnt(1)
  ds_read_b128 v[84:87], v114 offset:0
  v_lshlrev_b32 v10, 16, v88
  v_and_b32 v11, 0xffff0000, v88
  v_add_f32 v96, v96, v10
  v_add_f32 v97, v97, v11
  v_fmac_f32 v98, v10, v10
  v_fmac_f32 v99, v11, v11
  v_lshlrev_b32 v10, 16, v89
  v_and_b32 v11, 0xffff0000, v89
  v_add_f32 v96, v96, v10
  v_add_f32 v97, v97, v11
  v_fmac_f32 v98, v10, v10
  v_fmac_f32 v99, v11, v11
  v_lshlrev_b32 v10, 16, v90
  v_and_b32 v11, 0xffff0000, v90
  v_add_f32 v96, v96, v10
  v_add_f32 v97, v97, v11
  v_fmac_f32 v98, v10, v10
  v_fmac_f32 v99, v11, v11
  v_lshlrev_b32 v10, 16, v91
  v_and_b32 v11, 0xffff0000, v91
  v_add_f32 v96, v96, v10
  v_add_f32 v97, v97, v11
  v_fmac_f32 v98, v10, v10
  v_fmac_f32 v99, v11, v11
  s_waitcnt lgkmcnt(1)
  ds_read_b128 v[88:91], v115 offset:0
  v_lshlrev_b32 v10, 16, v80
  v_and_b32 v11, 0xffff0000, v80
  v_add_f32 v96, v96, v10
  v_add_f32 v97, v97, v11
  v_fmac_f32 v98, v10, v10
  v_fmac_f32 v99, v11, v11
  v_lshlrev_b32 v10, 16, v81
  v_and_b32 v11, 0xffff0000, v81
  v_add_f32 v96, v96, v10
  v_add_f32 v97, v97, v11
  v_fmac_f32 v98, v10, v10
  v_fmac_f32 v99, v11, v11
  v_lshlrev_b32 v10, 16, v82
  v_and_b32 v11, 0xffff0000, v82
  v_add_f32 v96, v96, v10
  v_add_f32 v97, v97, v11
  v_fmac_f32 v98, v10, v10
  v_fmac_f32 v99, v11, v11
  v_lshlrev_b32 v10, 16, v83
  v_and_b32 v11, 0xffff0000, v83
  v_add_f32 v96, v96, v10
  v_add_f32 v97, v97, v11
  v_fmac_f32 v98, v10, v10
  v_fmac_f32 v99, v11, v11
  s_waitcnt lgkmcnt(1)
  s_barrier
  ds_read_b128 v[80:83], v112 offset:28672
  v_lshlrev_b32 v10, 16, v84
  v_and_b32 v11, 0xffff0000, v84
  v_add_f32 v96, v96, v10
  v_add_f32 v97, v97, v11
  v_fmac_f32 v98, v10, v10
  v_fmac_f32 v99, v11, v11
  v_lshlrev_b32 v10, 16, v85
  v_and_b32 v11, 0xffff0000, v85
  v_add_f32 v96, v96, v10
  v_add_f32 v97, v97, v11
  v_fmac_f32 v98, v10, v10
  v_fmac_f32 v99, v11, v11
  v_lshlrev_b32 v10, 16, v86
  v_and_b32 v11, 0xffff0000, v86
  v_add_f32 v96, v96, v10
  v_add_f32 v97, v97, v11
  v_fmac_f32 v98, v10, v10
  v_fmac_f32 v99, v11, v11
  v_lshlrev_b32 v10, 16, v87
  v_and_b32 v11, 0xffff0000, v87
  v_add_f32 v96, v96, v10
  v_add_f32 v97, v97, v11
  v_fmac_f32 v98, v10, v10
  v_fmac_f32 v99, v11, v11
  s_waitcnt lgkmcnt(1)
  ds_read_b128 v[84:87], v113 offset:28672
  v_lshlrev_b32 v10, 16, v88
  v_and_b32 v11, 0xffff0000, v88
  v_add_f32 v96, v96, v10
  v_add_f32 v97, v97, v11
  v_fmac_f32 v98, v10, v10
  v_fmac_f32 v99, v11, v11
  v_lshlrev_b32 v10, 16, v89
  v_and_b32 v11, 0xffff0000, v89
  v_add_f32 v96, v96, v10
  v_add_f32 v97, v97, v11
  v_fmac_f32 v98, v10, v10
  v_fmac_f32 v99, v11, v11
  v_lshlrev_b32 v10, 16, v90
  v_and_b32 v11, 0xffff0000, v90
  v_add_f32 v96, v96, v10
  v_add_f32 v97, v97, v11
  v_fmac_f32 v98, v10, v10
  v_fmac_f32 v99, v11, v11
  v_lshlrev_b32 v10, 16, v91
  v_and_b32 v11, 0xffff0000, v91
  v_add_f32 v96, v96, v10
  v_add_f32 v97, v97, v11
  v_fmac_f32 v98, v10, v10
  v_fmac_f32 v99, v11, v11
  s_waitcnt lgkmcnt(1)
  ds_read_b128 v[88:91], v114 offset:28672
  v_lshlrev_b32 v10, 16, v80
  v_and_b32 v11, 0xffff0000, v80
  v_add_f32 v96, v96, v10
  v_add_f32 v97, v97, v11
  v_fmac_f32 v98, v10, v10
  v_fmac_f32 v99, v11, v11
  v_lshlrev_b32 v10, 16, v81
  v_and_b32 v11, 0xffff0000, v81
  v_add_f32 v96, v96, v10
  v_add_f32 v97, v97, v11
  v_fmac_f32 v98, v10, v10
  v_fmac_f32 v99, v11, v11
  v_lshlrev_b32 v10, 16, v82
  v_and_b32 v11, 0xffff0000, v82
  v_add_f32 v96, v96, v10
  v_add_f32 v97, v97, v11
  v_fmac_f32 v98, v10, v10
  v_fmac_f32 v99, v11, v11
  v_lshlrev_b32 v10, 16, v83
  v_and_b32 v11, 0xffff0000, v83
  v_add_f32 v96, v96, v10
  v_add_f32 v97, v97, v11
  v_fmac_f32 v98, v10, v10
  v_fmac_f32 v99, v11, v11
  s_waitcnt lgkmcnt(1)
  ds_read_b128 v[80:83], v115 offset:28672
  v_lshlrev_b32 v10, 16, v84
  v_and_b32 v11, 0xffff0000, v84
  v_add_f32 v96, v96, v10
  v_add_f32 v97, v97, v11
  v_fmac_f32 v98, v10, v10
  v_fmac_f32 v99, v11, v11
  v_lshlrev_b32 v10, 16, v85
  v_and_b32 v11, 0xffff0000, v85
  v_add_f32 v96, v96, v10
  v_add_f32 v97, v97, v11
  v_fmac_f32 v98, v10, v10
  v_fmac_f32 v99, v11, v11
  v_lshlrev_b32 v10, 16, v86
  v_and_b32 v11, 0xffff0000, v86
  v_add_f32 v96, v96, v10
  v_add_f32 v97, v97, v11
  v_fmac_f32 v98, v10, v10
  v_fmac_f32 v99, v11, v11
  v_lshlrev_b32 v10, 16, v87
  v_and_b32 v11, 0xffff0000, v87
  v_add_f32 v96, v96, v10
  v_add_f32 v97, v97, v11
  v_fmac_f32 v98, v10, v10
  v_fmac_f32 v99, v11, v11
  s_waitcnt lgkmcnt(1)
  s_barrier
  v_add_u32 v112, 0xe000, v112
  v_add_u32 v113, 0xe000, v113
  v_add_u32 v114, 0xe000, v114
  v_add_u32 v115, 0xe000, v115
  ds_read_b128 v[84:87], v112 offset:0
  v_lshlrev_b32 v10, 16, v88
  v_and_b32 v11, 0xffff0000, v88
  v_add_f32 v96, v96, v10
  v_add_f32 v97, v97, v11
  v_fmac_f32 v98, v10, v10
  v_fmac_f32 v99, v11, v11
  v_lshlrev_b32 v10, 16, v89
  v_and_b32 v11, 0xffff0000, v89
  v_add_f32 v96, v96, v10
  v_add_f32 v97, v97, v11
  v_fmac_f32 v98, v10, v10
  v_fmac_f32 v99, v11, v11
  v_lshlrev_b32 v10, 16, v90
  v_and_b32 v11, 0xffff0000, v90
  v_add_f32 v96, v96, v10
  v_add_f32 v97, v97, v11
  v_fmac_f32 v98, v10, v10
  v_fmac_f32 v99, v11, v11
  v_lshlrev_b32 v10, 16, v91
  v_and_b32 v11, 0xffff0000, v91
  v_add_f32 v96, v96, v10
  v_add_f32 v97, v97, v11
  v_fmac_f32 v98, v10, v10
  v_fmac_f32 v99, v11, v11
  s_waitcnt lgkmcnt(1)
  ds_read_b128 v[88:91], v113 offset:0
  v_lshlrev_b32 v10, 16, v80
  v_and_b32 v11, 0xffff0000, v80
  v_add_f32 v96, v96, v10
  v_add_f32 v97, v97, v11
  v_fmac_f32 v98, v10, v10
  v_fmac_f32 v99, v11, v11
  v_lshlrev_b32 v10, 16, v81
  v_and_b32 v11, 0xffff0000, v81
  v_add_f32 v96, v96, v10
  v_add_f32 v97, v97, v11
  v_fmac_f32 v98, v10, v10
  v_fmac_f32 v99, v11, v11
  v_lshlrev_b32 v10, 16, v82
  v_and_b32 v11, 0xffff0000, v82
  v_add_f32 v96, v96, v10
  v_add_f32 v97, v97, v11
  v_fmac_f32 v98, v10, v10
  v_fmac_f32 v99, v11, v11
  v_lshlrev_b32 v10, 16, v83
  v_and_b32 v11, 0xffff0000, v83
  v_add_f32 v96, v96, v10
  v_add_f32 v97, v97, v11
  v_fmac_f32 v98, v10, v10
  v_fmac_f32 v99, v11, v11
  s_waitcnt lgkmcnt(1)
  ds_read_b128 v[80:83], v114 offset:0
  v_lshlrev_b32 v10, 16, v84
  v_and_b32 v11, 0xffff0000, v84
  v_add_f32 v96, v96, v10
  v_add_f32 v97, v97, v11
  v_fmac_f32 v98, v10, v10
  v_fmac_f32 v99, v11, v11
  v_lshlrev_b32 v10, 16, v85
  v_and_b32 v11, 0xffff0000, v85
  v_add_f32 v96, v96, v10
  v_add_f32 v97, v97, v11
  v_fmac_f32 v98, v10, v10
  v_fmac_f32 v99, v11, v11
  v_lshlrev_b32 v10, 16, v86
  v_and_b32 v11, 0xffff0000, v86
  v_add_f32 v96, v96, v10
  v_add_f32 v97, v97, v11
  v_fmac_f32 v98, v10, v10
  v_fmac_f32 v99, v11, v11
  v_lshlrev_b32 v10, 16, v87
  v_and_b32 v11, 0xffff0000, v87
  v_add_f32 v96, v96, v10
  v_add_f32 v97, v97, v11
  v_fmac_f32 v98, v10, v10
  v_fmac_f32 v99, v11, v11
  s_waitcnt lgkmcnt(1)
  ds_read_b128 v[84:87], v115 offset:0
  v_lshlrev_b32 v10, 16, v88
  v_and_b32 v11, 0xffff0000, v88
  v_add_f32 v96, v96, v10
  v_add_f32 v97, v97, v11
  v_fmac_f32 v98, v10, v10
  v_fmac_f32 v99, v11, v11
  v_lshlrev_b32 v10, 16, v89
  v_and_b32 v11, 0xffff0000, v89
  v_add_f32 v96, v96, v10
  v_add_f32 v97, v97, v11
  v_fmac_f32 v98, v10, v10
  v_fmac_f32 v99, v11, v11
  v_lshlrev_b32 v10, 16, v90
  v_and_b32 v11, 0xffff0000, v90
  v_add_f32 v96, v96, v10
  v_add_f32 v97, v97, v11
  v_fmac_f32 v98, v10, v10
  v_fmac_f32 v99, v11, v11
  v_lshlrev_b32 v10, 16, v91
  v_and_b32 v11, 0xffff0000, v91
  v_add_f32 v96, v96, v10
  v_add_f32 v97, v97, v11
  v_fmac_f32 v98, v10, v10
  v_fmac_f32 v99, v11, v11
  s_waitcnt lgkmcnt(1)
  v_lshlrev_b32 v10, 16, v80
  v_and_b32 v11, 0xffff0000, v80
  v_add_f32 v96, v96, v10
  v_add_f32 v97, v97, v11
  v_fmac_f32 v98, v10, v10
  v_fmac_f32 v99, v11, v11
  v_lshlrev_b32 v10, 16, v81
  v_and_b32 v11, 0xffff0000, v81
  v_add_f32 v96, v96, v10
  v_add_f32 v97, v97, v11
  v_fmac_f32 v98, v10, v10
  v_fmac_f32 v99, v11, v11
  v_lshlrev_b32 v10, 16, v82
  v_and_b32 v11, 0xffff0000, v82
  v_add_f32 v96, v96, v10
  v_add_f32 v97, v97, v11
  v_fmac_f32 v98, v10, v10
  v_fmac_f32 v99, v11, v11
  v_lshlrev_b32 v10, 16, v83
  v_and_b32 v11, 0xffff0000, v83
  v_add_f32 v96, v96, v10
  v_add_f32 v97, v97, v11
  v_fmac_f32 v98, v10, v10
  v_fmac_f32 v99, v11, v11
  s_waitcnt lgkmcnt(0)
  v_lshlrev_b32 v10, 16, v84
  v_and_b32 v11, 0xffff0000, v84
  v_add_f32 v96, v96, v10
  v_add_f32 v97, v97, v11
  v_fmac_f32 v98, v10, v10
  v_fmac_f32 v99, v11, v11
  v_lshlrev_b32 v10, 16, v85
  v_and_b32 v11, 0xffff0000, v85
  v_add_f32 v96, v96, v10
  v_add_f32 v97, v97, v11
  v_fmac_f32 v98, v10, v10
  v_fmac_f32 v99, v11, v11
  v_lshlrev_b32 v10, 16, v86
  v_and_b32 v11, 0xffff0000, v86
  v_add_f32 v96, v96, v10
  v_add_f32 v97, v97, v11
  v_fmac_f32 v98, v10, v10
  v_fmac_f32 v99, v11, v11
  v_lshlrev_b32 v10, 16, v87
  v_and_b32 v11, 0xffff0000, v87
  v_add_f32 v96, v96, v10
  v_add_f32 v97, v97, v11
  v_fmac_f32 v98, v10, v10
  v_fmac_f32 v99, v11, v11
  v_add_f32 v96, v96, v97
  v_add_f32 v98, v98, v99
  v_mov_b32 v97, v96
  v_mov_b32 v99, v98
  s_nop 0
  v_permlane32_swap_b32 v96, v97
  v_permlane32_swap_b32 v98, v99
  v_add_f32 v96, v96, v97
  v_add_f32 v98, v98, v99
  v_mul_f32 v96, 0x3b000000, v96
  v_mul_f32 v98, 0x3b000000, v98
  v_fma_f32 v98, -v96, v96, v98
  v_add_f32 v98, 0x3727c5ac, v98
  v_rsq_f32 v98, v98
  s_lshl_b32 s27, s25, 8
  s_add_u32 s27, s27, 143872
  v_lshl_add_u32 v2, v5, 2, s27
  ds_write_b32 v2, v96
  ds_write_b32 v2, v98 offset:128
  s_waitcnt lgkmcnt(0)
  s_barrier
  s_cmp_lg_u32 s23, 0
  s_cbranch_scc1 qkv1_kernel_end
  v_subrev_u32 v9, 256, v0
  v_cmp_gt_u32 vcc, 96, v9
  s_nop 0
  s_and_saveexec_b64 s[28:29], vcc
  s_cbranch_execz qkv1_kernel_end
  v_lshlrev_b32 v14, 2, v9
  v_add_u32 v15, 143360, v14
  ds_read_b32 v15, v15
  v_lshrrev_b32 v14, 5, v9
  v_lshlrev_b32 v14, 11, v14
  v_and_b32 v3, 31, v9
  v_lshl_add_u32 v14, v3, 2, v14
  s_lshl_b32 s46, s24, 7
  s_add_u32 s46, s46, 0x1618000
  s_waitcnt lgkmcnt(0)
  s_mov_b32 s16, s20
  s_and_b32 s17, s21, 0xffff
  s_mov_b32 s18, 0x10000000
  s_mov_b32 s19, 0x20000
  buffer_store_dword v15, v14, s[16:19], s46 offen sc1
  s_endpgm
qkv1_kernel_loader:
  s_sub_u32 s22, s22, 8
  v_lshrrev_b32 v3, 3, v1
  v_and_b32 v4, 7, v1
  s_lshl_b32 s30, s23, 7
  s_lshl_b32 s31, s22, 5
  s_add_u32 s30, s30, s31
  v_add_u32 v5, 0, v3
  v_bfe_u32 v6, v5, 1, 3
  v_xor_b32 v6, v6, v4
  v_add_u32 v5, s30, v5
  v_lshlrev_b32 v5, 10, v5
  v_lshl_add_u32 v5, v6, 4, v5
  v_subrev_u32 v16, 0, v5
  v_add_u32 v5, 8, v3
  v_bfe_u32 v6, v5, 1, 3
  v_xor_b32 v6, v6, v4
  v_add_u32 v5, s30, v5
  v_lshlrev_b32 v5, 10, v5
  v_lshl_add_u32 v5, v6, 4, v5
  v_subrev_u32 v17, 1024, v5
  v_add_u32 v5, 16, v3
  v_bfe_u32 v6, v5, 1, 3
  v_xor_b32 v6, v6, v4
  v_add_u32 v5, s30, v5
  v_lshlrev_b32 v5, 10, v5
  v_lshl_add_u32 v5, v6, 4, v5
  v_subrev_u32 v18, 2048, v5
  v_add_u32 v5, 24, v3
  v_bfe_u32 v6, v5, 1, 3
  v_xor_b32 v6, v6, v4
  v_add_u32 v5, s30, v5
  v_lshlrev_b32 v5, 10, v5
  v_lshl_add_u32 v5, v6, 4, v5
  v_subrev_u32 v19, 3072, v5
  s_lshl_b32 s30, s24, 6
  s_mul_i32 s31, s22, 49152
  s_add_u32 s30, s30, s31
  v_and_b32 v7, 3, v1
  v_lshlrev_b32 v7, 4, v7
  v_lshrrev_b32 v8, 2, v1
  v_add_u32 v5, 0, v8
  v_mul_u32_u24 v6, 171, v5
  v_lshrrev_b32 v6, 9, v6
  v_mul_u32_u24 v9, 3, v6
  v_sub_u32 v9, v5, v9
  v_mul_u32_u24 v6, 3072, v6
  v_lshl_add_u32 v6, v9, 10, v6
  v_add3_u32 v6, v6, v7, s30
  v_subrev_u32 v20, 0, v6
  v_add_u32 v5, 16, v8
  v_mul_u32_u24 v6, 171, v5
  v_lshrrev_b32 v6, 9, v6
  v_mul_u32_u24 v9, 3, v6
  v_sub_u32 v9, v5, v9
  v_mul_u32_u24 v6, 3072, v6
  v_lshl_add_u32 v6, v9, 10, v6
  v_add3_u32 v6, v6, v7, s30
  v_subrev_u32 v21, 1024, v6
  v_add_u32 v5, 32, v8
  v_mul_u32_u24 v6, 171, v5
  v_lshrrev_b32 v6, 9, v6
  v_mul_u32_u24 v9, 3, v6
  v_sub_u32 v9, v5, v9
  v_mul_u32_u24 v6, 3072, v6
  v_lshl_add_u32 v6, v9, 10, v6
  v_add3_u32 v6, v6, v7, s30
  v_subrev_u32 v22, 2048, v6
  s_lshl_b32 s25, s22, 12
  s_mul_i32 s26, s22, 3072
  s_add_u32 s26, s26, 16384
  s_waitcnt lgkmcnt(0)
  s_mov_b32 s8, s4
  s_and_b32 s9, s5, 0xffff
  s_mov_b32 s10, 0x200000
  s_mov_b32 s11, 0x20000
  s_mov_b32 s12, s6
  s_and_b32 s13, s7, 0xffff
  s_mov_b32 s14, 0x180000
  s_mov_b32 s15, 0x20000
  s_add_u32 m0, s25, 0
  s_mov_b32 s30, 0
  buffer_load_dwordx4 v16, s[8:11], s30 offen offset:0 lds
  buffer_load_dwordx4 v17, s[8:11], s30 offen offset:1024 lds
  buffer_load_dwordx4 v18, s[8:11], s30 offen offset:2048 lds
  buffer_load_dwordx4 v19, s[8:11], s30 offen offset:3072 lds
  s_add_u32 m0, s26, 0
  s_mov_b32 s31, 0
  buffer_load_dwordx4 v20, s[12:15], s31 offen offset:0 lds
  buffer_load_dwordx4 v21, s[12:15], s31 offen offset:1024 lds
  buffer_load_dwordx4 v22, s[12:15], s31 offen offset:2048 lds
  s_add_u32 m0, s25, 28672
  s_mov_b32 s30, 128
  buffer_load_dwordx4 v16, s[8:11], s30 offen offset:0 lds
  buffer_load_dwordx4 v17, s[8:11], s30 offen offset:1024 lds
  buffer_load_dwordx4 v18, s[8:11], s30 offen offset:2048 lds
  buffer_load_dwordx4 v19, s[8:11], s30 offen offset:3072 lds
  s_add_u32 m0, s26, 28672
  s_mov_b32 s31, 196608
  buffer_load_dwordx4 v20, s[12:15], s31 offen offset:0 lds
  buffer_load_dwordx4 v21, s[12:15], s31 offen offset:1024 lds
  buffer_load_dwordx4 v22, s[12:15], s31 offen offset:2048 lds
  s_lshl_b32 s29, s28, 2
  s_add_u32 s29, s29, s22
  v_mul_u32_u24 v2, 43, v1
  v_lshrrev_b32 v2, 8, v2
  v_mul_u32_u24 v3, 6, v2
  v_sub_u32 v3, v1, v3
  s_mul_i32 s30, s29, 6
  v_add_u32 v3, s30, v3
  v_mul_u32_u24 v4, 43691, v3
  v_lshrrev_b32 v4, 19, v4
  v_mul_u32_u24 v5, 12, v4
  v_sub_u32 v5, v3, v5
  v_lshrrev_b32 v7, 2, v5
  v_and_b32 v5, 3, v5
  v_mul_u32_u24 v4, 3072, v4
  v_lshl_add_u32 v4, v7, 10, v4
  v_lshl_add_u32 v4, v5, 7, v4
  s_and_b32 s30, s27, 1
  s_lshl_b32 s30, s30, 9
  v_add_u32 v4, s30, v4
  s_mov_b32 s30, 196608
  v_mul_lo_u32 v2, v2, s30
  v_add_u32 v4, v4, v2
  v_and_b32 v5, 3, v1
  v_lshrrev_b32 v7, 2, v1
  s_lshr_b32 s30, s27, 1
  s_lshl_b32 s30, s30, 9
  s_lshl_b32 s31, s29, 2
  s_add_u32 s30, s30, s31
  v_add_u32 v5, s30, v5
  v_lshlrev_b32 v5, 10, v5
  v_lshl_add_u32 v5, v7, 7, v5
  v_mov_b32 v51, v4
  v_mov_b32 v52, v5
  s_mov_b32 exec_lo, 0xffffc0
  s_mov_b32 exec_hi, 0
  buffer_load_dword v48, v51, s[12:15], 0 offen
  s_mov_b32 exec_lo, 0xfff0
  buffer_load_dword v49, v52, s[8:11], 0 offen
  s_mov_b64 exec, -1
  s_getpc_b64 s[44:45]
qkv1_kernel_pc:
  s_and_b32 s45, s45, 0xffff
  s_mov_b32 s46, (all_code_end-qkv1_kernel_pc)
  s_mov_b32 s47, 0x20000
  s_lshl_b32 s48, s29, 9
  v_lshlrev_b32 v6, 7, v1
  s_mov_b32 exec_lo, 0xf
  s_mov_b32 exec_hi, 0
  buffer_load_dword v50, v6, s[44:47], s48 offen
  s_mov_b64 exec, -1
  s_mov_b32 s16, s20
  s_and_b32 s17, s21, 0xffff
  s_mov_b32 s18, 0x10000000
  s_mov_b32 s19, 0x20000
  s_waitcnt vmcnt(10)
  s_barrier
  s_add_u32 m0, s25, 57344
  s_mov_b32 s30, 256
  buffer_load_dwordx4 v16, s[8:11], s30 offen offset:0 lds
  buffer_load_dwordx4 v17, s[8:11], s30 offen offset:1024 lds
  buffer_load_dwordx4 v18, s[8:11], s30 offen offset:2048 lds
  buffer_load_dwordx4 v19, s[8:11], s30 offen offset:3072 lds
  s_add_u32 m0, s26, 57344
  s_mov_b32 s31, 393216
  buffer_load_dwordx4 v20, s[12:15], s31 offen offset:0 lds
  buffer_load_dwordx4 v21, s[12:15], s31 offen offset:1024 lds
  buffer_load_dwordx4 v22, s[12:15], s31 offen offset:2048 lds
  s_add_u32 m0, s25, 86016
  s_mov_b32 s30, 384
  buffer_load_dwordx4 v16, s[8:11], s30 offen offset:0 lds
  buffer_load_dwordx4 v17, s[8:11], s30 offen offset:1024 lds
  buffer_load_dwordx4 v18, s[8:11], s30 offen offset:2048 lds
  buffer_load_dwordx4 v19, s[8:11], s30 offen offset:3072 lds
  s_add_u32 m0, s26, 86016
  s_mov_b32 s31, 589824
  buffer_load_dwordx4 v20, s[12:15], s31 offen offset:0 lds
  buffer_load_dwordx4 v21, s[12:15], s31 offen offset:1024 lds
  buffer_load_dwordx4 v22, s[12:15], s31 offen offset:2048 lds
  s_mov_b32 exec_lo, 0xff000000
  s_mov_b32 exec_hi, 0xffff
  buffer_load_dword v53, v51, s[12:15], 0 offen
  s_mov_b32 exec_lo, 0xffff0000
  s_mov_b32 exec_hi, 0
  buffer_load_dword v54, v52, s[8:11], 0 offen
  s_mov_b64 exec, -1
  s_waitcnt vmcnt(19)
  s_barrier
  s_add_u32 m0, s25, 114688
  s_mov_b32 s30, 512
  buffer_load_dwordx4 v16, s[8:11], s30 offen offset:0 lds
  buffer_load_dwordx4 v17, s[8:11], s30 offen offset:1024 lds
  buffer_load_dwordx4 v18, s[8:11], s30 offen offset:2048 lds
  buffer_load_dwordx4 v19, s[8:11], s30 offen offset:3072 lds
  s_add_u32 m0, s26, 114688
  s_mov_b32 s31, 786432
  buffer_load_dwordx4 v20, s[12:15], s31 offen offset:0 lds
  buffer_load_dwordx4 v21, s[12:15], s31 offen offset:1024 lds
  buffer_load_dwordx4 v22, s[12:15], s31 offen offset:2048 lds
  s_waitcnt vmcnt(16)
  s_barrier
  s_add_u32 m0, s25, 0
  s_mov_b32 s30, 640
  buffer_load_dwordx4 v16, s[8:11], s30 offen offset:0 lds
  buffer_load_dwordx4 v17, s[8:11], s30 offen offset:1024 lds
  buffer_load_dwordx4 v18, s[8:11], s30 offen offset:2048 lds
  buffer_load_dwordx4 v19, s[8:11], s30 offen offset:3072 lds
  s_add_u32 m0, s26, 0
  s_mov_b32 s31, 983040
  buffer_load_dwordx4 v20, s[12:15], s31 offen offset:0 lds
  buffer_load_dwordx4 v21, s[12:15], s31 offen offset:1024 lds
  buffer_load_dwordx4 v22, s[12:15], s31 offen offset:2048 lds
  s_waitcnt vmcnt(16)
  s_barrier
  s_add_u32 m0, s25, 28672
  s_mov_b32 s30, 768
  buffer_load_dwordx4 v16, s[8:11], s30 offen offset:0 lds
  buffer_load_dwordx4 v17, s[8:11], s30 offen offset:1024 lds
  buffer_load_dwordx4 v18, s[8:11], s30 offen offset:2048 lds
  buffer_load_dwordx4 v19, s[8:11], s30 offen offset:3072 lds
  s_add_u32 m0, s26, 28672
  s_mov_b32 s31, 1179648
  buffer_load_dwordx4 v20, s[12:15], s31 offen offset:0 lds
  buffer_load_dwordx4 v21, s[12:15], s31 offen offset:1024 lds
  buffer_load_dwordx4 v22, s[12:15], s31 offen offset:2048 lds
  s_waitcnt vmcnt(14)
  s_barrier
  s_add_u32 m0, s25, 57344
  s_mov_b32 s30, 896
  buffer_load_dwordx4 v16, s[8:11], s30 offen offset:0 lds
  buffer_load_dwordx4 v17, s[8:11], s30 offen offset:1024 lds
  buffer_load_dwordx4 v18, s[8:11], s30 offen offset:2048 lds
  buffer_load_dwordx4 v19, s[8:11], s30 offen offset:3072 lds
  s_add_u32 m0, s26, 57344
  s_mov_b32 s31, 1376256
  buffer_load_dwordx4 v20, s[12:15], s31 offen offset:0 lds
  buffer_load_dwordx4 v21, s[12:15], s31 offen offset:1024 lds
  buffer_load_dwordx4 v22, s[12:15], s31 offen offset:2048 lds
  s_waitcnt vmcnt(14)
  s_barrier
  v_and_b32 v5, 31, v1
  v_lshrrev_b32 v6, 5, v1
  s_lshl_b32 s46, s23, 7
  s_lshl_b32 s47, s22, 5
  s_add_u32 s46, s46, s47
  v_add_u32 v7, s46, v5
  v_lshlrev_b32 v7, 10, v7
  v_lshl_add_u32 v7, v6, 4, v7
  s_lshl_b32 s47, s24, 6
  buffer_load_dwordx4 v[24:27], v7, s[8:11], s47 offen
  buffer_load_dwordx4 v[28:31], v7, s[8:11], s47 offen offset:32
  s_load_dwordx2 s[30:31], s[0:1], 16
  s_load_dwordx4 s[32:35], s[0:1], 40
  s_load_dwordx2 s[36:37], s[0:1], 56
  s_load_dwordx2 s[38:39], s[0:1], 32
  s_waitcnt lgkmcnt(0)
  s_mov_b32 s40, s30
  s_and_b32 s41, s31, 0xffff
  s_mov_b32 s42, 0x80000
  s_mov_b32 s43, 0x20000
  s_mov_b32 s44, s32
  s_and_b32 s45, s33, 0xffff
  s_mov_b32 s46, 0x1c0000
  s_mov_b32 s47, 0x20000
  s_mov_b32 s48, s34
  s_and_b32 s49, s35, 0xffff
  s_mov_b32 s50, 0x1c0000
  s_mov_b32 s51, 0x20000
  s_mov_b32 s56, s36
  s_and_b32 s57, s37, 0xffff
  s_mov_b32 s58, 0x1c0000
  s_mov_b32 s59, 0x20000
  s_and_b32 s60, s2, 7
  s_lshl_b32 s30, s29, 12
  v_lshl_add_u32 v2, v1, 7, s30
  v_mul_u32_u24 v3, 205, v1
  v_lshrrev_b32 v3, 10, v3
  v_mul_u32_u24 v4, 5, v3
  v_sub_u32 v4, v1, v4
  s_lshl_b32 s30, s29, 2
  v_add_u32 v3, s30, v3
  s_movk_i32 s30, 3584
  v_mul_lo_u32 v3, v3, s30
  s_mul_i32 s30, s60, 448
  s_and_b32 s30, s30, 0xffffff80
  v_lshl_add_u32 v3, v4, 7, v3
  v_add_u32 v3, s30, v3
  s_mul_i32 s30, s60, 229376
  s_mul_i32 s31, s29, 1792
  s_add_u32 s30, s30, s31
  v_lshlrev_b32 v4, 7, v1
  s_mov_b32 exec_lo, -1
  s_mov_b32 exec_hi, 0
  buffer_load_dword v44, v2, s[40:43], 0 offen
  s_mov_b32 exec_lo, 0xfffff
  buffer_load_dword v45, v3, s[44:47], 0 offen
  buffer_load_dword v46, v3, s[48:51], 0 offen
  s_mov_b32 exec_lo, 0x3fff
  buffer_load_dword v47, v4, s[56:59], s30 offen
  s_mov_b64 exec, -1
  s_waitcnt vmcnt(13)
  s_barrier
  s_waitcnt vmcnt(6)
  s_barrier
  s_barrier
  s_lshl_b32 s30, s23, 2
  s_add_u32 s30, s30, s22
  s_lshl_b32 s30, s30, 5
  s_lshl_b32 s31, s24, 1
  s_add_u32 s30, s30, s31
  s_lshl_b32 s30, s30, 10
  s_add_u32 s30, s30, 0x1000000
  v_lshlrev_b32 v8, 4, v1
  s_waitcnt vmcnt(4)
  buffer_store_dwordx4 v[24:27], v8, s[16:19], s30 offen sc1
  buffer_store_dwordx4 v[28:31], v8, s[16:19], s30 offen offset:1024 sc1
  s_cmp_eq_u32 s22, 1
  s_cbranch_scc1 qkv1_kernel_sw
  s_cmp_lg_u32 s22, 0
  s_cbranch_scc1 qkv1_kernel_end
  v_mov_b32 v32, 0
  v_mov_b32 v33, 0
  v_mov_b32 v34, 0
  v_mov_b32 v35, 0
  s_mul_i32 s27, s2, 352
  s_add_u32 s27, s27, 0x1600000
  s_mov_b32 exec_lo, 0x3fffff
  s_mov_b32 exec_hi, 0
  buffer_store_dwordx4 v[32:35], v8, s[16:19], s27 offen sc1
  s_endpgm
qkv1_kernel_sw:
  s_cmp_lg_u32 s2, 0
  s_cbranch_scc1 qkv1_kernel_end
  s_mov_b32 s40, s38
  s_and_b32 s41, s39, 0xffff
  s_mov_b32 s42, 0x400
  s_mov_b32 s43, 0x20000
  buffer_load_dwordx4 v[32:35], v8, s[40:43], 0 offen
  s_waitcnt vmcnt(0)
  v_lshlrev_b32 v36, 16, v32
  v_and_b32 v37, 0xffff0000, v32
  v_lshlrev_b32 v38, 16, v33
  v_and_b32 v39, 0xffff0000, v33
  v_lshlrev_b32 v40, 16, v34
  v_and_b32 v41, 0xffff0000, v34
  v_lshlrev_b32 v42, 16, v35
  v_and_b32 v43, 0xffff0000, v35
  v_add_f32 v36, v36, v37
  v_add_f32 v38, v38, v39
  v_add_f32 v40, v40, v41
  v_add_f32 v42, v42, v43
  v_add_f32 v36, v36, v38
  v_add_f32 v40, v40, v42
  v_add_f32 v36, v36, v40
  s_nop 1
  v_add_f32_dpp v36, v36, v36 quad_perm:[1,0,3,2] row_mask:0xf bank_mask:0xf
  s_nop 1
  v_add_f32_dpp v36, v36, v36 quad_perm:[2,3,0,1] row_mask:0xf bank_mask:0xf
  s_nop 1
  v_add_f32_dpp v36, v36, v36 row_half_mirror row_mask:0xf bank_mask:0xf
  s_nop 1
  v_add_f32_dpp v36, v36, v36 row_mirror row_mask:0xf bank_mask:0xf
  v_mov_b32 v37, v36
  s_nop 1
  v_permlane16_swap_b32 v36, v37
  v_add_f32 v36, v36, v37
  v_mov_b32 v37, v36
  s_nop 1
  v_permlane32_swap_b32 v36, v37
  v_add_f32 v36, v36, v37
  v_mov_b32 v37, 0
  s_mov_b32 s27, 0x161a200
  s_mov_b64 exec, 1
  buffer_store_dword v36, v37, s[16:19], s27 offen sc1
qkv1_kernel_end:
  s_endpgm
qkv1_kernel_codeend:
.globl attn1_kernel
.p2align 8
.type attn1_kernel,@function
attn1_kernel:
  s_cmp_ge_u32 s2, 256
  s_cbranch_scc1 attn1_kernel_end
  s_load_dwordx2 s[20:21], s[0:1], 80
  v_lshrrev_b32 v2, 6, v0
  v_and_b32 v1, 63, v0
  v_readfirstlane_b32 s22, v2
  s_and_b32 s23, s2, 7
  s_lshr_b32 s24, s2, 3
  s_load_dwordx2 s[6:7], s[0:1], 8
  s_load_dwordx2 s[4:5], s[0:1], 16
  s_load_dwordx4 s[32:35], s[0:1], 40
  s_load_dwordx2 s[36:37], s[0:1], 56
  v_lshrrev_b32 v3, 4, v0
  s_lshl_b32 s25, s23, 3
  v_add_u32 v3, s25, v3
  v_mov_b32 v5, 0x3f803f80
  v_cmp_le_u32 s[26:27], 8, v3
  v_lshlrev_b32 v6, 2, v0
  s_nop 0
  v_cndmask_b32 v5, 0, v5, s[26:27]
  v_cmp_gt_u32 vcc, 256, v0
  s_nop 0
  s_and_saveexec_b64 s[28:29], vcc
  ds_write_b32 v6, v5 offset:32768
  s_mov_b64 exec, s[28:29]
  s_waitcnt lgkmcnt(0)
  s_mov_b32 s16, s20
  s_and_b32 s17, s21, 0xffff
  s_mov_b32 s18, 0x10000000
  s_mov_b32 s19, 0x20000
  s_lshl_b32 s25, s24, 16
  s_add_u32 s8, s20, s25
  s_addc_u32 s9, s21, 0
  s_add_u32 s12, s8, 0x400000
  s_addc_u32 s13, s9, 0
  s_add_u32 s8, s8, 0x200000
  s_addc_u32 s9, s9, 0
  s_and_b32 s9, s9, 0xffff
  s_and_b32 s13, s13, 0xffff
  s_mov_b32 s10, 0x10000
  s_mov_b32 s11, 0x20000
  s_mov_b32 s14, 0x10000
  s_mov_b32 s15, 0x20000
  s_lshl_b32 s25, s23, 3
  s_add_u32 s25, s25, s22
  s_lshl_b32 s26, s25, 10
  s_sub_u32 s25, s25, 8
  s_lshl_b32 s25, s25, 10
  s_cmp_lt_i32 s25, 0
  s_cselect_b32 s25, 0x40000000, s25
  v_lshl_add_u32 v3, v1, 4, s25
  v_lshl_add_u32 v2, v1, 4, s26
  s_lshl_b32 s27, s22, 10
  s_add_u32 m0, s27, 0
  s_nop 0
  buffer_load_dwordx4 v3, s[8:11], 0 offen lds
  s_add_u32 m0, s27, 16384
  s_nop 0
  buffer_load_dwordx4 v3, s[12:15], 0 offen lds
  s_lshl_b32 s25, s24, 16
  s_add_u32 s25, s25, s26
  s_add_u32 s25, s25, 0x0
  v_lshlrev_b32 v3, 4, v1
  buffer_load_dwordx4 v[4:7], v3, s[16:19], s25 offen
  s_add_u32 m0, s27, 8192
  s_nop 0
  buffer_load_dwordx4 v2, s[8:11], 0 offen lds
  s_add_u32 m0, s27, 24576
  s_nop 0
  buffer_load_dwordx4 v2, s[12:15], 0 offen lds
  v_and_b32 v2, 31, v1
  v_lshrrev_b32 v3, 5, v1
  v_lshlrev_b32 v3, 2, v3
  v_sub_u32 v2, v2, v3
  v_mov_b32 v8, 0xf149f2ca
  v_mov_b32 v9, 0
  v_cmp_gt_i32 s[26:27], 0, v2
  s_nop 1
  v_cndmask_b32 v88, v8, v9, s[26:27]
  v_cndmask_b32 v104, v9, v8, s[26:27]
  v_cmp_gt_i32 s[28:29], 1, v2
  s_nop 1
  v_cndmask_b32 v89, v8, v9, s[28:29]
  v_cndmask_b32 v105, v9, v8, s[28:29]
  v_cmp_gt_i32 s[26:27], 2, v2
  s_nop 1
  v_cndmask_b32 v90, v8, v9, s[26:27]
  v_cndmask_b32 v106, v9, v8, s[26:27]
  v_cmp_gt_i32 s[28:29], 3, v2
  s_nop 1
  v_cndmask_b32 v91, v8, v9, s[28:29]
  v_cndmask_b32 v107, v9, v8, s[28:29]
  v_cmp_gt_i32 s[26:27], 8, v2
  s_nop 1
  v_cndmask_b32 v92, v8, v9, s[26:27]
  v_cndmask_b32 v108, v9, v8, s[26:27]
  v_cmp_gt_i32 s[28:29], 9, v2
  s_nop 1
  v_cndmask_b32 v93, v8, v9, s[28:29]
  v_cndmask_b32 v109, v9, v8, s[28:29]
  v_cmp_gt_i32 s[26:27], 10, v2
  s_nop 1
  v_cndmask_b32 v94, v8, v9, s[26:27]
  v_cndmask_b32 v110, v9, v8, s[26:27]
  v_cmp_gt_i32 s[28:29], 11, v2
  s_nop 1
  v_cndmask_b32 v95, v8, v9, s[28:29]
  v_cndmask_b32 v111, v9, v8, s[28:29]
  v_cmp_gt_i32 s[26:27], 16, v2
  s_nop 1
  v_cndmask_b32 v96, v8, v9, s[26:27]
  v_cndmask_b32 v112, v9, v8, s[26:27]
  v_cmp_gt_i32 s[28:29], 17, v2
  s_nop 1
  v_cndmask_b32 v97, v8, v9, s[28:29]
  v_cndmask_b32 v113, v9, v8, s[28:29]
  v_cmp_gt_i32 s[26:27], 18, v2
  s_nop 1
  v_cndmask_b32 v98, v8, v9, s[26:27]
  v_cndmask_b32 v114, v9, v8, s[26:27]
  v_cmp_gt_i32 s[28:29], 19, v2
  s_nop 1
  v_cndmask_b32 v99, v8, v9, s[28:29]
  v_cndmask_b32 v115, v9, v8, s[28:29]
  v_cmp_gt_i32 s[26:27], 24, v2
  s_nop 1
  v_cndmask_b32 v100, v8, v9, s[26:27]
  v_cndmask_b32 v116, v9, v8, s[26:27]
  v_cmp_gt_i32 s[28:29], 25, v2
  s_nop 1
  v_cndmask_b32 v101, v8, v9, s[28:29]
  v_cndmask_b32 v117, v9, v8, s[28:29]
  v_cmp_gt_i32 s[26:27], 26, v2
  s_nop 1
  v_cndmask_b32 v102, v8, v9, s[26:27]
  v_cndmask_b32 v118, v9, v8, s[26:27]
  v_cmp_gt_i32 s[28:29], 27, v2
  s_nop 1
  v_cndmask_b32 v103, v8, v9, s[28:29]
  v_cndmask_b32 v119, v9, v8, s[28:29]
  s_lshl_b32 s25, s22, 10
  v_lshl_add_u32 v120, v1, 4, s25
  v_bfe_u32 v2, v1, 4, 1
  v_lshrrev_b32 v3, 5, v1
  v_and_b32 v8, 15, v1
  v_lshlrev_b32 v9, 8, v3
  v_lshl_add_u32 v9, v8, 4, v9
  v_add_u32 v9, s25, v9
  v_add_u32 v9, 16384, v9
  s_lshl_b32 s26, s22, 6
  v_lshlrev_b32 v10, 4, v3
  v_add_u32 v10, s26, v10
  v_add_u32 v10, 32768, v10
  v_cmp_eq_u32 s[26:27], 0, v2
  v_mov_b32 v11, 1024
  s_nop 0
  v_cndmask_b32 v121, v10, v9, s[26:27]
  v_cndmask_b32 v122, 64, v11, s[26:27]
  v_mov_b32 v11, 512
  v_cndmask_b32 v123, 32, v11, s[26:27]
  v_add_u32 v123, v123, v121
  s_cmp_lt_u32 s22, 2
  s_cbranch_scc1 attn1_kernel_pa0
  s_waitcnt vmcnt(2)
  s_branch attn1_kernel_pa1
attn1_kernel_pa0:
  s_waitcnt vmcnt(0)
attn1_kernel_pa1:
  s_barrier
  ds_read_b128 v[8:11], v120 offset:0
  ds_read_b128 v[12:15], v120 offset:1024
  ds_read_b128 v[16:19], v121
  ds_read_b128 v[20:23], v123
  v_add_u32 v121, v122, v121
  v_add_u32 v123, v122, v123
  s_waitcnt lgkmcnt(3)
  v_mfma_f32_32x32x16_bf16 v[32:47], v[8:11], v[4:7], v[88:103]
  s_waitcnt lgkmcnt(2)
  v_mfma_f32_32x32x16_bf16 v[48:63], v[12:15], v[4:7], 0
  ds_read_b128 v[8:11], v120 offset:2048
  ds_read_b128 v[24:27], v121
  ds_read_b128 v[28:31], v123
  v_add_u32 v121, v122, v121
  v_add_u32 v123, v122, v123
  s_nop 4
  v_exp_f32 v32, v32
  v_exp_f32 v33, v33
  v_exp_f32 v34, v34
  v_exp_f32 v35, v35
  v_exp_f32 v36, v36
  v_exp_f32 v37, v37
  v_exp_f32 v38, v38
  v_exp_f32 v39, v39
  v_exp_f32 v40, v40
  v_exp_f32 v41, v41
  v_exp_f32 v42, v42
  v_exp_f32 v43, v43
  v_exp_f32 v44, v44
  v_exp_f32 v45, v45
  v_exp_f32 v46, v46
  v_exp_f32 v47, v47
  v_cvt_pk_bf16_f32 v64, v32, v33
  v_cvt_pk_bf16_f32 v65, v34, v35
  v_cvt_pk_bf16_f32 v66, v36, v37
  v_cvt_pk_bf16_f32 v67, v38, v39
  v_cvt_pk_bf16_f32 v68, v40, v41
  v_cvt_pk_bf16_f32 v69, v42, v43
  v_cvt_pk_bf16_f32 v70, v44, v45
  v_cvt_pk_bf16_f32 v71, v46, v47
  s_waitcnt lgkmcnt(3)
  v_mfma_f32_32x32x16_bf16 v[72:87], v[16:19], v[64:67], 0
  v_mfma_f32_32x32x16_bf16 v[72:87], v[20:23], v[68:71], v[72:87]
  s_waitcnt vmcnt(0)
  s_barrier
  s_cmp_lg_u32 s22, 7
  s_cbranch_scc1 attn1_kernel_noct
  s_mov_b32 s31, s24
  s_getpc_b64 s[76:77]
attn1_kernel_pc0:
  s_add_u32 s76, s76, (attn1_kernel_codeend-attn1_kernel_pc0)
  s_addc_u32 s77, s77, 0
  s_and_b32 s77, s77, 0xffff
  s_mov_b32 s78, (all_code_end-attn1_kernel_codeend)
  s_mov_b32 s79, 0x20000
  s_mul_i32 s31, s31, 1536
  v_lshlrev_b32 v2, 7, v1
  s_mov_b32 exec_lo, 0xfff
  s_mov_b32 exec_hi, 0
  buffer_load_dword v127, v2, s[76:79], s31 offen
  s_mov_b64 exec, -1
attn1_kernel_noct:
  s_waitcnt lgkmcnt(2)
  v_mfma_f32_32x32x16_bf16 v[32:47], v[8:11], v[4:7], 0
  ds_read_b128 v[12:15], v120 offset:3072
  ds_read_b128 v[16:19], v121
  ds_read_b128 v[20:23], v123
  v_add_u32 v121, v122, v121
  v_add_u32 v123, v122, v123
  v_exp_f32 v48, v48
  v_exp_f32 v49, v49
  v_exp_f32 v50, v50
  v_exp_f32 v51, v51
  v_exp_f32 v52, v52
  v_exp_f32 v53, v53
  v_exp_f32 v54, v54
  v_exp_f32 v55, v55
  v_exp_f32 v56, v56
  v_exp_f32 v57, v57
  v_exp_f32 v58, v58
  v_exp_f32 v59, v59
  v_exp_f32 v60, v60
  v_exp_f32 v61, v61
  v_exp_f32 v62, v62
  v_exp_f32 v63, v63
  v_cvt_pk_bf16_f32 v64, v48, v49
  v_cvt_pk_bf16_f32 v65, v50, v51
  v_cvt_pk_bf16_f32 v66, v52, v53
  v_cvt_pk_bf16_f32 v67, v54, v55
  v_cvt_pk_bf16_f32 v68, v56, v57
  v_cvt_pk_bf16_f32 v69, v58, v59
  v_cvt_pk_bf16_f32 v70, v60, v61
  v_cvt_pk_bf16_f32 v71, v62, v63
  s_waitcnt lgkmcnt(3)
  v_mfma_f32_32x32x16_bf16 v[72:87], v[24:27], v[64:67], v[72:87]
  v_mfma_f32_32x32x16_bf16 v[72:87], v[28:31], v[68:71], v[72:87]
  s_waitcnt lgkmcnt(2)
  v_mfma_f32_32x32x16_bf16 v[48:63], v[12:15], v[4:7], 0
  ds_read_b128 v[8:11], v120 offset:4096
  ds_read_b128 v[24:27], v121
  ds_read_b128 v[28:31], v123
  v_add_u32 v121, v122, v121
  v_add_u32 v123, v122, v123
  v_exp_f32 v32, v32
  v_exp_f32 v33, v33
  v_exp_f32 v34, v34
  v_exp_f32 v35, v35
  v_exp_f32 v36, v36
  v_exp_f32 v37, v37
  v_exp_f32 v38, v38
  v_exp_f32 v39, v39
  v_exp_f32 v40, v40
  v_exp_f32 v41, v41
  v_exp_f32 v42, v42
  v_exp_f32 v43, v43
  v_exp_f32 v44, v44
  v_exp_f32 v45, v45
  v_exp_f32 v46, v46
  v_exp_f32 v47, v47
  v_cvt_pk_bf16_f32 v64, v32, v33
  v_cvt_pk_bf16_f32 v65, v34, v35
  v_cvt_pk_bf16_f32 v66, v36, v37
  v_cvt_pk_bf16_f32 v67, v38, v39
  v_cvt_pk_bf16_f32 v68, v40, v41
  v_cvt_pk_bf16_f32 v69, v42, v43
  v_cvt_pk_bf16_f32 v70, v44, v45
  v_cvt_pk_bf16_f32 v71, v46, v47
  s_waitcnt lgkmcnt(3)
  v_mfma_f32_32x32x16_bf16 v[72:87], v[16:19], v[64:67], v[72:87]
  v_mfma_f32_32x32x16_bf16 v[72:87], v[20:23], v[68:71], v[72:87]
  s_waitcnt lgkmcnt(2)
  v_mfma_f32_32x32x16_bf16 v[32:47], v[8:11], v[4:7], 0
  ds_read_b128 v[12:15], v120 offset:5120
  ds_read_b128 v[16:19], v121
  ds_read_b128 v[20:23], v123
  v_add_u32 v121, v122, v121
  v_add_u32 v123, v122, v123
  v_exp_f32 v48, v48
  v_exp_f32 v49, v49
  v_exp_f32 v50, v50
  v_exp_f32 v51, v51
  v_exp_f32 v52, v52
  v_exp_f32 v53, v53
  v_exp_f32 v54, v54
  v_exp_f32 v55, v55
  v_exp_f32 v56, v56
  v_exp_f32 v57, v57
  v_exp_f32 v58, v58
  v_exp_f32 v59, v59
  v_exp_f32 v60, v60
  v_exp_f32 v61, v61
  v_exp_f32 v62, v62
  v_exp_f32 v63, v63
  v_cvt_pk_bf16_f32 v64, v48, v49
  v_cvt_pk_bf16_f32 v65, v50, v51
  v_cvt_pk_bf16_f32 v66, v52, v53
  v_cvt_pk_bf16_f32 v67, v54, v55
  v_cvt_pk_bf16_f32 v68, v56, v57
  v_cvt_pk_bf16_f32 v69, v58, v59
  v_cvt_pk_bf16_f32 v70, v60, v61
  v_cvt_pk_bf16_f32 v71, v62, v63
  s_waitcnt lgkmcnt(3)
  v_mfma_f32_32x32x16_bf16 v[72:87], v[24:27], v[64:67], v[72:87]
  v_mfma_f32_32x32x16_bf16 v[72:87], v[28:31], v[68:71], v[72:87]
  s_waitcnt lgkmcnt(2)
  v_mfma_f32_32x32x16_bf16 v[48:63], v[12:15], v[4:7], 0
  ds_read_b128 v[8:11], v120 offset:6144
  ds_read_b128 v[24:27], v121
  ds_read_b128 v[28:31], v123
  v_add_u32 v121, v122, v121
  v_add_u32 v123, v122, v123
  v_exp_f32 v32, v32
  v_exp_f32 v33, v33
  v_exp_f32 v34, v34
  v_exp_f32 v35, v35
  v_exp_f32 v36, v36
  v_exp_f32 v37, v37
  v_exp_f32 v38, v38
  v_exp_f32 v39, v39
  v_exp_f32 v40, v40
  v_exp_f32 v41, v41
  v_exp_f32 v42, v42
  v_exp_f32 v43, v43
  v_exp_f32 v44, v44
  v_exp_f32 v45, v45
  v_exp_f32 v46, v46
  v_exp_f32 v47, v47
  v_cvt_pk_bf16_f32 v64, v32, v33
  v_cvt_pk_bf16_f32 v65, v34, v35
  v_cvt_pk_bf16_f32 v66, v36, v37
  v_cvt_pk_bf16_f32 v67, v38, v39
  v_cvt_pk_bf16_f32 v68, v40, v41
  v_cvt_pk_bf16_f32 v69, v42, v43
  v_cvt_pk_bf16_f32 v70, v44, v45
  v_cvt_pk_bf16_f32 v71, v46, v47
  s_waitcnt lgkmcnt(3)
  v_mfma_f32_32x32x16_bf16 v[72:87], v[16:19], v[64:67], v[72:87]
  v_mfma_f32_32x32x16_bf16 v[72:87], v[20:23], v[68:71], v[72:87]
  s_waitcnt lgkmcnt(2)
  v_mfma_f32_32x32x16_bf16 v[32:47], v[8:11], v[4:7], 0
  ds_read_b128 v[12:15], v120 offset:7168
  ds_read_b128 v[16:19], v121
  ds_read_b128 v[20:23], v123
  v_add_u32 v121, v122, v121
  v_add_u32 v123, v122, v123
  v_exp_f32 v48, v48
  v_exp_f32 v49, v49
  v_exp_f32 v50, v50
  v_exp_f32 v51, v51
  v_exp_f32 v52, v52
  v_exp_f32 v53, v53
  v_exp_f32 v54, v54
  v_exp_f32 v55, v55
  v_exp_f32 v56, v56
  v_exp_f32 v57, v57
  v_exp_f32 v58, v58
  v_exp_f32 v59, v59
  v_exp_f32 v60, v60
  v_exp_f32 v61, v61
  v_exp_f32 v62, v62
  v_exp_f32 v63, v63
  v_cvt_pk_bf16_f32 v64, v48, v49
  v_cvt_pk_bf16_f32 v65, v50, v51
  v_cvt_pk_bf16_f32 v66, v52, v53
  v_cvt_pk_bf16_f32 v67, v54, v55
  v_cvt_pk_bf16_f32 v68, v56, v57
  v_cvt_pk_bf16_f32 v69, v58, v59
  v_cvt_pk_bf16_f32 v70, v60, v61
  v_cvt_pk_bf16_f32 v71, v62, v63
  s_waitcnt lgkmcnt(3)
  v_mfma_f32_32x32x16_bf16 v[72:87], v[24:27], v[64:67], v[72:87]
  v_mfma_f32_32x32x16_bf16 v[72:87], v[28:31], v[68:71], v[72:87]
  s_waitcnt lgkmcnt(2)
  v_mfma_f32_32x32x16_bf16 v[48:63], v[12:15], v[4:7], 0
  ds_read_b128 v[8:11], v120 offset:8192
  ds_read_b128 v[24:27], v121
  ds_read_b128 v[28:31], v123
  v_add_u32 v121, v122, v121
  v_add_u32 v123, v122, v123
  v_exp_f32 v32, v32
  v_exp_f32 v33, v33
  v_exp_f32 v34, v34
  v_exp_f32 v35, v35
  v_exp_f32 v36, v36
  v_exp_f32 v37, v37
  v_exp_f32 v38, v38
  v_exp_f32 v39, v39
  v_exp_f32 v40, v40
  v_exp_f32 v41, v41
  v_exp_f32 v42, v42
  v_exp_f32 v43, v43
  v_exp_f32 v44, v44
  v_exp_f32 v45, v45
  v_exp_f32 v46, v46
  v_exp_f32 v47, v47
  v_cvt_pk_bf16_f32 v64, v32, v33
  v_cvt_pk_bf16_f32 v65, v34, v35
  v_cvt_pk_bf16_f32 v66, v36, v37
  v_cvt_pk_bf16_f32 v67, v38, v39
  v_cvt_pk_bf16_f32 v68, v40, v41
  v_cvt_pk_bf16_f32 v69, v42, v43
  v_cvt_pk_bf16_f32 v70, v44, v45
  v_cvt_pk_bf16_f32 v71, v46, v47
  s_waitcnt lgkmcnt(3)
  v_mfma_f32_32x32x16_bf16 v[72:87], v[16:19], v[64:67], v[72:87]
  v_mfma_f32_32x32x16_bf16 v[72:87], v[20:23], v[68:71], v[72:87]
  s_waitcnt lgkmcnt(2)
  v_mfma_f32_32x32x16_bf16 v[32:47], v[8:11], v[4:7], v[104:119]
  ds_read_b128 v[16:19], v121
  ds_read_b128 v[20:23], v123
  v_add_u32 v121, v122, v121
  v_add_u32 v123, v122, v123
  v_exp_f32 v48, v48
  v_exp_f32 v49, v49
  v_exp_f32 v50, v50
  v_exp_f32 v51, v51
  v_exp_f32 v52, v52
  v_exp_f32 v53, v53
  v_exp_f32 v54, v54
  v_exp_f32 v55, v55
  v_exp_f32 v56, v56
  v_exp_f32 v57, v57
  v_exp_f32 v58, v58
  v_exp_f32 v59, v59
  v_exp_f32 v60, v60
  v_exp_f32 v61, v61
  v_exp_f32 v62, v62
  v_exp_f32 v63, v63
  v_cvt_pk_bf16_f32 v64, v48, v49
  v_cvt_pk_bf16_f32 v65, v50, v51
  v_cvt_pk_bf16_f32 v66, v52, v53
  v_cvt_pk_bf16_f32 v67, v54, v55
  v_cvt_pk_bf16_f32 v68, v56, v57
  v_cvt_pk_bf16_f32 v69, v58, v59
  v_cvt_pk_bf16_f32 v70, v60, v61
  v_cvt_pk_bf16_f32 v71, v62, v63
  s_waitcnt lgkmcnt(2)
  v_mfma_f32_32x32x16_bf16 v[72:87], v[24:27], v[64:67], v[72:87]
  v_mfma_f32_32x32x16_bf16 v[72:87], v[28:31], v[68:71], v[72:87]
  v_exp_f32 v32, v32
  v_exp_f32 v33, v33
  v_exp_f32 v34, v34
  v_exp_f32 v35, v35
  v_exp_f32 v36, v36
  v_exp_f32 v37, v37
  v_exp_f32 v38, v38
  v_exp_f32 v39, v39
  v_exp_f32 v40, v40
  v_exp_f32 v41, v41
  v_exp_f32 v42, v42
  v_exp_f32 v43, v43
  v_exp_f32 v44, v44
  v_exp_f32 v45, v45
  v_exp_f32 v46, v46
  v_exp_f32 v47, v47
  v_cvt_pk_bf16_f32 v64, v32, v33
  v_cvt_pk_bf16_f32 v65, v34, v35
  v_cvt_pk_bf16_f32 v66, v36, v37
  v_cvt_pk_bf16_f32 v67, v38, v39
  v_cvt_pk_bf16_f32 v68, v40, v41
  v_cvt_pk_bf16_f32 v69, v42, v43
  v_cvt_pk_bf16_f32 v70, v44, v45
  v_cvt_pk_bf16_f32 v71, v46, v47
  s_waitcnt lgkmcnt(0)
  v_mfma_f32_32x32x16_bf16 v[72:87], v[16:19], v[64:67], v[72:87]
  v_mfma_f32_32x32x16_bf16 v[72:87], v[20:23], v[68:71], v[72:87]
  v_mov_b32 v8, 0x21800000
  v_mov_b32 v9, 0x5d800000
  s_nop 9
  v_cmp_le_f32 s[26:27], v8, v80
  v_cmp_ge_f32 s[28:29], v9, v80
  s_nop 0
  s_and_b64 s[26:27], s[26:27], s[28:29]
  s_cmp_eq_u64 s[26:27], -1
  s_cbranch_scc0 attn1_kernel_fallback
attn1_kernel_finish:
  v_rcp_f32 v8, v80
  s_nop 0
  v_mul_f32 v72, v8, v72
  v_mul_f32 v73, v8, v73
  v_mul_f32 v74, v8, v74
  v_mul_f32 v75, v8, v75
  v_mul_f32 v76, v8, v76
  v_mul_f32 v77, v8, v77
  v_mul_f32 v78, v8, v78
  v_mul_f32 v79, v8, v79
  v_cvt_pk_bf16_f32 v64, v72, v73
  v_cvt_pk_bf16_f32 v65, v74, v75
  v_cvt_pk_bf16_f32 v66, v76, v77
  v_cvt_pk_bf16_f32 v67, v78, v79
  s_lshl_b32 s25, s23, 3
  s_add_u32 s25, s25, s22
  s_lshl_b32 s25, s25, 5
  s_add_u32 s25, s25, s24
  s_lshl_b32 s25, s25, 10
  s_add_u32 s25, s25, 0x600000
  v_lshlrev_b32 v3, 4, v1
  buffer_store_dwordx4 v[64:67], v3, s[16:19], s25 offen sc1
  s_endpgm
attn1_kernel_fallback:
  s_waitcnt vmcnt(0)
  s_mov_b32 s30, 0
  s_cmp_lg_u32 s23, 0
  s_cbranch_scc1 attn1_kernel_fb_j
  s_sub_u32 s30, 8, s22
attn1_kernel_fb_j:
  v_mov_b32 v124, 0xff61b1e6
  s_mov_b32 s31, s30
attn1_kernel_fb_p1:
  s_lshl_b32 s25, s31, 10
  v_add_u32 v125, s25, v120
  ds_read_b128 v[8:11], v125 offset:0
  s_waitcnt lgkmcnt(0)
  v_mfma_f32_32x32x16_bf16 v[32:47], v[8:11], v[4:7], 0
  s_nop 15
  s_cmp_lg_u32 s31, 0
  s_cbranch_scc1 attn1_kernel_m1a
  v_add_f32 v32, v88, v32
  v_add_f32 v33, v89, v33
  v_add_f32 v34, v90, v34
  v_add_f32 v35, v91, v35
  v_add_f32 v36, v92, v36
  v_add_f32 v37, v93, v37
  v_add_f32 v38, v94, v38
  v_add_f32 v39, v95, v39
  v_add_f32 v40, v96, v40
  v_add_f32 v41, v97, v41
  v_add_f32 v42, v98, v42
  v_add_f32 v43, v99, v43
  v_add_f32 v44, v100, v44
  v_add_f32 v45, v101, v45
  v_add_f32 v46, v102, v46
  v_add_f32 v47, v103, v47
attn1_kernel_m1a:
  s_cmp_lg_u32 s31, 8
  s_cbranch_scc1 attn1_kernel_m1b
  v_add_f32 v32, v104, v32
  v_add_f32 v33, v105, v33
  v_add_f32 v34, v106, v34
  v_add_f32 v35, v107, v35
  v_add_f32 v36, v108, v36
  v_add_f32 v37, v109, v37
  v_add_f32 v38, v110, v38
  v_add_f32 v39, v111, v39
  v_add_f32 v40, v112, v40
  v_add_f32 v41, v113, v41
  v_add_f32 v42, v114, v42
  v_add_f32 v43, v115, v43
  v_add_f32 v44, v116, v44
  v_add_f32 v45, v117, v45
  v_add_f32 v46, v118, v46
  v_add_f32 v47, v119, v47
attn1_kernel_m1b:
  v_max3_f32 v124, v32, v33, v124
  v_max3_f32 v124, v34, v35, v124
  v_max3_f32 v124, v36, v37, v124
  v_max3_f32 v124, v38, v39, v124
  v_max3_f32 v124, v40, v41, v124
  v_max3_f32 v124, v42, v43, v124
  v_max3_f32 v124, v44, v45, v124
  v_max3_f32 v124, v46, v47, v124
  s_add_u32 s31, s31, 1
  s_cmp_le_u32 s31, 8
  s_cbranch_scc1 attn1_kernel_fb_p1
  v_mov_b32 v125, v124
  s_nop 1
  v_permlane32_swap_b32 v124, v125
  s_nop 1
  v_max_f32 v124, v124, v125
  s_mov_b32 s31, s30
  v_mov_b32 v72, 0
  v_mov_b32 v73, 0
  v_mov_b32 v74, 0
  v_mov_b32 v75, 0
  v_mov_b32 v76, 0
  v_mov_b32 v77, 0
  v_mov_b32 v78, 0
  v_mov_b32 v79, 0
  v_mov_b32 v80, 0
  v_mov_b32 v81, 0
  v_mov_b32 v82, 0
  v_mov_b32 v83, 0
  v_mov_b32 v84, 0
  v_mov_b32 v85, 0
  v_mov_b32 v86, 0
  v_mov_b32 v87, 0
  v_mul_u32_u24 v125, 9, v122
  v_sub_u32 v121, v121, v125
  v_sub_u32 v123, v123, v125
attn1_kernel_fb_p2:
  s_lshl_b32 s25, s31, 10
  v_add_u32 v125, s25, v120
  ds_read_b128 v[8:11], v125 offset:0
  v_mul_lo_u32 v126, s31, v122
  v_add_u32 v127, v126, v121
  v_add_u32 v126, v126, v123
  ds_read_b128 v[16:19], v127
  ds_read_b128 v[20:23], v126
  s_waitcnt lgkmcnt(0)
  v_mfma_f32_32x32x16_bf16 v[32:47], v[8:11], v[4:7], 0
  s_nop 15
  s_cmp_lg_u32 s31, 0
  s_cbranch_scc1 attn1_kernel_m2a
  v_add_f32 v32, v88, v32
  v_add_f32 v33, v89, v33
  v_add_f32 v34, v90, v34
  v_add_f32 v35, v91, v35
  v_add_f32 v36, v92, v36
  v_add_f32 v37, v93, v37
  v_add_f32 v38, v94, v38
  v_add_f32 v39, v95, v39
  v_add_f32 v40, v96, v40
  v_add_f32 v41, v97, v41
  v_add_f32 v42, v98, v42
  v_add_f32 v43, v99, v43
  v_add_f32 v44, v100, v44
  v_add_f32 v45, v101, v45
  v_add_f32 v46, v102, v46
  v_add_f32 v47, v103, v47
attn1_kernel_m2a:
  s_cmp_lg_u32 s31, 8
  s_cbranch_scc1 attn1_kernel_m2b
  v_add_f32 v32, v104, v32
  v_add_f32 v33, v105, v33
  v_add_f32 v34, v106, v34
  v_add_f32 v35, v107, v35
  v_add_f32 v36, v108, v36
  v_add_f32 v37, v109, v37
  v_add_f32 v38, v110, v38
  v_add_f32 v39, v111, v39
  v_add_f32 v40, v112, v40
  v_add_f32 v41, v113, v41
  v_add_f32 v42, v114, v42
  v_add_f32 v43, v115, v43
  v_add_f32 v44, v116, v44
  v_add_f32 v45, v117, v45
  v_add_f32 v46, v118, v46
  v_add_f32 v47, v119, v47
attn1_kernel_m2b:
  v_sub_f32 v32, v32, v124
  v_sub_f32 v33, v33, v124
  v_sub_f32 v34, v34, v124
  v_sub_f32 v35, v35, v124
  v_sub_f32 v36, v36, v124
  v_sub_f32 v37, v37, v124
  v_sub_f32 v38, v38, v124
  v_sub_f32 v39, v39, v124
  v_sub_f32 v40, v40, v124
  v_sub_f32 v41, v41, v124
  v_sub_f32 v42, v42, v124
  v_sub_f32 v43, v43, v124
  v_sub_f32 v44, v44, v124
  v_sub_f32 v45, v45, v124
  v_sub_f32 v46, v46, v124
  v_sub_f32 v47, v47, v124
  v_exp_f32 v32, v32
  v_exp_f32 v33, v33
  v_exp_f32 v34, v34
  v_exp_f32 v35, v35
  v_exp_f32 v36, v36
  v_exp_f32 v37, v37
  v_exp_f32 v38, v38
  v_exp_f32 v39, v39
  v_exp_f32 v40, v40
  v_exp_f32 v41, v41
  v_exp_f32 v42, v42
  v_exp_f32 v43, v43
  v_exp_f32 v44, v44
  v_exp_f32 v45, v45
  v_exp_f32 v46, v46
  v_exp_f32 v47, v47
  s_nop 1
  v_cvt_pk_bf16_f32 v64, v32, v33
  v_cvt_pk_bf16_f32 v65, v34, v35
  v_cvt_pk_bf16_f32 v66, v36, v37
  v_cvt_pk_bf16_f32 v67, v38, v39
  v_cvt_pk_bf16_f32 v68, v40, v41
  v_cvt_pk_bf16_f32 v69, v42, v43
  v_cvt_pk_bf16_f32 v70, v44, v45
  v_cvt_pk_bf16_f32 v71, v46, v47
  s_nop 1
  v_mfma_f32_32x32x16_bf16 v[72:87], v[16:19], v[64:67], v[72:87]
  v_mfma_f32_32x32x16_bf16 v[72:87], v[20:23], v[68:71], v[72:87]
  s_nop 15
  s_add_u32 s31, s31, 1
  s_cmp_le_u32 s31, 8
  s_cbranch_scc1 attn1_kernel_fb_p2
  s_nop 7
  s_branch attn1_kernel_finish
attn1_kernel_end:
  s_endpgm
attn1_kernel_codeend:
.globl wo1_kernel
.p2align 8
.type wo1_kernel,@function
wo1_kernel:
  s_cmp_ge_u32 s2, 256
  s_cbranch_scc1 wo1_kernel_end
  s_load_dwordx2 s[4:5], s[0:1], 16
  s_load_dwordx2 s[6:7], s[0:1], 32
  s_load_dwordx2 s[20:21], s[0:1], 80
  v_lshrrev_b32 v2, 6, v0
  v_and_b32 v1, 63, v0
  v_readfirstlane_b32 s22, v2
  s_and_b32 s25, s2, 7
  s_lshr_b32 s26, s2, 3
  s_and_b32 s23, s26, 3
  s_lshl2_add_u32 s23, s25, s23
  s_lshr_b32 s24, s26, 2
  s_and_b32 s27, s22, 1
  s_lshr_b32 s28, s22, 1
  v_lshlrev_b32 v82, 4, v1
  v_lshrrev_b32 v3, 3, v1
  s_lshl_b32 s25, s22, 4
  v_add_u32 v3, s25, v3
  v_lshlrev_b32 v3, 10, v3
  v_bfe_u32 v4, v1, 2, 1
  v_bfe_u32 v5, v1, 4, 1
  v_xor_b32 v4, v4, v5
  v_lshl_add_u32 v3, v4, 6, v3
  v_and_b32 v4, 3, v1
  v_lshl_add_u32 v3, v4, 4, v3
  s_lshl_b32 s25, s24, 7
  v_add_u32 v83, s25, v3
  s_lshl_b32 s25, s27, 15
  v_lshl_add_u32 v80, v1, 4, s25
  v_lshrrev_b32 v6, 5, v1
  v_bfe_u32 v7, v1, 2, 2
  v_lshl_add_u32 v8, v6, 3, v7
  v_lshlrev_b32 v8, 7, v8
  v_bfe_u32 v9, v1, 3, 1
  v_xor_b32 v9, s28, v9
  v_lshl_add_u32 v8, v9, 6, v8
  v_bfe_u32 v9, v1, 4, 1
  v_lshl_add_u32 v8, v9, 5, v8
  v_and_b32 v9, 1, v1
  v_lshl_add_u32 v8, v9, 4, v8
  v_bfe_u32 v9, v1, 1, 1
  v_lshl_add_u32 v8, v9, 3, v8
  v_add_u32 v81, 0x10000, v8
  s_lshl_b32 s25, s23, 1
  s_add_u32 s25, s25, s27
  s_lshl_b32 s34, s25, 5
  s_lshl_b32 s26, s28, 1
  s_add_u32 s29, s34, s26
  s_lshl_b32 s29, s29, 10
  s_add_u32 s29, s29, 0x600000
  s_lshl_b32 s30, s27, 15
  s_lshl_b32 s26, s28, 11
  s_add_u32 s30, s30, s26
  s_lshl_b32 s31, s22, 11
  s_add_u32 s31, s31, 0x10000
  s_waitcnt lgkmcnt(0)
  s_mov_b32 s8, s4
  s_and_b32 s9, s5, 0xffff
  s_mov_b32 s10, 0x80000
  s_mov_b32 s11, 0x20000
  s_mov_b32 s12, s6
  s_and_b32 s13, s7, 0xffff
  s_mov_b32 s14, 0x400
  s_mov_b32 s15, 0x20000
  s_mov_b32 s16, s20
  s_and_b32 s17, s21, 0xffff
  s_mov_b32 s18, 0x10000000
  s_mov_b32 s19, 0x20000
  s_add_u32 m0, s30, 0
  s_add_u32 s32, s29, 0
  buffer_load_dwordx4 v82, s[16:19], s32 offen lds
  buffer_load_dwordx4 v82, s[16:19], s32 offen offset:1024 lds
  s_add_u32 m0, s31, 0
  s_mov_b32 s33, 0
  buffer_load_dwordx4 v83, s[8:11], s33 offen lds
  s_mov_b32 s33, 7168
  buffer_load_dwordx4 v83, s[8:11], s33 offen offset:1024 lds
  s_add_u32 m0, s30, 4096
  s_add_u32 s32, s29, 4096
  buffer_load_dwordx4 v82, s[16:19], s32 offen lds
  buffer_load_dwordx4 v82, s[16:19], s32 offen offset:1024 lds
  s_add_u32 m0, s31, 8192
  s_mov_b32 s33, 65536
  buffer_load_dwordx4 v83, s[8:11], s33 offen lds
  s_mov_b32 s33, 72704
  buffer_load_dwordx4 v83, s[8:11], s33 offen offset:1024 lds
  s_add_u32 m0, s30, 8192
  s_add_u32 s32, s29, 8192
  buffer_load_dwordx4 v82, s[16:19], s32 offen lds
  buffer_load_dwordx4 v82, s[16:19], s32 offen offset:1024 lds
  s_add_u32 m0, s31, 16384
  s_mov_b32 s33, 131072
  buffer_load_dwordx4 v83, s[8:11], s33 offen lds
  s_mov_b32 s33, 138240
  buffer_load_dwordx4 v83, s[8:11], s33 offen offset:1024 lds
  s_lshl_b32 s26, s24, 2
  s_add_u32 s34, s34, s26
  s_lshl_b32 s26, s28, 1
  s_add_u32 s34, s34, s26
  s_lshl_b32 s34, s34, 10
  s_add_u32 s35, s34, 0x1000000
  s_lshl_b32 s36, s24, 7
  s_lshl_b32 s26, s28, 6
  s_add_u32 s36, s36, s26
  v_lshlrev_b32 v10, 4, v6
  buffer_load_dwordx4 v[64:67], v82, s[16:19], s35 offen
  buffer_load_dwordx4 v[68:71], v82, s[16:19], s35 offen offset:1024
  buffer_load_dwordx4 v[72:75], v10, s[12:15], s36 offen
  buffer_load_dwordx4 v[76:79], v10, s[12:15], s36 offen offset:32
  v_and_b32 v11, 31, v1
  s_lshl_b32 s26, s25, 5
  v_add_u32 v11, s26, v11
  v_lshlrev_b32 v12, 2, v11
  s_waitcnt vmcnt(12)
  s_barrier
  ds_read_b128 v[32:35], v80 offset:0
  ds_read_b64_tr_b16 v[48:49], v81 offset:0
  ds_read_b64_tr_b16 v[50:51], v81 offset:512
  ds_read_b128 v[36:39], v80 offset:1024
  ds_read_b64_tr_b16 v[52:53], v81 offset:2048
  ds_read_b64_tr_b16 v[54:55], v81 offset:2560
  ds_read_b128 v[40:43], v80 offset:2048
  ds_read_b64_tr_b16 v[56:57], v81 offset:4096
  ds_read_b64_tr_b16 v[58:59], v81 offset:4608
  ds_read_b128 v[44:47], v80 offset:3072
  ds_read_b64_tr_b16 v[60:61], v81 offset:6144
  ds_read_b64_tr_b16 v[62:63], v81 offset:6656
  s_add_u32 m0, s30, 12288
  s_add_u32 s32, s29, 12288
  buffer_load_dwordx4 v82, s[16:19], s32 offen lds
  s_waitcnt lgkmcnt(9)
  v_mfma_f32_32x32x16_bf16 v[16:31], v[48:51], v[32:35], 0
  buffer_load_dwordx4 v82, s[16:19], s32 offen offset:1024 lds
  s_waitcnt lgkmcnt(6)
  v_mfma_f32_32x32x16_bf16 v[16:31], v[52:55], v[36:39], v[16:31]
  s_add_u32 m0, s31, 24576
  s_mov_b32 s33, 196608
  buffer_load_dwordx4 v83, s[8:11], s33 offen lds
  s_waitcnt lgkmcnt(3)
  v_mfma_f32_32x32x16_bf16 v[16:31], v[56:59], v[40:43], v[16:31]
  s_mov_b32 s33, 203776
  buffer_load_dwordx4 v83, s[8:11], s33 offen offset:1024 lds
  s_waitcnt lgkmcnt(0)
  v_mfma_f32_32x32x16_bf16 v[16:31], v[60:63], v[44:47], v[16:31]
  s_waitcnt vmcnt(12)
  s_barrier
  ds_read_b128 v[32:35], v80 offset:4096
  ds_read_b64_tr_b16 v[48:49], v81 offset:8192
  ds_read_b64_tr_b16 v[50:51], v81 offset:8704
  ds_read_b128 v[36:39], v80 offset:5120
  ds_read_b64_tr_b16 v[52:53], v81 offset:10240
  ds_read_b64_tr_b16 v[54:55], v81 offset:10752
  ds_read_b128 v[40:43], v80 offset:6144
  ds_read_b64_tr_b16 v[56:57], v81 offset:12288
  ds_read_b64_tr_b16 v[58:59], v81 offset:12800
  ds_read_b128 v[44:47], v80 offset:7168
  ds_read_b64_tr_b16 v[60:61], v81 offset:14336
  ds_read_b64_tr_b16 v[62:63], v81 offset:14848
  s_add_u32 m0, s30, 16384
  s_add_u32 s32, s29, 16384
  buffer_load_dwordx4 v82, s[16:19], s32 offen lds
  s_waitcnt lgkmcnt(9)
  v_mfma_f32_32x32x16_bf16 v[16:31], v[48:51], v[32:35], v[16:31]
  buffer_load_dwordx4 v82, s[16:19], s32 offen offset:1024 lds
  s_waitcnt lgkmcnt(6)
  v_mfma_f32_32x32x16_bf16 v[16:31], v[52:55], v[36:39], v[16:31]
  s_add_u32 m0, s31, 32768
  s_mov_b32 s33, 262144
  buffer_load_dwordx4 v83, s[8:11], s33 offen lds
  s_waitcnt lgkmcnt(3)
  v_mfma_f32_32x32x16_bf16 v[16:31], v[56:59], v[40:43], v[16:31]
  s_mov_b32 s33, 269312
  buffer_load_dwordx4 v83, s[8:11], s33 offen offset:1024 lds
  s_waitcnt lgkmcnt(0)
  v_mfma_f32_32x32x16_bf16 v[16:31], v[60:63], v[44:47], v[16:31]
  s_waitcnt vmcnt(12)
  s_barrier
  ds_read_b128 v[32:35], v80 offset:8192
  ds_read_b64_tr_b16 v[48:49], v81 offset:16384
  ds_read_b64_tr_b16 v[50:51], v81 offset:16896
  ds_read_b128 v[36:39], v80 offset:9216
  ds_read_b64_tr_b16 v[52:53], v81 offset:18432
  ds_read_b64_tr_b16 v[54:55], v81 offset:18944
  ds_read_b128 v[40:43], v80 offset:10240
  ds_read_b64_tr_b16 v[56:57], v81 offset:20480
  ds_read_b64_tr_b16 v[58:59], v81 offset:20992
  ds_read_b128 v[44:47], v80 offset:11264
  ds_read_b64_tr_b16 v[60:61], v81 offset:22528
  ds_read_b64_tr_b16 v[62:63], v81 offset:23040
  s_add_u32 m0, s30, 20480
  s_add_u32 s32, s29, 20480
  buffer_load_dwordx4 v82, s[16:19], s32 offen lds
  s_waitcnt lgkmcnt(9)
  v_mfma_f32_32x32x16_bf16 v[16:31], v[48:51], v[32:35], v[16:31]
  buffer_load_dwordx4 v82, s[16:19], s32 offen offset:1024 lds
  s_waitcnt lgkmcnt(6)
  v_mfma_f32_32x32x16_bf16 v[16:31], v[52:55], v[36:39], v[16:31]
  s_add_u32 m0, s31, 40960
  s_mov_b32 s33, 327680
  buffer_load_dwordx4 v83, s[8:11], s33 offen lds
  s_waitcnt lgkmcnt(3)
  v_mfma_f32_32x32x16_bf16 v[16:31], v[56:59], v[40:43], v[16:31]
  s_mov_b32 s33, 334848
  buffer_load_dwordx4 v83, s[8:11], s33 offen offset:1024 lds
  s_waitcnt lgkmcnt(0)
  v_mfma_f32_32x32x16_bf16 v[16:31], v[60:63], v[44:47], v[16:31]
  s_waitcnt vmcnt(8)
  s_barrier
  ds_read_b128 v[32:35], v80 offset:12288
  ds_read_b64_tr_b16 v[48:49], v81 offset:24576
  ds_read_b64_tr_b16 v[50:51], v81 offset:25088
  ds_read_b128 v[36:39], v80 offset:13312
  ds_read_b64_tr_b16 v[52:53], v81 offset:26624
  ds_read_b64_tr_b16 v[54:55], v81 offset:27136
  ds_read_b128 v[40:43], v80 offset:14336
  ds_read_b64_tr_b16 v[56:57], v81 offset:28672
  ds_read_b64_tr_b16 v[58:59], v81 offset:29184
  ds_read_b128 v[44:47], v80 offset:15360
  ds_read_b64_tr_b16 v[60:61], v81 offset:30720
  ds_read_b64_tr_b16 v[62:63], v81 offset:31232
  s_add_u32 m0, s30, 24576
  s_add_u32 s32, s29, 24576
  buffer_load_dwordx4 v82, s[16:19], s32 offen lds
  s_waitcnt lgkmcnt(9)
  v_mfma_f32_32x32x16_bf16 v[16:31], v[48:51], v[32:35], v[16:31]
  buffer_load_dwordx4 v82, s[16:19], s32 offen offset:1024 lds
  s_waitcnt lgkmcnt(6)
  v_mfma_f32_32x32x16_bf16 v[16:31], v[52:55], v[36:39], v[16:31]
  s_add_u32 m0, s31, 49152
  s_mov_b32 s33, 393216
  buffer_load_dwordx4 v83, s[8:11], s33 offen lds
  s_waitcnt lgkmcnt(3)
  v_mfma_f32_32x32x16_bf16 v[16:31], v[56:59], v[40:43], v[16:31]
  s_mov_b32 s33, 400384
  buffer_load_dwordx4 v83, s[8:11], s33 offen offset:1024 lds
  s_waitcnt lgkmcnt(0)
  v_mfma_f32_32x32x16_bf16 v[16:31], v[60:63], v[44:47], v[16:31]
  s_waitcnt vmcnt(8)
  s_barrier
  ds_read_b128 v[32:35], v80 offset:16384
  ds_read_b64_tr_b16 v[48:49], v81 offset:32768
  ds_read_b64_tr_b16 v[50:51], v81 offset:33280
  ds_read_b128 v[36:39], v80 offset:17408
  ds_read_b64_tr_b16 v[52:53], v81 offset:34816
  ds_read_b64_tr_b16 v[54:55], v81 offset:35328
  ds_read_b128 v[40:43], v80 offset:18432
  ds_read_b64_tr_b16 v[56:57], v81 offset:36864
  ds_read_b64_tr_b16 v[58:59], v81 offset:37376
  ds_read_b128 v[44:47], v80 offset:19456
  ds_read_b64_tr_b16 v[60:61], v81 offset:38912
  ds_read_b64_tr_b16 v[62:63], v81 offset:39424
  s_add_u32 m0, s30, 28672
  s_add_u32 s32, s29, 28672
  buffer_load_dwordx4 v82, s[16:19], s32 offen lds
  s_waitcnt lgkmcnt(9)
  v_mfma_f32_32x32x16_bf16 v[16:31], v[48:51], v[32:35], v[16:31]
  buffer_load_dwordx4 v82, s[16:19], s32 offen offset:1024 lds
  s_waitcnt lgkmcnt(6)
  v_mfma_f32_32x32x16_bf16 v[16:31], v[52:55], v[36:39], v[16:31]
  s_add_u32 m0, s31, 57344
  s_mov_b32 s33, 458752
  buffer_load_dwordx4 v83, s[8:11], s33 offen lds
  s_waitcnt lgkmcnt(3)
  v_mfma_f32_32x32x16_bf16 v[16:31], v[56:59], v[40:43], v[16:31]
  s_mov_b32 s33, 465920
  buffer_load_dwordx4 v83, s[8:11], s33 offen offset:1024 lds
  s_waitcnt lgkmcnt(0)
  v_mfma_f32_32x32x16_bf16 v[16:31], v[60:63], v[44:47], v[16:31]
  s_waitcnt vmcnt(8)
  s_barrier
  ds_read_b128 v[32:35], v80 offset:20480
  ds_read_b64_tr_b16 v[48:49], v81 offset:40960
  ds_read_b64_tr_b16 v[50:51], v81 offset:41472
  ds_read_b128 v[36:39], v80 offset:21504
  ds_read_b64_tr_b16 v[52:53], v81 offset:43008
  ds_read_b64_tr_b16 v[54:55], v81 offset:43520
  ds_read_b128 v[40:43], v80 offset:22528
  ds_read_b64_tr_b16 v[56:57], v81 offset:45056
  ds_read_b64_tr_b16 v[58:59], v81 offset:45568
  ds_read_b128 v[44:47], v80 offset:23552
  ds_read_b64_tr_b16 v[60:61], v81 offset:47104
  ds_read_b64_tr_b16 v[62:63], v81 offset:47616
  s_waitcnt lgkmcnt(9)
  v_mfma_f32_32x32x16_bf16 v[16:31], v[48:51], v[32:35], v[16:31]
  s_waitcnt lgkmcnt(6)
  v_mfma_f32_32x32x16_bf16 v[16:31], v[52:55], v[36:39], v[16:31]
  s_waitcnt lgkmcnt(3)
  v_mfma_f32_32x32x16_bf16 v[16:31], v[56:59], v[40:43], v[16:31]
  s_waitcnt lgkmcnt(0)
  v_mfma_f32_32x32x16_bf16 v[16:31], v[60:63], v[44:47], v[16:31]
  s_waitcnt vmcnt(4)
  s_barrier
  ds_read_b128 v[32:35], v80 offset:24576
  ds_read_b64_tr_b16 v[48:49], v81 offset:49152
  ds_read_b64_tr_b16 v[50:51], v81 offset:49664
  ds_read_b128 v[36:39], v80 offset:25600
  ds_read_b64_tr_b16 v[52:53], v81 offset:51200
  ds_read_b64_tr_b16 v[54:55], v81 offset:51712
  ds_read_b128 v[40:43], v80 offset:26624
  ds_read_b64_tr_b16 v[56:57], v81 offset:53248
  ds_read_b64_tr_b16 v[58:59], v81 offset:53760
  ds_read_b128 v[44:47], v80 offset:27648
  ds_read_b64_tr_b16 v[60:61], v81 offset:55296
  ds_read_b64_tr_b16 v[62:63], v81 offset:55808
  s_waitcnt lgkmcnt(9)
  v_mfma_f32_32x32x16_bf16 v[16:31], v[48:51], v[32:35], v[16:31]
  s_waitcnt lgkmcnt(6)
  v_mfma_f32_32x32x16_bf16 v[16:31], v[52:55], v[36:39], v[16:31]
  s_waitcnt lgkmcnt(3)
  v_mfma_f32_32x32x16_bf16 v[16:31], v[56:59], v[40:43], v[16:31]
  s_waitcnt lgkmcnt(0)
  v_mfma_f32_32x32x16_bf16 v[16:31], v[60:63], v[44:47], v[16:31]
  s_waitcnt vmcnt(0)
  s_barrier
  ds_read_b128 v[32:35], v80 offset:28672
  ds_read_b64_tr_b16 v[48:49], v81 offset:57344
  ds_read_b64_tr_b16 v[50:51], v81 offset:57856
  ds_read_b128 v[36:39], v80 offset:29696
  ds_read_b64_tr_b16 v[52:53], v81 offset:59392
  ds_read_b64_tr_b16 v[54:55], v81 offset:59904
  ds_read_b128 v[40:43], v80 offset:30720
  ds_read_b64_tr_b16 v[56:57], v81 offset:61440
  ds_read_b64_tr_b16 v[58:59], v81 offset:61952
  ds_read_b128 v[44:47], v80 offset:31744
  ds_read_b64_tr_b16 v[60:61], v81 offset:63488
  ds_read_b64_tr_b16 v[62:63], v81 offset:64000
  s_waitcnt lgkmcnt(9)
  v_mfma_f32_32x32x16_bf16 v[16:31], v[48:51], v[32:35], v[16:31]
  s_waitcnt lgkmcnt(6)
  v_mfma_f32_32x32x16_bf16 v[16:31], v[52:55], v[36:39], v[16:31]
  s_waitcnt lgkmcnt(3)
  v_mfma_f32_32x32x16_bf16 v[16:31], v[56:59], v[40:43], v[16:31]
  s_waitcnt lgkmcnt(0)
  v_mfma_f32_32x32x16_bf16 v[16:31], v[60:63], v[44:47], v[16:31]
  s_cmp_lg_u32 s22, 3
  s_cbranch_scc1 wo1_kernel_noct
  s_lshr_b32 s47, s2, 3
  s_getpc_b64 s[48:49]
wo1_kernel_pc0:
  s_add_u32 s48, s48, (wo1_kernel_codeend-wo1_kernel_pc0)
  s_addc_u32 s49, s49, 0
  s_and_b32 s49, s49, 0xffff
  s_mov_b32 s50, (all_code_end-wo1_kernel_codeend)
  s_mov_b32 s51, 0x20000
  s_mul_i32 s47, s47, 1536
  v_lshlrev_b32 v14, 7, v1
  s_mov_b32 exec_lo, 0xfff
  s_mov_b32 exec_hi, 0
  buffer_load_dword v15, v14, s[48:51], s47 offen
  s_mov_b64 exec, -1
wo1_kernel_noct:
  v_lshlrev_b32 v32, 16, v64
  v_and_b32 v33, 0xffff0000, v64
  v_lshlrev_b32 v48, 16, v72
  v_and_b32 v49, 0xffff0000, v72
  v_lshlrev_b32 v34, 16, v65
  v_and_b32 v35, 0xffff0000, v65
  v_lshlrev_b32 v50, 16, v73
  v_and_b32 v51, 0xffff0000, v73
  v_lshlrev_b32 v36, 16, v66
  v_and_b32 v37, 0xffff0000, v66
  v_lshlrev_b32 v52, 16, v74
  v_and_b32 v53, 0xffff0000, v74
  v_lshlrev_b32 v38, 16, v67
  v_and_b32 v39, 0xffff0000, v67
  v_lshlrev_b32 v54, 16, v75
  v_and_b32 v55, 0xffff0000, v75
  v_lshlrev_b32 v40, 16, v68
  v_and_b32 v41, 0xffff0000, v68
  v_lshlrev_b32 v56, 16, v76
  v_and_b32 v57, 0xffff0000, v76
  v_lshlrev_b32 v42, 16, v69
  v_and_b32 v43, 0xffff0000, v69
  v_lshlrev_b32 v58, 16, v77
  v_and_b32 v59, 0xffff0000, v77
  v_lshlrev_b32 v44, 16, v70
  v_and_b32 v45, 0xffff0000, v70
  v_lshlrev_b32 v60, 16, v78
  v_and_b32 v61, 0xffff0000, v78
  v_lshlrev_b32 v46, 16, v71
  v_and_b32 v47, 0xffff0000, v71
  v_lshlrev_b32 v62, 16, v79
  v_and_b32 v63, 0xffff0000, v79
  v_add_f32 v16, v16, v32
  v_add_f32 v17, v17, v33
  v_add_f32 v18, v18, v34
  v_add_f32 v19, v19, v35
  v_add_f32 v20, v20, v36
  v_add_f32 v21, v21, v37
  v_add_f32 v22, v22, v38
  v_add_f32 v23, v23, v39
  v_add_f32 v24, v24, v40
  v_add_f32 v25, v25, v41
  v_add_f32 v26, v26, v42
  v_add_f32 v27, v27, v43
  v_add_f32 v28, v28, v44
  v_add_f32 v29, v29, v45
  v_add_f32 v30, v30, v46
  v_add_f32 v31, v31, v47
  v_mov_b32 v4, v16
  v_mul_f32 v5, v16, v16
  v_mul_f32 v7, v16, v48
  v_add_f32 v4, v4, v17
  v_fmac_f32 v5, v17, v17
  v_fmac_f32 v7, v17, v49
  v_add_f32 v4, v4, v18
  v_fmac_f32 v5, v18, v18
  v_fmac_f32 v7, v18, v50
  v_add_f32 v4, v4, v19
  v_fmac_f32 v5, v19, v19
  v_fmac_f32 v7, v19, v51
  v_add_f32 v4, v4, v20
  v_fmac_f32 v5, v20, v20
  v_fmac_f32 v7, v20, v52
  v_add_f32 v4, v4, v21
  v_fmac_f32 v5, v21, v21
  v_fmac_f32 v7, v21, v53
  v_add_f32 v4, v4, v22
  v_fmac_f32 v5, v22, v22
  v_fmac_f32 v7, v22, v54
  v_add_f32 v4, v4, v23
  v_fmac_f32 v5, v23, v23
  v_fmac_f32 v7, v23, v55
  v_add_f32 v4, v4, v24
  v_fmac_f32 v5, v24, v24
  v_fmac_f32 v7, v24, v56
  v_add_f32 v4, v4, v25
  v_fmac_f32 v5, v25, v25
  v_fmac_f32 v7, v25, v57
  v_add_f32 v4, v4, v26
  v_fmac_f32 v5, v26, v26
  v_fmac_f32 v7, v26, v58
  v_add_f32 v4, v4, v27
  v_fmac_f32 v5, v27, v27
  v_fmac_f32 v7, v27, v59
  v_add_f32 v4, v4, v28
  v_fmac_f32 v5, v28, v28
  v_fmac_f32 v7, v28, v60
  v_add_f32 v4, v4, v29
  v_fmac_f32 v5, v29, v29
  v_fmac_f32 v7, v29, v61
  v_add_f32 v4, v4, v30
  v_fmac_f32 v5, v30, v30
  v_fmac_f32 v7, v30, v62
  v_add_f32 v4, v4, v31
  v_fmac_f32 v5, v31, v31
  v_fmac_f32 v7, v31, v63
  v_cvt_pk_bf16_f32 v64, v16, v17
  v_cvt_pk_bf16_f32 v65, v18, v19
  v_cvt_pk_bf16_f32 v66, v20, v21
  v_cvt_pk_bf16_f32 v67, v22, v23
  v_cvt_pk_bf16_f32 v68, v24, v25
  v_cvt_pk_bf16_f32 v69, v26, v27
  v_cvt_pk_bf16_f32 v70, v28, v29
  v_cvt_pk_bf16_f32 v71, v30, v31
  s_add_u32 s35, s34, 0x1200000
  buffer_store_dwordx4 v[64:67], v82, s[16:19], s35 offen sc1
  buffer_store_dwordx4 v[68:71], v82, s[16:19], s35 offen offset:1024 sc1
  v_mov_b32 v8, v4
  v_mov_b32 v9, v5
  v_mov_b32 v13, v7
  s_nop 0
  v_permlane32_swap_b32 v4, v8
  v_permlane32_swap_b32 v5, v9
  v_permlane32_swap_b32 v7, v13
  v_add_f32 v4, v4, v8
  v_add_f32 v5, v5, v9
  v_add_f32 v7, v7, v13
  v_cmp_eq_u32 s[26:27], 0, v6
  v_lshl_add_u32 v8, v6, 13, v12
  s_mov_b32 s37, 0x1600000
  s_add_u32 s38, s37, 16384
  v_cndmask_b32 v4, v5, v4, s[26:27]
  buffer_atomic_add_f32 v4, v8, s[16:19], s37 offen
  s_mov_b32 exec_hi, 0
  buffer_atomic_add_f32 v7, v12, s[16:19], s38 offen
wo1_kernel_end:
  s_endpgm
wo1_kernel_codeend:
.globl qkv2_kernel
.p2align 8
.type qkv2_kernel,@function
qkv2_kernel:
  s_cmp_ge_u32 s2, 248
  s_cbranch_scc1 qkv2_kernel_end
  s_load_dwordx2 s[6:7], s[0:1], 8
  s_load_dwordx2 s[20:21], s[0:1], 80
  v_lshrrev_b32 v2, 6, v0
  v_and_b32 v1, 63, v0
  v_readfirstlane_b32 s22, v2
  s_and_b32 s27, s2, 7
  s_lshr_b32 s28, s2, 3
  s_waitcnt lgkmcnt(0)
  s_mov_b32 s16, s20
  s_and_b32 s17, s21, 0xffff
  s_mov_b32 s18, 0x10000000
  s_mov_b32 s19, 0x20000
  s_cmp_ge_u32 s28, 24
  s_cbranch_scc1 qkv2_kernel_ffn
  s_and_b32 s23, s28, 1
  s_lshl1_add_u32 s23, s27, s23
  s_lshr_b32 s24, s28, 1
  s_cmp_ge_u32 s22, 4
  s_cbranch_scc1 qkv2_kernel_loader
  s_lshl_b32 s25, s23, 2
  s_add_u32 s25, s25, s22
  v_lshrrev_b32 v6, 5, v1
  v_bfe_u32 v7, v1, 2, 2
  v_lshl_add_u32 v8, v6, 3, v7
  v_lshlrev_b32 v8, 8, v8
  v_bfe_u32 v9, v1, 4, 1
  v_lshl_add_u32 v8, v9, 5, v8
  v_and_b32 v9, 1, v1
  v_lshl_add_u32 v8, v9, 4, v8
  v_bfe_u32 v9, v1, 1, 1
  v_lshl_add_u32 v8, v9, 3, v8
  v_xor_b32 v9, 0, v7
  v_lshl_add_u32 v140, v9, 6, v8
  v_xor_b32 v9, 1, v7
  v_lshl_add_u32 v141, v9, 6, v8
  v_xor_b32 v9, 2, v7
  v_lshl_add_u32 v142, v9, 6, v8
  v_xor_b32 v9, 3, v7
  v_lshl_add_u32 v143, v9, 6, v8
  s_lshl_b32 s26, s22, 12
  s_add_u32 s26, s26, 16384
  v_lshl_add_u32 v144, v1, 4, s26
  s_cmp_ge_u32 s24, 8
  s_cbranch_scc1 qkv2_kernel_vtype
  s_barrier
  ds_read_b128 v[128:131], v144 offset:0
  ds_read_b64_tr_b16 v[80:81], v140 offset:0
  ds_read_b64_tr_b16 v[82:83], v140 offset:1024
  ds_read_b64_tr_b16 v[84:85], v141 offset:0
  ds_read_b64_tr_b16 v[86:87], v141 offset:1024
  ds_read_b64_tr_b16 v[88:89], v142 offset:0
  ds_read_b64_tr_b16 v[90:91], v142 offset:1024
  ds_read_b64_tr_b16 v[92:93], v143 offset:0
  ds_read_b64_tr_b16 v[94:95], v143 offset:1024
  ds_read_b128 v[132:135], v144 offset:1024
  ds_read_b64_tr_b16 v[96:97], v140 offset:4096
  ds_read_b64_tr_b16 v[98:99], v140 offset:5120
  ds_read_b64_tr_b16 v[100:101], v141 offset:4096
  ds_read_b64_tr_b16 v[102:103], v141 offset:5120
  ds_read_b64_tr_b16 v[104:105], v142 offset:4096
  ds_read_b64_tr_b16 v[106:107], v142 offset:5120
  ds_read_b64_tr_b16 v[108:109], v143 offset:4096
  ds_read_b64_tr_b16 v[110:111], v143 offset:5120
  s_waitcnt lgkmcnt(9)
  v_mfma_f32_32x32x16_bf16 v[16:31], v[80:83], v[128:131], 0
  ds_read_b128 v[136:139], v144 offset:2048
  ds_read_b64_tr_b16 v[112:113], v140 offset:8192
  ds_read_b64_tr_b16 v[114:115], v140 offset:9216
  v_mfma_f32_32x32x16_bf16 v[32:47], v[84:87], v[128:131], 0
  ds_read_b64_tr_b16 v[116:117], v141 offset:8192
  ds_read_b64_tr_b16 v[118:119], v141 offset:9216
  v_mfma_f32_32x32x16_bf16 v[48:63], v[88:91], v[128:131], 0
  ds_read_b64_tr_b16 v[120:121], v142 offset:8192
  ds_read_b64_tr_b16 v[122:123], v142 offset:9216
  v_mfma_f32_32x32x16_bf16 v[64:79], v[92:95], v[128:131], 0
  ds_read_b64_tr_b16 v[124:125], v143 offset:8192
  ds_read_b64_tr_b16 v[126:127], v143 offset:9216
  s_waitcnt lgkmcnt(9)
  v_mfma_f32_32x32x16_bf16 v[16:31], v[96:99], v[132:135], v[16:31]
  ds_read_b128 v[128:131], v144 offset:3072
  ds_read_b64_tr_b16 v[80:81], v140 offset:12288
  ds_read_b64_tr_b16 v[82:83], v140 offset:13312
  v_mfma_f32_32x32x16_bf16 v[32:47], v[100:103], v[132:135], v[32:47]
  ds_read_b64_tr_b16 v[84:85], v141 offset:12288
  ds_read_b64_tr_b16 v[86:87], v141 offset:13312
  v_mfma_f32_32x32x16_bf16 v[48:63], v[104:107], v[132:135], v[48:63]
  ds_read_b64_tr_b16 v[88:89], v142 offset:12288
  ds_read_b64_tr_b16 v[90:91], v142 offset:13312
  v_mfma_f32_32x32x16_bf16 v[64:79], v[108:111], v[132:135], v[64:79]
  ds_read_b64_tr_b16 v[92:93], v143 offset:12288
  ds_read_b64_tr_b16 v[94:95], v143 offset:13312
  s_waitcnt lgkmcnt(9)
  s_barrier
  v_mfma_f32_32x32x16_bf16 v[16:31], v[112:115], v[136:139], v[16:31]
  ds_read_b128 v[132:135], v144 offset:32768
  ds_read_b64_tr_b16 v[96:97], v140 offset:32768
  ds_read_b64_tr_b16 v[98:99], v140 offset:33792
  v_mfma_f32_32x32x16_bf16 v[32:47], v[116:119], v[136:139], v[32:47]
  ds_read_b64_tr_b16 v[100:101], v141 offset:32768
  ds_read_b64_tr_b16 v[102:103], v141 offset:33792
  v_mfma_f32_32x32x16_bf16 v[48:63], v[120:123], v[136:139], v[48:63]
  ds_read_b64_tr_b16 v[104:105], v142 offset:32768
  ds_read_b64_tr_b16 v[106:107], v142 offset:33792
  v_mfma_f32_32x32x16_bf16 v[64:79], v[124:127], v[136:139], v[64:79]
  ds_read_b64_tr_b16 v[108:109], v143 offset:32768
  ds_read_b64_tr_b16 v[110:111], v143 offset:33792
  s_waitcnt lgkmcnt(9)
  v_mfma_f32_32x32x16_bf16 v[16:31], v[80:83], v[128:131], v[16:31]
  ds_read_b128 v[136:139], v144 offset:33792
  ds_read_b64_tr_b16 v[112:113], v140 offset:36864
  ds_read_b64_tr_b16 v[114:115], v140 offset:37888
  v_mfma_f32_32x32x16_bf16 v[32:47], v[84:87], v[128:131], v[32:47]
  ds_read_b64_tr_b16 v[116:117], v141 offset:36864
  ds_read_b64_tr_b16 v[118:119], v141 offset:37888
  v_mfma_f32_32x32x16_bf16 v[48:63], v[88:91], v[128:131], v[48:63]
  ds_read_b64_tr_b16 v[120:121], v142 offset:36864
  ds_read_b64_tr_b16 v[122:123], v142 offset:37888
  v_mfma_f32_32x32x16_bf16 v[64:79], v[92:95], v[128:131], v[64:79]
  ds_read_b64_tr_b16 v[124:125], v143 offset:36864
  ds_read_b64_tr_b16 v[126:127], v143 offset:37888
  s_waitcnt lgkmcnt(9)
  v_mfma_f32_32x32x16_bf16 v[16:31], v[96:99], v[132:135], v[16:31]
  ds_read_b128 v[128:131], v144 offset:34816
  ds_read_b64_tr_b16 v[80:81], v140 offset:40960
  ds_read_b64_tr_b16 v[82:83], v140 offset:41984
  v_mfma_f32_32x32x16_bf16 v[32:47], v[100:103], v[132:135], v[32:47]
  ds_read_b64_tr_b16 v[84:85], v141 offset:40960
  ds_read_b64_tr_b16 v[86:87], v141 offset:41984
  v_mfma_f32_32x32x16_bf16 v[48:63], v[104:107], v[132:135], v[48:63]
  ds_read_b64_tr_b16 v[88:89], v142 offset:40960
  ds_read_b64_tr_b16 v[90:91], v142 offset:41984
  v_mfma_f32_32x32x16_bf16 v[64:79], v[108:111], v[132:135], v[64:79]
  ds_read_b64_tr_b16 v[92:93], v143 offset:40960
  ds_read_b64_tr_b16 v[94:95], v143 offset:41984
  s_waitcnt lgkmcnt(9)
  v_mfma_f32_32x32x16_bf16 v[16:31], v[112:115], v[136:139], v[16:31]
  ds_read_b128 v[132:135], v144 offset:35840
  ds_read_b64_tr_b16 v[96:97], v140 offset:45056
  ds_read_b64_tr_b16 v[98:99], v140 offset:46080
  v_mfma_f32_32x32x16_bf16 v[32:47], v[116:119], v[136:139], v[32:47]
  ds_read_b64_tr_b16 v[100:101], v141 offset:45056
  ds_read_b64_tr_b16 v[102:103], v141 offset:46080
  v_mfma_f32_32x32x16_bf16 v[48:63], v[120:123], v[136:139], v[48:63]
  ds_read_b64_tr_b16 v[104:105], v142 offset:45056
  ds_read_b64_tr_b16 v[106:107], v142 offset:46080
  v_mfma_f32_32x32x16_bf16 v[64:79], v[124:127], v[136:139], v[64:79]
  ds_read_b64_tr_b16 v[108:109], v143 offset:45056
  ds_read_b64_tr_b16 v[110:111], v143 offset:46080
  s_waitcnt lgkmcnt(9)
  s_barrier
  v_add_u32 v140, 0x10000, v140
  v_add_u32 v141, 0x10000, v141
  v_add_u32 v142, 0x10000, v142
  v_add_u32 v143, 0x10000, v143
  v_add_u32 v144, 0x10000, v144
  v_mfma_f32_32x32x16_bf16 v[16:31], v[80:83], v[128:131], v[16:31]
  ds_read_b128 v[136:139], v144 offset:0
  ds_read_b64_tr_b16 v[112:113], v140 offset:0
  ds_read_b64_tr_b16 v[114:115], v140 offset:1024
  v_mfma_f32_32x32x16_bf16 v[32:47], v[84:87], v[128:131], v[32:47]
  ds_read_b64_tr_b16 v[116:117], v141 offset:0
  ds_read_b64_tr_b16 v[118:119], v141 offset:1024
  v_mfma_f32_32x32x16_bf16 v[48:63], v[88:91], v[128:131], v[48:63]
  ds_read_b64_tr_b16 v[120:121], v142 offset:0
  ds_read_b64_tr_b16 v[122:123], v142 offset:1024
  v_mfma_f32_32x32x16_bf16 v[64:79], v[92:95], v[128:131], v[64:79]
  ds_read_b64_tr_b16 v[124:125], v143 offset:0
  ds_read_b64_tr_b16 v[126:127], v143 offset:1024
  s_waitcnt lgkmcnt(9)
  v_mfma_f32_32x32x16_bf16 v[16:31], v[96:99], v[132:135], v[16:31]
  ds_read_b128 v[128:131], v144 offset:1024
  ds_read_b64_tr_b16 v[80:81], v140 offset:4096
  ds_read_b64_tr_b16 v[82:83], v140 offset:5120
  v_mfma_f32_32x32x16_bf16 v[32:47], v[100:103], v[132:135], v[32:47]
  ds_read_b64_tr_b16 v[84:85], v141 offset:4096
  ds_read_b64_tr_b16 v[86:87], v141 offset:5120
  v_mfma_f32_32x32x16_bf16 v[48:63], v[104:107], v[132:135], v[48:63]
  ds_read_b64_tr_b16 v[88:89], v142 offset:4096
  ds_read_b64_tr_b16 v[90:91], v142 offset:5120
  v_mfma_f32_32x32x16_bf16 v[64:79], v[108:111], v[132:135], v[64:79]
  ds_read_b64_tr_b16 v[92:93], v143 offset:4096
  ds_read_b64_tr_b16 v[94:95], v143 offset:5120
  s_waitcnt lgkmcnt(9)
  v_mfma_f32_32x32x16_bf16 v[16:31], v[112:115], v[136:139], v[16:31]
  ds_read_b128 v[132:135], v144 offset:2048
  ds_read_b64_tr_b16 v[96:97], v140 offset:8192
  ds_read_b64_tr_b16 v[98:99], v140 offset:9216
  v_mfma_f32_32x32x16_bf16 v[32:47], v[116:119], v[136:139], v[32:47]
  ds_read_b64_tr_b16 v[100:101], v141 offset:8192
  ds_read_b64_tr_b16 v[102:103], v141 offset:9216
  v_mfma_f32_32x32x16_bf16 v[48:63], v[120:123], v[136:139], v[48:63]
  ds_read_b64_tr_b16 v[104:105], v142 offset:8192
  ds_read_b64_tr_b16 v[106:107], v142 offset:9216
  v_mfma_f32_32x32x16_bf16 v[64:79], v[124:127], v[136:139], v[64:79]
  ds_read_b64_tr_b16 v[108:109], v143 offset:8192
  ds_read_b64_tr_b16 v[110:111], v143 offset:9216
  s_waitcnt lgkmcnt(9)
  v_mfma_f32_32x32x16_bf16 v[16:31], v[80:83], v[128:131], v[16:31]
  ds_read_b128 v[136:139], v144 offset:3072
  ds_read_b64_tr_b16 v[112:113], v140 offset:12288
  ds_read_b64_tr_b16 v[114:115], v140 offset:13312
  v_mfma_f32_32x32x16_bf16 v[32:47], v[84:87], v[128:131], v[32:47]
  ds_read_b64_tr_b16 v[116:117], v141 offset:12288
  ds_read_b64_tr_b16 v[118:119], v141 offset:13312
  v_mfma_f32_32x32x16_bf16 v[48:63], v[88:91], v[128:131], v[48:63]
  ds_read_b64_tr_b16 v[120:121], v142 offset:12288
  ds_read_b64_tr_b16 v[122:123], v142 offset:13312
  v_mfma_f32_32x32x16_bf16 v[64:79], v[92:95], v[128:131], v[64:79]
  ds_read_b64_tr_b16 v[124:125], v143 offset:12288
  ds_read_b64_tr_b16 v[126:127], v143 offset:13312
  s_waitcnt lgkmcnt(9)
  s_barrier
  v_mfma_f32_32x32x16_bf16 v[16:31], v[96:99], v[132:135], v[16:31]
  ds_read_b128 v[128:131], v144 offset:32768
  ds_read_b64_tr_b16 v[80:81], v140 offset:32768
  ds_read_b64_tr_b16 v[82:83], v140 offset:33792
  v_mfma_f32_32x32x16_bf16 v[32:47], v[100:103], v[132:135], v[32:47]
  ds_read_b64_tr_b16 v[84:85], v141 offset:32768
  ds_read_b64_tr_b16 v[86:87], v141 offset:33792
  v_mfma_f32_32x32x16_bf16 v[48:63], v[104:107], v[132:135], v[48:63]
  ds_read_b64_tr_b16 v[88:89], v142 offset:32768
  ds_read_b64_tr_b16 v[90:91], v142 offset:33792
  v_mfma_f32_32x32x16_bf16 v[64:79], v[108:111], v[132:135], v[64:79]
  ds_read_b64_tr_b16 v[92:93], v143 offset:32768
  ds_read_b64_tr_b16 v[94:95], v143 offset:33792
  s_waitcnt lgkmcnt(9)
  v_mfma_f32_32x32x16_bf16 v[16:31], v[112:115], v[136:139], v[16:31]
  ds_read_b128 v[132:135], v144 offset:33792
  ds_read_b64_tr_b16 v[96:97], v140 offset:36864
  ds_read_b64_tr_b16 v[98:99], v140 offset:37888
  v_mfma_f32_32x32x16_bf16 v[32:47], v[116:119], v[136:139], v[32:47]
  ds_read_b64_tr_b16 v[100:101], v141 offset:36864
  ds_read_b64_tr_b16 v[102:103], v141 offset:37888
  v_mfma_f32_32x32x16_bf16 v[48:63], v[120:123], v[136:139], v[48:63]
  ds_read_b64_tr_b16 v[104:105], v142 offset:36864
  ds_read_b64_tr_b16 v[106:107], v142 offset:37888
  v_mfma_f32_32x32x16_bf16 v[64:79], v[124:127], v[136:139], v[64:79]
  ds_read_b64_tr_b16 v[108:109], v143 offset:36864
  ds_read_b64_tr_b16 v[110:111], v143 offset:37888
  s_waitcnt lgkmcnt(9)
  v_mfma_f32_32x32x16_bf16 v[16:31], v[80:83], v[128:131], v[16:31]
  ds_read_b128 v[136:139], v144 offset:34816
  ds_read_b64_tr_b16 v[112:113], v140 offset:40960
  ds_read_b64_tr_b16 v[114:115], v140 offset:41984
  v_mfma_f32_32x32x16_bf16 v[32:47], v[84:87], v[128:131], v[32:47]
  ds_read_b64_tr_b16 v[116:117], v141 offset:40960
  ds_read_b64_tr_b16 v[118:119], v141 offset:41984
  v_mfma_f32_32x32x16_bf16 v[48:63], v[88:91], v[128:131], v[48:63]
  ds_read_b64_tr_b16 v[120:121], v142 offset:40960
  ds_read_b64_tr_b16 v[122:123], v142 offset:41984
  v_mfma_f32_32x32x16_bf16 v[64:79], v[92:95], v[128:131], v[64:79]
  ds_read_b64_tr_b16 v[124:125], v143 offset:40960
  ds_read_b64_tr_b16 v[126:127], v143 offset:41984
  s_waitcnt lgkmcnt(9)
  v_mfma_f32_32x32x16_bf16 v[16:31], v[96:99], v[132:135], v[16:31]
  ds_read_b128 v[128:131], v144 offset:35840
  ds_read_b64_tr_b16 v[80:81], v140 offset:45056
  ds_read_b64_tr_b16 v[82:83], v140 offset:46080
  v_mfma_f32_32x32x16_bf16 v[32:47], v[100:103], v[132:135], v[32:47]
  ds_read_b64_tr_b16 v[84:85], v141 offset:45056
  ds_read_b64_tr_b16 v[86:87], v141 offset:46080
  v_mfma_f32_32x32x16_bf16 v[48:63], v[104:107], v[132:135], v[48:63]
  ds_read_b64_tr_b16 v[88:89], v142 offset:45056
  ds_read_b64_tr_b16 v[90:91], v142 offset:46080
  v_mfma_f32_32x32x16_bf16 v[64:79], v[108:111], v[132:135], v[64:79]
  ds_read_b64_tr_b16 v[92:93], v143 offset:45056
  ds_read_b64_tr_b16 v[94:95], v143 offset:46080
  s_waitcnt lgkmcnt(9)
  s_barrier
  v_add_u32 v140, 0xffff0000, v140
  v_add_u32 v141, 0xffff0000, v141
  v_add_u32 v142, 0xffff0000, v142
  v_add_u32 v143, 0xffff0000, v143
  v_add_u32 v144, 0xffff0000, v144
  v_mfma_f32_32x32x16_bf16 v[16:31], v[112:115], v[136:139], v[16:31]
  ds_read_b128 v[132:135], v144 offset:0
  ds_read_b64_tr_b16 v[96:97], v140 offset:0
  ds_read_b64_tr_b16 v[98:99], v140 offset:1024
  v_mfma_f32_32x32x16_bf16 v[32:47], v[116:119], v[136:139], v[32:47]
  ds_read_b64_tr_b16 v[100:101], v141 offset:0
  ds_read_b64_tr_b16 v[102:103], v141 offset:1024
  v_mfma_f32_32x32x16_bf16 v[48:63], v[120:123], v[136:139], v[48:63]
  ds_read_b64_tr_b16 v[104:105], v142 offset:0
  ds_read_b64_tr_b16 v[106:107], v142 offset:1024
  v_mfma_f32_32x32x16_bf16 v[64:79], v[124:127], v[136:139], v[64:79]
  ds_read_b64_tr_b16 v[108:109], v143 offset:0
  ds_read_b64_tr_b16 v[110:111], v143 offset:1024
  s_waitcnt lgkmcnt(9)
  v_mfma_f32_32x32x16_bf16 v[16:31], v[80:83], v[128:131], v[16:31]
  ds_read_b128 v[136:139], v144 offset:1024
  ds_read_b64_tr_b16 v[112:113], v140 offset:4096
  ds_read_b64_tr_b16 v[114:115], v140 offset:5120
  v_mfma_f32_32x32x16_bf16 v[32:47], v[84:87], v[128:131], v[32:47]
  ds_read_b64_tr_b16 v[116:117], v141 offset:4096
  ds_read_b64_tr_b16 v[118:119], v141 offset:5120
  v_mfma_f32_32x32x16_bf16 v[48:63], v[88:91], v[128:131], v[48:63]
  ds_read_b64_tr_b16 v[120:121], v142 offset:4096
  ds_read_b64_tr_b16 v[122:123], v142 offset:5120
  v_mfma_f32_32x32x16_bf16 v[64:79], v[92:95], v[128:131], v[64:79]
  ds_read_b64_tr_b16 v[124:125], v143 offset:4096
  ds_read_b64_tr_b16 v[126:127], v143 offset:5120
  s_waitcnt lgkmcnt(9)
  v_mfma_f32_32x32x16_bf16 v[16:31], v[96:99], v[132:135], v[16:31]
  ds_read_b128 v[128:131], v144 offset:2048
  ds_read_b64_tr_b16 v[80:81], v140 offset:8192
  ds_read_b64_tr_b16 v[82:83], v140 offset:9216
  v_mfma_f32_32x32x16_bf16 v[32:47], v[100:103], v[132:135], v[32:47]
  ds_read_b64_tr_b16 v[84:85], v141 offset:8192
  ds_read_b64_tr_b16 v[86:87], v141 offset:9216
  v_mfma_f32_32x32x16_bf16 v[48:63], v[104:107], v[132:135], v[48:63]
  ds_read_b64_tr_b16 v[88:89], v142 offset:8192
  ds_read_b64_tr_b16 v[90:91], v142 offset:9216
  v_mfma_f32_32x32x16_bf16 v[64:79], v[108:111], v[132:135], v[64:79]
  ds_read_b64_tr_b16 v[92:93], v143 offset:8192
  ds_read_b64_tr_b16 v[94:95], v143 offset:9216
  s_waitcnt lgkmcnt(9)
  v_mfma_f32_32x32x16_bf16 v[16:31], v[112:115], v[136:139], v[16:31]
  ds_read_b128 v[132:135], v144 offset:3072
  ds_read_b64_tr_b16 v[96:97], v140 offset:12288
  ds_read_b64_tr_b16 v[98:99], v140 offset:13312
  v_mfma_f32_32x32x16_bf16 v[32:47], v[116:119], v[136:139], v[32:47]
  ds_read_b64_tr_b16 v[100:101], v141 offset:12288
  ds_read_b64_tr_b16 v[102:103], v141 offset:13312
  v_mfma_f32_32x32x16_bf16 v[48:63], v[120:123], v[136:139], v[48:63]
  ds_read_b64_tr_b16 v[104:105], v142 offset:12288
  ds_read_b64_tr_b16 v[106:107], v142 offset:13312
  v_mfma_f32_32x32x16_bf16 v[64:79], v[124:127], v[136:139], v[64:79]
  ds_read_b64_tr_b16 v[108:109], v143 offset:12288
  ds_read_b64_tr_b16 v[110:111], v143 offset:13312
  s_waitcnt lgkmcnt(9)
  s_barrier
  v_mfma_f32_32x32x16_bf16 v[16:31], v[80:83], v[128:131], v[16:31]
  ds_read_b128 v[136:139], v144 offset:32768
  ds_read_b64_tr_b16 v[112:113], v140 offset:32768
  ds_read_b64_tr_b16 v[114:115], v140 offset:33792
  v_mfma_f32_32x32x16_bf16 v[32:47], v[84:87], v[128:131], v[32:47]
  ds_read_b64_tr_b16 v[116:117], v141 offset:32768
  ds_read_b64_tr_b16 v[118:119], v141 offset:33792
  v_mfma_f32_32x32x16_bf16 v[48:63], v[88:91], v[128:131], v[48:63]
  ds_read_b64_tr_b16 v[120:121], v142 offset:32768
  ds_read_b64_tr_b16 v[122:123], v142 offset:33792
  v_mfma_f32_32x32x16_bf16 v[64:79], v[92:95], v[128:131], v[64:79]
  ds_read_b64_tr_b16 v[124:125], v143 offset:32768
  ds_read_b64_tr_b16 v[126:127], v143 offset:33792
  s_waitcnt lgkmcnt(9)
  v_mfma_f32_32x32x16_bf16 v[16:31], v[96:99], v[132:135], v[16:31]
  ds_read_b128 v[128:131], v144 offset:33792
  ds_read_b64_tr_b16 v[80:81], v140 offset:36864
  ds_read_b64_tr_b16 v[82:83], v140 offset:37888
  v_mfma_f32_32x32x16_bf16 v[32:47], v[100:103], v[132:135], v[32:47]
  ds_read_b64_tr_b16 v[84:85], v141 offset:36864
  ds_read_b64_tr_b16 v[86:87], v141 offset:37888
  v_mfma_f32_32x32x16_bf16 v[48:63], v[104:107], v[132:135], v[48:63]
  ds_read_b64_tr_b16 v[88:89], v142 offset:36864
  ds_read_b64_tr_b16 v[90:91], v142 offset:37888
  v_mfma_f32_32x32x16_bf16 v[64:79], v[108:111], v[132:135], v[64:79]
  ds_read_b64_tr_b16 v[92:93], v143 offset:36864
  ds_read_b64_tr_b16 v[94:95], v143 offset:37888
  s_waitcnt lgkmcnt(9)
  v_mfma_f32_32x32x16_bf16 v[16:31], v[112:115], v[136:139], v[16:31]
  ds_read_b128 v[132:135], v144 offset:34816
  ds_read_b64_tr_b16 v[96:97], v140 offset:40960
  ds_read_b64_tr_b16 v[98:99], v140 offset:41984
  v_mfma_f32_32x32x16_bf16 v[32:47], v[116:119], v[136:139], v[32:47]
  ds_read_b64_tr_b16 v[100:101], v141 offset:40960
  ds_read_b64_tr_b16 v[102:103], v141 offset:41984
  v_mfma_f32_32x32x16_bf16 v[48:63], v[120:123], v[136:139], v[48:63]
  ds_read_b64_tr_b16 v[104:105], v142 offset:40960
  ds_read_b64_tr_b16 v[106:107], v142 offset:41984
  v_mfma_f32_32x32x16_bf16 v[64:79], v[124:127], v[136:139], v[64:79]
  ds_read_b64_tr_b16 v[108:109], v143 offset:40960
  ds_read_b64_tr_b16 v[110:111], v143 offset:41984
  s_waitcnt lgkmcnt(9)
  v_mfma_f32_32x32x16_bf16 v[16:31], v[80:83], v[128:131], v[16:31]
  ds_read_b128 v[136:139], v144 offset:35840
  ds_read_b64_tr_b16 v[112:113], v140 offset:45056
  ds_read_b64_tr_b16 v[114:115], v140 offset:46080
  v_mfma_f32_32x32x16_bf16 v[32:47], v[84:87], v[128:131], v[32:47]
  ds_read_b64_tr_b16 v[116:117], v141 offset:45056
  ds_read_b64_tr_b16 v[118:119], v141 offset:46080
  v_mfma_f32_32x32x16_bf16 v[48:63], v[88:91], v[128:131], v[48:63]
  ds_read_b64_tr_b16 v[120:121], v142 offset:45056
  ds_read_b64_tr_b16 v[122:123], v142 offset:46080
  v_mfma_f32_32x32x16_bf16 v[64:79], v[92:95], v[128:131], v[64:79]
  ds_read_b64_tr_b16 v[124:125], v143 offset:45056
  ds_read_b64_tr_b16 v[126:127], v143 offset:46080
  s_waitcnt lgkmcnt(9)
  s_barrier
  v_add_u32 v140, 0x10000, v140
  v_add_u32 v141, 0x10000, v141
  v_add_u32 v142, 0x10000, v142
  v_add_u32 v143, 0x10000, v143
  v_add_u32 v144, 0x10000, v144
  v_mfma_f32_32x32x16_bf16 v[16:31], v[96:99], v[132:135], v[16:31]
  ds_read_b128 v[128:131], v144 offset:0
  ds_read_b64_tr_b16 v[80:81], v140 offset:0
  ds_read_b64_tr_b16 v[82:83], v140 offset:1024
  v_mfma_f32_32x32x16_bf16 v[32:47], v[100:103], v[132:135], v[32:47]
  ds_read_b64_tr_b16 v[84:85], v141 offset:0
  ds_read_b64_tr_b16 v[86:87], v141 offset:1024
  v_mfma_f32_32x32x16_bf16 v[48:63], v[104:107], v[132:135], v[48:63]
  ds_read_b64_tr_b16 v[88:89], v142 offset:0
  ds_read_b64_tr_b16 v[90:91], v142 offset:1024
  v_mfma_f32_32x32x16_bf16 v[64:79], v[108:111], v[132:135], v[64:79]
  ds_read_b64_tr_b16 v[92:93], v143 offset:0
  ds_read_b64_tr_b16 v[94:95], v143 offset:1024
  s_waitcnt lgkmcnt(9)
  v_mfma_f32_32x32x16_bf16 v[16:31], v[112:115], v[136:139], v[16:31]
  ds_read_b128 v[132:135], v144 offset:1024
  ds_read_b64_tr_b16 v[96:97], v140 offset:4096
  ds_read_b64_tr_b16 v[98:99], v140 offset:5120
  v_mfma_f32_32x32x16_bf16 v[32:47], v[116:119], v[136:139], v[32:47]
  ds_read_b64_tr_b16 v[100:101], v141 offset:4096
  ds_read_b64_tr_b16 v[102:103], v141 offset:5120
  v_mfma_f32_32x32x16_bf16 v[48:63], v[120:123], v[136:139], v[48:63]
  ds_read_b64_tr_b16 v[104:105], v142 offset:4096
  ds_read_b64_tr_b16 v[106:107], v142 offset:5120
  v_mfma_f32_32x32x16_bf16 v[64:79], v[124:127], v[136:139], v[64:79]
  ds_read_b64_tr_b16 v[108:109], v143 offset:4096
  ds_read_b64_tr_b16 v[110:111], v143 offset:5120
  s_waitcnt lgkmcnt(9)
  v_mfma_f32_32x32x16_bf16 v[16:31], v[80:83], v[128:131], v[16:31]
  ds_read_b128 v[136:139], v144 offset:2048
  ds_read_b64_tr_b16 v[112:113], v140 offset:8192
  ds_read_b64_tr_b16 v[114:115], v140 offset:9216
  v_mfma_f32_32x32x16_bf16 v[32:47], v[84:87], v[128:131], v[32:47]
  ds_read_b64_tr_b16 v[116:117], v141 offset:8192
  ds_read_b64_tr_b16 v[118:119], v141 offset:9216
  v_mfma_f32_32x32x16_bf16 v[48:63], v[88:91], v[128:131], v[48:63]
  ds_read_b64_tr_b16 v[120:121], v142 offset:8192
  ds_read_b64_tr_b16 v[122:123], v142 offset:9216
  v_mfma_f32_32x32x16_bf16 v[64:79], v[92:95], v[128:131], v[64:79]
  ds_read_b64_tr_b16 v[124:125], v143 offset:8192
  ds_read_b64_tr_b16 v[126:127], v143 offset:9216
  s_waitcnt lgkmcnt(9)
  v_mfma_f32_32x32x16_bf16 v[16:31], v[96:99], v[132:135], v[16:31]
  ds_read_b128 v[128:131], v144 offset:3072
  ds_read_b64_tr_b16 v[80:81], v140 offset:12288
  ds_read_b64_tr_b16 v[82:83], v140 offset:13312
  v_mfma_f32_32x32x16_bf16 v[32:47], v[100:103], v[132:135], v[32:47]
  ds_read_b64_tr_b16 v[84:85], v141 offset:12288
  ds_read_b64_tr_b16 v[86:87], v141 offset:13312
  v_mfma_f32_32x32x16_bf16 v[48:63], v[104:107], v[132:135], v[48:63]
  ds_read_b64_tr_b16 v[88:89], v142 offset:12288
  ds_read_b64_tr_b16 v[90:91], v142 offset:13312
  v_mfma_f32_32x32x16_bf16 v[64:79], v[108:111], v[132:135], v[64:79]
  ds_read_b64_tr_b16 v[92:93], v143 offset:12288
  ds_read_b64_tr_b16 v[94:95], v143 offset:13312
  s_waitcnt lgkmcnt(9)
  s_barrier
  v_mfma_f32_32x32x16_bf16 v[16:31], v[112:115], v[136:139], v[16:31]
  ds_read_b128 v[132:135], v144 offset:32768
  ds_read_b64_tr_b16 v[96:97], v140 offset:32768
  ds_read_b64_tr_b16 v[98:99], v140 offset:33792
  v_mfma_f32_32x32x16_bf16 v[32:47], v[116:119], v[136:139], v[32:47]
  ds_read_b64_tr_b16 v[100:101], v141 offset:32768
  ds_read_b64_tr_b16 v[102:103], v141 offset:33792
  v_mfma_f32_32x32x16_bf16 v[48:63], v[120:123], v[136:139], v[48:63]
  ds_read_b64_tr_b16 v[104:105], v142 offset:32768
  ds_read_b64_tr_b16 v[106:107], v142 offset:33792
  v_mfma_f32_32x32x16_bf16 v[64:79], v[124:127], v[136:139], v[64:79]
  ds_read_b64_tr_b16 v[108:109], v143 offset:32768
  ds_read_b64_tr_b16 v[110:111], v143 offset:33792
  s_waitcnt lgkmcnt(9)
  v_mfma_f32_32x32x16_bf16 v[16:31], v[80:83], v[128:131], v[16:31]
  ds_read_b128 v[136:139], v144 offset:33792
  ds_read_b64_tr_b16 v[112:113], v140 offset:36864
  ds_read_b64_tr_b16 v[114:115], v140 offset:37888
  v_mfma_f32_32x32x16_bf16 v[32:47], v[84:87], v[128:131], v[32:47]
  ds_read_b64_tr_b16 v[116:117], v141 offset:36864
  ds_read_b64_tr_b16 v[118:119], v141 offset:37888
  v_mfma_f32_32x32x16_bf16 v[48:63], v[88:91], v[128:131], v[48:63]
  ds_read_b64_tr_b16 v[120:121], v142 offset:36864
  ds_read_b64_tr_b16 v[122:123], v142 offset:37888
  v_mfma_f32_32x32x16_bf16 v[64:79], v[92:95], v[128:131], v[64:79]
  ds_read_b64_tr_b16 v[124:125], v143 offset:36864
  ds_read_b64_tr_b16 v[126:127], v143 offset:37888
  s_waitcnt lgkmcnt(9)
  v_mfma_f32_32x32x16_bf16 v[16:31], v[96:99], v[132:135], v[16:31]
  ds_read_b128 v[128:131], v144 offset:34816
  ds_read_b64_tr_b16 v[80:81], v140 offset:40960
  ds_read_b64_tr_b16 v[82:83], v140 offset:41984
  v_mfma_f32_32x32x16_bf16 v[32:47], v[100:103], v[132:135], v[32:47]
  ds_read_b64_tr_b16 v[84:85], v141 offset:40960
  ds_read_b64_tr_b16 v[86:87], v141 offset:41984
  v_mfma_f32_32x32x16_bf16 v[48:63], v[104:107], v[132:135], v[48:63]
  ds_read_b64_tr_b16 v[88:89], v142 offset:40960
  ds_read_b64_tr_b16 v[90:91], v142 offset:41984
  v_mfma_f32_32x32x16_bf16 v[64:79], v[108:111], v[132:135], v[64:79]
  ds_read_b64_tr_b16 v[92:93], v143 offset:40960
  ds_read_b64_tr_b16 v[94:95], v143 offset:41984
  s_waitcnt lgkmcnt(9)
  v_mfma_f32_32x32x16_bf16 v[16:31], v[112:115], v[136:139], v[16:31]
  ds_read_b128 v[132:135], v144 offset:35840
  ds_read_b64_tr_b16 v[96:97], v140 offset:45056
  ds_read_b64_tr_b16 v[98:99], v140 offset:46080
  v_mfma_f32_32x32x16_bf16 v[32:47], v[116:119], v[136:139], v[32:47]
  ds_read_b64_tr_b16 v[100:101], v141 offset:45056
  ds_read_b64_tr_b16 v[102:103], v141 offset:46080
  v_mfma_f32_32x32x16_bf16 v[48:63], v[120:123], v[136:139], v[48:63]
  ds_read_b64_tr_b16 v[104:105], v142 offset:45056
  ds_read_b64_tr_b16 v[106:107], v142 offset:46080
  v_mfma_f32_32x32x16_bf16 v[64:79], v[124:127], v[136:139], v[64:79]
  ds_read_b64_tr_b16 v[108:109], v143 offset:45056
  ds_read_b64_tr_b16 v[110:111], v143 offset:46080
  s_waitcnt lgkmcnt(9)
  v_mfma_f32_32x32x16_bf16 v[16:31], v[80:83], v[128:131], v[16:31]
  v_mfma_f32_32x32x16_bf16 v[32:47], v[84:87], v[128:131], v[32:47]
  v_mfma_f32_32x32x16_bf16 v[48:63], v[88:91], v[128:131], v[48:63]
  v_mfma_f32_32x32x16_bf16 v[64:79], v[92:95], v[128:131], v[64:79]
  s_waitcnt lgkmcnt(0)
  v_mfma_f32_32x32x16_bf16 v[16:31], v[96:99], v[132:135], v[16:31]
  v_mfma_f32_32x32x16_bf16 v[32:47], v[100:103], v[132:135], v[32:47]
  v_mfma_f32_32x32x16_bf16 v[48:63], v[104:107], v[132:135], v[48:63]
  v_mfma_f32_32x32x16_bf16 v[64:79], v[108:111], v[132:135], v[64:79]
  v_and_b32 v10, 31, v1
  s_lshl_b32 s30, s22, 7
  v_lshl_add_u32 v10, v10, 2, s30
  v_add_u32 v10, 131584, v10
  ds_read_b32 v12, v10
  ds_read_b32 v13, v10 offset:512
  s_waitcnt lgkmcnt(0)
  v_mul_f32 v12, 0x3b000000, v12
  v_mul_f32 v13, 0x3b000000, v13
  v_fma_f32 v13, -v12, v12, v13
  v_add_f32 v14, 0x3727c5ac, v13
  v_rsq_f32 v14, v14
  s_nop 0
  v_add_f32 v14, 1.0, v14
  v_mul_f32 v15, v14, v14
  v_mul_f32 v15, v15, v13
  v_add_f32 v15, 0x3727c5ac, v15
  v_rsq_f32 v15, v15
  s_nop 0
  v_mul_f32 v13, v14, v15
  s_cmp_lt_u32 s24, 4
  s_cselect_b32 s30, 0x3eb8aa3b, 1.0
  v_mul_f32 v13, s30, v13
  v_mul_f32 v14, v12, v13
  v_lshlrev_b32 v11, 4, v6
  v_add_u32 v11, 131072, v11
  s_and_b32 s30, s24, 3
  s_lshl_b32 s30, s30, 9
  s_add_u32 s30, s30, s25
  s_lshl_b32 s30, s30, 10
  s_cmp_lt_u32 s24, 4
  s_mov_b32 s31, 0xa00000
  s_cselect_b32 s31, 0x800000, s31
  s_add_u32 s30, s30, s31
  v_lshlrev_b32 v9, 4, v1
  ds_read_b128 v[80:83], v11 offset:0
  ds_read_b128 v[84:87], v11 offset:32
  ds_read_b128 v[88:91], v11 offset:64
  ds_read_b128 v[92:95], v11 offset:96
  s_waitcnt lgkmcnt(0)
  v_mul_f32 v16, v13, v16
  v_fma_f32 v16, -v14, v80, v16
  v_mul_f32 v17, v13, v17
  v_fma_f32 v17, -v14, v81, v17
  v_mul_f32 v18, v13, v18
  v_fma_f32 v18, -v14, v82, v18
  v_mul_f32 v19, v13, v19
  v_fma_f32 v19, -v14, v83, v19
  v_mul_f32 v20, v13, v20
  v_fma_f32 v20, -v14, v84, v20
  v_mul_f32 v21, v13, v21
  v_fma_f32 v21, -v14, v85, v21
  v_mul_f32 v22, v13, v22
  v_fma_f32 v22, -v14, v86, v22
  v_mul_f32 v23, v13, v23
  v_fma_f32 v23, -v14, v87, v23
  v_mul_f32 v24, v13, v24
  v_fma_f32 v24, -v14, v88, v24
  v_mul_f32 v25, v13, v25
  v_fma_f32 v25, -v14, v89, v25
  v_mul_f32 v26, v13, v26
  v_fma_f32 v26, -v14, v90, v26
  v_mul_f32 v27, v13, v27
  v_fma_f32 v27, -v14, v91, v27
  v_mul_f32 v28, v13, v28
  v_fma_f32 v28, -v14, v92, v28
  v_mul_f32 v29, v13, v29
  v_fma_f32 v29, -v14, v93, v29
  v_mul_f32 v30, v13, v30
  v_fma_f32 v30, -v14, v94, v30
  v_mul_f32 v31, v13, v31
  v_fma_f32 v31, -v14, v95, v31
  v_cvt_pk_bf16_f32 v112, v16, v17
  v_cvt_pk_bf16_f32 v113, v18, v19
  v_cvt_pk_bf16_f32 v114, v20, v21
  v_cvt_pk_bf16_f32 v115, v22, v23
  v_cvt_pk_bf16_f32 v116, v24, v25
  v_cvt_pk_bf16_f32 v117, v26, v27
  v_cvt_pk_bf16_f32 v118, v28, v29
  v_cvt_pk_bf16_f32 v119, v30, v31
  s_add_u32 s31, s30, 0
  s_add_u32 s32, s31, 65536
  buffer_store_dwordx4 v[112:115], v9, s[16:19], s31 offen sc1
  buffer_store_dwordx4 v[116:119], v9, s[16:19], s32 offen sc1
  ds_read_b128 v[96:99], v11 offset:128
  ds_read_b128 v[100:103], v11 offset:160
  ds_read_b128 v[104:107], v11 offset:192
  ds_read_b128 v[108:111], v11 offset:224
  s_waitcnt lgkmcnt(0)
  v_mul_f32 v32, v13, v32
  v_fma_f32 v32, -v14, v96, v32
  v_mul_f32 v33, v13, v33
  v_fma_f32 v33, -v14, v97, v33
  v_mul_f32 v34, v13, v34
  v_fma_f32 v34, -v14, v98, v34
  v_mul_f32 v35, v13, v35
  v_fma_f32 v35, -v14, v99, v35
  v_mul_f32 v36, v13, v36
  v_fma_f32 v36, -v14, v100, v36
  v_mul_f32 v37, v13, v37
  v_fma_f32 v37, -v14, v101, v37
  v_mul_f32 v38, v13, v38
  v_fma_f32 v38, -v14, v102, v38
  v_mul_f32 v39, v13, v39
  v_fma_f32 v39, -v14, v103, v39
  v_mul_f32 v40, v13, v40
  v_fma_f32 v40, -v14, v104, v40
  v_mul_f32 v41, v13, v41
  v_fma_f32 v41, -v14, v105, v41
  v_mul_f32 v42, v13, v42
  v_fma_f32 v42, -v14, v106, v42
  v_mul_f32 v43, v13, v43
  v_fma_f32 v43, -v14, v107, v43
  v_mul_f32 v44, v13, v44
  v_fma_f32 v44, -v14, v108, v44
  v_mul_f32 v45, v13, v45
  v_fma_f32 v45, -v14, v109, v45
  v_mul_f32 v46, v13, v46
  v_fma_f32 v46, -v14, v110, v46
  v_mul_f32 v47, v13, v47
  v_fma_f32 v47, -v14, v111, v47
  v_cvt_pk_bf16_f32 v120, v32, v33
  v_cvt_pk_bf16_f32 v121, v34, v35
  v_cvt_pk_bf16_f32 v122, v36, v37
  v_cvt_pk_bf16_f32 v123, v38, v39
  v_cvt_pk_bf16_f32 v124, v40, v41
  v_cvt_pk_bf16_f32 v125, v42, v43
  v_cvt_pk_bf16_f32 v126, v44, v45
  v_cvt_pk_bf16_f32 v127, v46, v47
  s_add_u32 s31, s30, 131072
  s_add_u32 s32, s31, 65536
  buffer_store_dwordx4 v[120:123], v9, s[16:19], s31 offen sc1
  buffer_store_dwordx4 v[124:127], v9, s[16:19], s32 offen sc1
  ds_read_b128 v[80:83], v11 offset:256
  ds_read_b128 v[84:87], v11 offset:288
  ds_read_b128 v[88:91], v11 offset:320
  ds_read_b128 v[92:95], v11 offset:352
  s_waitcnt lgkmcnt(0)
  v_mul_f32 v48, v13, v48
  v_fma_f32 v48, -v14, v80, v48
  v_mul_f32 v49, v13, v49
  v_fma_f32 v49, -v14, v81, v49
  v_mul_f32 v50, v13, v50
  v_fma_f32 v50, -v14, v82, v50
  v_mul_f32 v51, v13, v51
  v_fma_f32 v51, -v14, v83, v51
  v_mul_f32 v52, v13, v52
  v_fma_f32 v52, -v14, v84, v52
  v_mul_f32 v53, v13, v53
  v_fma_f32 v53, -v14, v85, v53
  v_mul_f32 v54, v13, v54
  v_fma_f32 v54, -v14, v86, v54
  v_mul_f32 v55, v13, v55
  v_fma_f32 v55, -v14, v87, v55
  v_mul_f32 v56, v13, v56
  v_fma_f32 v56, -v14, v88, v56
  v_mul_f32 v57, v13, v57
  v_fma_f32 v57, -v14, v89, v57
  v_mul_f32 v58, v13, v58
  v_fma_f32 v58, -v14, v90, v58
  v_mul_f32 v59, v13, v59
  v_fma_f32 v59, -v14, v91, v59
  v_mul_f32 v60, v13, v60
  v_fma_f32 v60, -v14, v92, v60
  v_mul_f32 v61, v13, v61
  v_fma_f32 v61, -v14, v93, v61
  v_mul_f32 v62, v13, v62
  v_fma_f32 v62, -v14, v94, v62
  v_mul_f32 v63, v13, v63
  v_fma_f32 v63, -v14, v95, v63
  v_cvt_pk_bf16_f32 v112, v48, v49
  v_cvt_pk_bf16_f32 v113, v50, v51
  v_cvt_pk_bf16_f32 v114, v52, v53
  v_cvt_pk_bf16_f32 v115, v54, v55
  v_cvt_pk_bf16_f32 v116, v56, v57
  v_cvt_pk_bf16_f32 v117, v58, v59
  v_cvt_pk_bf16_f32 v118, v60, v61
  v_cvt_pk_bf16_f32 v119, v62, v63
  s_add_u32 s31, s30, 262144
  s_add_u32 s32, s31, 65536
  buffer_store_dwordx4 v[112:115], v9, s[16:19], s31 offen sc1
  buffer_store_dwordx4 v[116:119], v9, s[16:19], s32 offen sc1
  ds_read_b128 v[96:99], v11 offset:384
  ds_read_b128 v[100:103], v11 offset:416
  ds_read_b128 v[104:107], v11 offset:448
  ds_read_b128 v[108:111], v11 offset:480
  s_waitcnt lgkmcnt(0)
  v_mul_f32 v64, v13, v64
  v_fma_f32 v64, -v14, v96, v64
  v_mul_f32 v65, v13, v65
  v_fma_f32 v65, -v14, v97, v65
  v_mul_f32 v66, v13, v66
  v_fma_f32 v66, -v14, v98, v66
  v_mul_f32 v67, v13, v67
  v_fma_f32 v67, -v14, v99, v67
  v_mul_f32 v68, v13, v68
  v_fma_f32 v68, -v14, v100, v68
  v_mul_f32 v69, v13, v69
  v_fma_f32 v69, -v14, v101, v69
  v_mul_f32 v70, v13, v70
  v_fma_f32 v70, -v14, v102, v70
  v_mul_f32 v71, v13, v71
  v_fma_f32 v71, -v14, v103, v71
  v_mul_f32 v72, v13, v72
  v_fma_f32 v72, -v14, v104, v72
  v_mul_f32 v73, v13, v73
  v_fma_f32 v73, -v14, v105, v73
  v_mul_f32 v74, v13, v74
  v_fma_f32 v74, -v14, v106, v74
  v_mul_f32 v75, v13, v75
  v_fma_f32 v75, -v14, v107, v75
  v_mul_f32 v76, v13, v76
  v_fma_f32 v76, -v14, v108, v76
  v_mul_f32 v77, v13, v77
  v_fma_f32 v77, -v14, v109, v77
  v_mul_f32 v78, v13, v78
  v_fma_f32 v78, -v14, v110, v78
  v_mul_f32 v79, v13, v79
  v_fma_f32 v79, -v14, v111, v79
  v_cvt_pk_bf16_f32 v120, v64, v65
  v_cvt_pk_bf16_f32 v121, v66, v67
  v_cvt_pk_bf16_f32 v122, v68, v69
  v_cvt_pk_bf16_f32 v123, v70, v71
  v_cvt_pk_bf16_f32 v124, v72, v73
  v_cvt_pk_bf16_f32 v125, v74, v75
  v_cvt_pk_bf16_f32 v126, v76, v77
  v_cvt_pk_bf16_f32 v127, v78, v79
  s_add_u32 s31, s30, 393216
  s_add_u32 s32, s31, 65536
  buffer_store_dwordx4 v[120:123], v9, s[16:19], s31 offen sc1
  buffer_store_dwordx4 v[124:127], v9, s[16:19], s32 offen sc1
  s_branch qkv2_kernel_done
qkv2_kernel_vtype:
  s_barrier
  ds_read_b128 v[128:131], v144 offset:0
  ds_read_b64_tr_b16 v[80:81], v140 offset:0
  ds_read_b64_tr_b16 v[82:83], v140 offset:1024
  ds_read_b64_tr_b16 v[84:85], v141 offset:0
  ds_read_b64_tr_b16 v[86:87], v141 offset:1024
  ds_read_b64_tr_b16 v[88:89], v142 offset:0
  ds_read_b64_tr_b16 v[90:91], v142 offset:1024
  ds_read_b64_tr_b16 v[92:93], v143 offset:0
  ds_read_b64_tr_b16 v[94:95], v143 offset:1024
  ds_read_b128 v[132:135], v144 offset:1024
  ds_read_b64_tr_b16 v[96:97], v140 offset:4096
  ds_read_b64_tr_b16 v[98:99], v140 offset:5120
  ds_read_b64_tr_b16 v[100:101], v141 offset:4096
  ds_read_b64_tr_b16 v[102:103], v141 offset:5120
  ds_read_b64_tr_b16 v[104:105], v142 offset:4096
  ds_read_b64_tr_b16 v[106:107], v142 offset:5120
  ds_read_b64_tr_b16 v[108:109], v143 offset:4096
  ds_read_b64_tr_b16 v[110:111], v143 offset:5120
  s_waitcnt lgkmcnt(9)
  v_mfma_f32_32x32x16_bf16 v[16:31], v[128:131], v[80:83], 0
  ds_read_b128 v[136:139], v144 offset:2048
  ds_read_b64_tr_b16 v[112:113], v140 offset:8192
  ds_read_b64_tr_b16 v[114:115], v140 offset:9216
  v_mfma_f32_32x32x16_bf16 v[32:47], v[128:131], v[84:87], 0
  ds_read_b64_tr_b16 v[116:117], v141 offset:8192
  ds_read_b64_tr_b16 v[118:119], v141 offset:9216
  v_mfma_f32_32x32x16_bf16 v[48:63], v[128:131], v[88:91], 0
  ds_read_b64_tr_b16 v[120:121], v142 offset:8192
  ds_read_b64_tr_b16 v[122:123], v142 offset:9216
  v_mfma_f32_32x32x16_bf16 v[64:79], v[128:131], v[92:95], 0
  ds_read_b64_tr_b16 v[124:125], v143 offset:8192
  ds_read_b64_tr_b16 v[126:127], v143 offset:9216
  s_waitcnt lgkmcnt(9)
  v_mfma_f32_32x32x16_bf16 v[16:31], v[132:135], v[96:99], v[16:31]
  ds_read_b128 v[128:131], v144 offset:3072
  ds_read_b64_tr_b16 v[80:81], v140 offset:12288
  ds_read_b64_tr_b16 v[82:83], v140 offset:13312
  v_mfma_f32_32x32x16_bf16 v[32:47], v[132:135], v[100:103], v[32:47]
  ds_read_b64_tr_b16 v[84:85], v141 offset:12288
  ds_read_b64_tr_b16 v[86:87], v141 offset:13312
  v_mfma_f32_32x32x16_bf16 v[48:63], v[132:135], v[104:107], v[48:63]
  ds_read_b64_tr_b16 v[88:89], v142 offset:12288
  ds_read_b64_tr_b16 v[90:91], v142 offset:13312
  v_mfma_f32_32x32x16_bf16 v[64:79], v[132:135], v[108:111], v[64:79]
  ds_read_b64_tr_b16 v[92:93], v143 offset:12288
  ds_read_b64_tr_b16 v[94:95], v143 offset:13312
  s_waitcnt lgkmcnt(9)
  s_barrier
  v_mfma_f32_32x32x16_bf16 v[16:31], v[136:139], v[112:115], v[16:31]
  ds_read_b128 v[132:135], v144 offset:32768
  ds_read_b64_tr_b16 v[96:97], v140 offset:32768
  ds_read_b64_tr_b16 v[98:99], v140 offset:33792
  v_mfma_f32_32x32x16_bf16 v[32:47], v[136:139], v[116:119], v[32:47]
  ds_read_b64_tr_b16 v[100:101], v141 offset:32768
  ds_read_b64_tr_b16 v[102:103], v141 offset:33792
  v_mfma_f32_32x32x16_bf16 v[48:63], v[136:139], v[120:123], v[48:63]
  ds_read_b64_tr_b16 v[104:105], v142 offset:32768
  ds_read_b64_tr_b16 v[106:107], v142 offset:33792
  v_mfma_f32_32x32x16_bf16 v[64:79], v[136:139], v[124:127], v[64:79]
  ds_read_b64_tr_b16 v[108:109], v143 offset:32768
  ds_read_b64_tr_b16 v[110:111], v143 offset:33792
  s_waitcnt lgkmcnt(9)
  v_mfma_f32_32x32x16_bf16 v[16:31], v[128:131], v[80:83], v[16:31]
  ds_read_b128 v[136:139], v144 offset:33792
  ds_read_b64_tr_b16 v[112:113], v140 offset:36864
  ds_read_b64_tr_b16 v[114:115], v140 offset:37888
  v_mfma_f32_32x32x16_bf16 v[32:47], v[128:131], v[84:87], v[32:47]
  ds_read_b64_tr_b16 v[116:117], v141 offset:36864
  ds_read_b64_tr_b16 v[118:119], v141 offset:37888
  v_mfma_f32_32x32x16_bf16 v[48:63], v[128:131], v[88:91], v[48:63]
  ds_read_b64_tr_b16 v[120:121], v142 offset:36864
  ds_read_b64_tr_b16 v[122:123], v142 offset:37888
  v_mfma_f32_32x32x16_bf16 v[64:79], v[128:131], v[92:95], v[64:79]
  ds_read_b64_tr_b16 v[124:125], v143 offset:36864
  ds_read_b64_tr_b16 v[126:127], v143 offset:37888
  s_waitcnt lgkmcnt(9)
  v_mfma_f32_32x32x16_bf16 v[16:31], v[132:135], v[96:99], v[16:31]
  ds_read_b128 v[128:131], v144 offset:34816
  ds_read_b64_tr_b16 v[80:81], v140 offset:40960
  ds_read_b64_tr_b16 v[82:83], v140 offset:41984
  v_mfma_f32_32x32x16_bf16 v[32:47], v[132:135], v[100:103], v[32:47]
  ds_read_b64_tr_b16 v[84:85], v141 offset:40960
  ds_read_b64_tr_b16 v[86:87], v141 offset:41984
  v_mfma_f32_32x32x16_bf16 v[48:63], v[132:135], v[104:107], v[48:63]
  ds_read_b64_tr_b16 v[88:89], v142 offset:40960
  ds_read_b64_tr_b16 v[90:91], v142 offset:41984
  v_mfma_f32_32x32x16_bf16 v[64:79], v[132:135], v[108:111], v[64:79]
  ds_read_b64_tr_b16 v[92:93], v143 offset:40960
  ds_read_b64_tr_b16 v[94:95], v143 offset:41984
  s_waitcnt lgkmcnt(9)
  v_mfma_f32_32x32x16_bf16 v[16:31], v[136:139], v[112:115], v[16:31]
  ds_read_b128 v[132:135], v144 offset:35840
  ds_read_b64_tr_b16 v[96:97], v140 offset:45056
  ds_read_b64_tr_b16 v[98:99], v140 offset:46080
  v_mfma_f32_32x32x16_bf16 v[32:47], v[136:139], v[116:119], v[32:47]
  ds_read_b64_tr_b16 v[100:101], v141 offset:45056
  ds_read_b64_tr_b16 v[102:103], v141 offset:46080
  v_mfma_f32_32x32x16_bf16 v[48:63], v[136:139], v[120:123], v[48:63]
  ds_read_b64_tr_b16 v[104:105], v142 offset:45056
  ds_read_b64_tr_b16 v[106:107], v142 offset:46080
  v_mfma_f32_32x32x16_bf16 v[64:79], v[136:139], v[124:127], v[64:79]
  ds_read_b64_tr_b16 v[108:109], v143 offset:45056
  ds_read_b64_tr_b16 v[110:111], v143 offset:46080
  s_waitcnt lgkmcnt(9)
  s_barrier
  v_add_u32 v140, 0x10000, v140
  v_add_u32 v141, 0x10000, v141
  v_add_u32 v142, 0x10000, v142
  v_add_u32 v143, 0x10000, v143
  v_add_u32 v144, 0x10000, v144
  v_mfma_f32_32x32x16_bf16 v[16:31], v[128:131], v[80:83], v[16:31]
  ds_read_b128 v[136:139], v144 offset:0
  ds_read_b64_tr_b16 v[112:113], v140 offset:0
  ds_read_b64_tr_b16 v[114:115], v140 offset:1024
  v_mfma_f32_32x32x16_bf16 v[32:47], v[128:131], v[84:87], v[32:47]
  ds_read_b64_tr_b16 v[116:117], v141 offset:0
  ds_read_b64_tr_b16 v[118:119], v141 offset:1024
  v_mfma_f32_32x32x16_bf16 v[48:63], v[128:131], v[88:91], v[48:63]
  ds_read_b64_tr_b16 v[120:121], v142 offset:0
  ds_read_b64_tr_b16 v[122:123], v142 offset:1024
  v_mfma_f32_32x32x16_bf16 v[64:79], v[128:131], v[92:95], v[64:79]
  ds_read_b64_tr_b16 v[124:125], v143 offset:0
  ds_read_b64_tr_b16 v[126:127], v143 offset:1024
  s_waitcnt lgkmcnt(9)
  v_mfma_f32_32x32x16_bf16 v[16:31], v[132:135], v[96:99], v[16:31]
  ds_read_b128 v[128:131], v144 offset:1024
  ds_read_b64_tr_b16 v[80:81], v140 offset:4096
  ds_read_b64_tr_b16 v[82:83], v140 offset:5120
  v_mfma_f32_32x32x16_bf16 v[32:47], v[132:135], v[100:103], v[32:47]
  ds_read_b64_tr_b16 v[84:85], v141 offset:4096
  ds_read_b64_tr_b16 v[86:87], v141 offset:5120
  v_mfma_f32_32x32x16_bf16 v[48:63], v[132:135], v[104:107], v[48:63]
  ds_read_b64_tr_b16 v[88:89], v142 offset:4096
  ds_read_b64_tr_b16 v[90:91], v142 offset:5120
  v_mfma_f32_32x32x16_bf16 v[64:79], v[132:135], v[108:111], v[64:79]
  ds_read_b64_tr_b16 v[92:93], v143 offset:4096
  ds_read_b64_tr_b16 v[94:95], v143 offset:5120
  s_waitcnt lgkmcnt(9)
  v_mfma_f32_32x32x16_bf16 v[16:31], v[136:139], v[112:115], v[16:31]
  ds_read_b128 v[132:135], v144 offset:2048
  ds_read_b64_tr_b16 v[96:97], v140 offset:8192
  ds_read_b64_tr_b16 v[98:99], v140 offset:9216
  v_mfma_f32_32x32x16_bf16 v[32:47], v[136:139], v[116:119], v[32:47]
  ds_read_b64_tr_b16 v[100:101], v141 offset:8192
  ds_read_b64_tr_b16 v[102:103], v141 offset:9216
  v_mfma_f32_32x32x16_bf16 v[48:63], v[136:139], v[120:123], v[48:63]
  ds_read_b64_tr_b16 v[104:105], v142 offset:8192
  ds_read_b64_tr_b16 v[106:107], v142 offset:9216
  v_mfma_f32_32x32x16_bf16 v[64:79], v[136:139], v[124:127], v[64:79]
  ds_read_b64_tr_b16 v[108:109], v143 offset:8192
  ds_read_b64_tr_b16 v[110:111], v143 offset:9216
  s_waitcnt lgkmcnt(9)
  v_mfma_f32_32x32x16_bf16 v[16:31], v[128:131], v[80:83], v[16:31]
  ds_read_b128 v[136:139], v144 offset:3072
  ds_read_b64_tr_b16 v[112:113], v140 offset:12288
  ds_read_b64_tr_b16 v[114:115], v140 offset:13312
  v_mfma_f32_32x32x16_bf16 v[32:47], v[128:131], v[84:87], v[32:47]
  ds_read_b64_tr_b16 v[116:117], v141 offset:12288
  ds_read_b64_tr_b16 v[118:119], v141 offset:13312
  v_mfma_f32_32x32x16_bf16 v[48:63], v[128:131], v[88:91], v[48:63]
  ds_read_b64_tr_b16 v[120:121], v142 offset:12288
  ds_read_b64_tr_b16 v[122:123], v142 offset:13312
  v_mfma_f32_32x32x16_bf16 v[64:79], v[128:131], v[92:95], v[64:79]
  ds_read_b64_tr_b16 v[124:125], v143 offset:12288
  ds_read_b64_tr_b16 v[126:127], v143 offset:13312
  s_waitcnt lgkmcnt(9)
  s_barrier
  v_mfma_f32_32x32x16_bf16 v[16:31], v[132:135], v[96:99], v[16:31]
  ds_read_b128 v[128:131], v144 offset:32768
  ds_read_b64_tr_b16 v[80:81], v140 offset:32768
  ds_read_b64_tr_b16 v[82:83], v140 offset:33792
  v_mfma_f32_32x32x16_bf16 v[32:47], v[132:135], v[100:103], v[32:47]
  ds_read_b64_tr_b16 v[84:85], v141 offset:32768
  ds_read_b64_tr_b16 v[86:87], v141 offset:33792
  v_mfma_f32_32x32x16_bf16 v[48:63], v[132:135], v[104:107], v[48:63]
  ds_read_b64_tr_b16 v[88:89], v142 offset:32768
  ds_read_b64_tr_b16 v[90:91], v142 offset:33792
  v_mfma_f32_32x32x16_bf16 v[64:79], v[132:135], v[108:111], v[64:79]
  ds_read_b64_tr_b16 v[92:93], v143 offset:32768
  ds_read_b64_tr_b16 v[94:95], v143 offset:33792
  s_waitcnt lgkmcnt(9)
  v_mfma_f32_32x32x16_bf16 v[16:31], v[136:139], v[112:115], v[16:31]
  ds_read_b128 v[132:135], v144 offset:33792
  ds_read_b64_tr_b16 v[96:97], v140 offset:36864
  ds_read_b64_tr_b16 v[98:99], v140 offset:37888
  v_mfma_f32_32x32x16_bf16 v[32:47], v[136:139], v[116:119], v[32:47]
  ds_read_b64_tr_b16 v[100:101], v141 offset:36864
  ds_read_b64_tr_b16 v[102:103], v141 offset:37888
  v_mfma_f32_32x32x16_bf16 v[48:63], v[136:139], v[120:123], v[48:63]
  ds_read_b64_tr_b16 v[104:105], v142 offset:36864
  ds_read_b64_tr_b16 v[106:107], v142 offset:37888
  v_mfma_f32_32x32x16_bf16 v[64:79], v[136:139], v[124:127], v[64:79]
  ds_read_b64_tr_b16 v[108:109], v143 offset:36864
  ds_read_b64_tr_b16 v[110:111], v143 offset:37888
  s_waitcnt lgkmcnt(9)
  v_mfma_f32_32x32x16_bf16 v[16:31], v[128:131], v[80:83], v[16:31]
  ds_read_b128 v[136:139], v144 offset:34816
  ds_read_b64_tr_b16 v[112:113], v140 offset:40960
  ds_read_b64_tr_b16 v[114:115], v140 offset:41984
  v_mfma_f32_32x32x16_bf16 v[32:47], v[128:131], v[84:87], v[32:47]
  ds_read_b64_tr_b16 v[116:117], v141 offset:40960
  ds_read_b64_tr_b16 v[118:119], v141 offset:41984
  v_mfma_f32_32x32x16_bf16 v[48:63], v[128:131], v[88:91], v[48:63]
  ds_read_b64_tr_b16 v[120:121], v142 offset:40960
  ds_read_b64_tr_b16 v[122:123], v142 offset:41984
  v_mfma_f32_32x32x16_bf16 v[64:79], v[128:131], v[92:95], v[64:79]
  ds_read_b64_tr_b16 v[124:125], v143 offset:40960
  ds_read_b64_tr_b16 v[126:127], v143 offset:41984
  s_waitcnt lgkmcnt(9)
  v_mfma_f32_32x32x16_bf16 v[16:31], v[132:135], v[96:99], v[16:31]
  ds_read_b128 v[128:131], v144 offset:35840
  ds_read_b64_tr_b16 v[80:81], v140 offset:45056
  ds_read_b64_tr_b16 v[82:83], v140 offset:46080
  v_mfma_f32_32x32x16_bf16 v[32:47], v[132:135], v[100:103], v[32:47]
  ds_read_b64_tr_b16 v[84:85], v141 offset:45056
  ds_read_b64_tr_b16 v[86:87], v141 offset:46080
  v_mfma_f32_32x32x16_bf16 v[48:63], v[132:135], v[104:107], v[48:63]
  ds_read_b64_tr_b16 v[88:89], v142 offset:45056
  ds_read_b64_tr_b16 v[90:91], v142 offset:46080
  v_mfma_f32_32x32x16_bf16 v[64:79], v[132:135], v[108:111], v[64:79]
  ds_read_b64_tr_b16 v[92:93], v143 offset:45056
  ds_read_b64_tr_b16 v[94:95], v143 offset:46080
  s_waitcnt lgkmcnt(9)
  s_barrier
  v_add_u32 v140, 0xffff0000, v140
  v_add_u32 v141, 0xffff0000, v141
  v_add_u32 v142, 0xffff0000, v142
  v_add_u32 v143, 0xffff0000, v143
  v_add_u32 v144, 0xffff0000, v144
  v_mfma_f32_32x32x16_bf16 v[16:31], v[136:139], v[112:115], v[16:31]
  ds_read_b128 v[132:135], v144 offset:0
  ds_read_b64_tr_b16 v[96:97], v140 offset:0
  ds_read_b64_tr_b16 v[98:99], v140 offset:1024
  v_mfma_f32_32x32x16_bf16 v[32:47], v[136:139], v[116:119], v[32:47]
  ds_read_b64_tr_b16 v[100:101], v141 offset:0
  ds_read_b64_tr_b16 v[102:103], v141 offset:1024
  v_mfma_f32_32x32x16_bf16 v[48:63], v[136:139], v[120:123], v[48:63]
  ds_read_b64_tr_b16 v[104:105], v142 offset:0
  ds_read_b64_tr_b16 v[106:107], v142 offset:1024
  v_mfma_f32_32x32x16_bf16 v[64:79], v[136:139], v[124:127], v[64:79]
  ds_read_b64_tr_b16 v[108:109], v143 offset:0
  ds_read_b64_tr_b16 v[110:111], v143 offset:1024
  s_waitcnt lgkmcnt(9)
  v_mfma_f32_32x32x16_bf16 v[16:31], v[128:131], v[80:83], v[16:31]
  ds_read_b128 v[136:139], v144 offset:1024
  ds_read_b64_tr_b16 v[112:113], v140 offset:4096
  ds_read_b64_tr_b16 v[114:115], v140 offset:5120
  v_mfma_f32_32x32x16_bf16 v[32:47], v[128:131], v[84:87], v[32:47]
  ds_read_b64_tr_b16 v[116:117], v141 offset:4096
  ds_read_b64_tr_b16 v[118:119], v141 offset:5120
  v_mfma_f32_32x32x16_bf16 v[48:63], v[128:131], v[88:91], v[48:63]
  ds_read_b64_tr_b16 v[120:121], v142 offset:4096
  ds_read_b64_tr_b16 v[122:123], v142 offset:5120
  v_mfma_f32_32x32x16_bf16 v[64:79], v[128:131], v[92:95], v[64:79]
  ds_read_b64_tr_b16 v[124:125], v143 offset:4096
  ds_read_b64_tr_b16 v[126:127], v143 offset:5120
  s_waitcnt lgkmcnt(9)
  v_mfma_f32_32x32x16_bf16 v[16:31], v[132:135], v[96:99], v[16:31]
  ds_read_b128 v[128:131], v144 offset:2048
  ds_read_b64_tr_b16 v[80:81], v140 offset:8192
  ds_read_b64_tr_b16 v[82:83], v140 offset:9216
  v_mfma_f32_32x32x16_bf16 v[32:47], v[132:135], v[100:103], v[32:47]
  ds_read_b64_tr_b16 v[84:85], v141 offset:8192
  ds_read_b64_tr_b16 v[86:87], v141 offset:9216
  v_mfma_f32_32x32x16_bf16 v[48:63], v[132:135], v[104:107], v[48:63]
  ds_read_b64_tr_b16 v[88:89], v142 offset:8192
  ds_read_b64_tr_b16 v[90:91], v142 offset:9216
  v_mfma_f32_32x32x16_bf16 v[64:79], v[132:135], v[108:111], v[64:79]
  ds_read_b64_tr_b16 v[92:93], v143 offset:8192
  ds_read_b64_tr_b16 v[94:95], v143 offset:9216
  s_waitcnt lgkmcnt(9)
  v_mfma_f32_32x32x16_bf16 v[16:31], v[136:139], v[112:115], v[16:31]
  ds_read_b128 v[132:135], v144 offset:3072
  ds_read_b64_tr_b16 v[96:97], v140 offset:12288
  ds_read_b64_tr_b16 v[98:99], v140 offset:13312
  v_mfma_f32_32x32x16_bf16 v[32:47], v[136:139], v[116:119], v[32:47]
  ds_read_b64_tr_b16 v[100:101], v141 offset:12288
  ds_read_b64_tr_b16 v[102:103], v141 offset:13312
  v_mfma_f32_32x32x16_bf16 v[48:63], v[136:139], v[120:123], v[48:63]
  ds_read_b64_tr_b16 v[104:105], v142 offset:12288
  ds_read_b64_tr_b16 v[106:107], v142 offset:13312
  v_mfma_f32_32x32x16_bf16 v[64:79], v[136:139], v[124:127], v[64:79]
  ds_read_b64_tr_b16 v[108:109], v143 offset:12288
  ds_read_b64_tr_b16 v[110:111], v143 offset:13312
  s_waitcnt lgkmcnt(9)
  s_barrier
  v_mfma_f32_32x32x16_bf16 v[16:31], v[128:131], v[80:83], v[16:31]
  ds_read_b128 v[136:139], v144 offset:32768
  ds_read_b64_tr_b16 v[112:113], v140 offset:32768
  ds_read_b64_tr_b16 v[114:115], v140 offset:33792
  v_mfma_f32_32x32x16_bf16 v[32:47], v[128:131], v[84:87], v[32:47]
  ds_read_b64_tr_b16 v[116:117], v141 offset:32768
  ds_read_b64_tr_b16 v[118:119], v141 offset:33792
  v_mfma_f32_32x32x16_bf16 v[48:63], v[128:131], v[88:91], v[48:63]
  ds_read_b64_tr_b16 v[120:121], v142 offset:32768
  ds_read_b64_tr_b16 v[122:123], v142 offset:33792
  v_mfma_f32_32x32x16_bf16 v[64:79], v[128:131], v[92:95], v[64:79]
  ds_read_b64_tr_b16 v[124:125], v143 offset:32768
  ds_read_b64_tr_b16 v[126:127], v143 offset:33792
  s_waitcnt lgkmcnt(9)
  v_mfma_f32_32x32x16_bf16 v[16:31], v[132:135], v[96:99], v[16:31]
  ds_read_b128 v[128:131], v144 offset:33792
  ds_read_b64_tr_b16 v[80:81], v140 offset:36864
  ds_read_b64_tr_b16 v[82:83], v140 offset:37888
  v_mfma_f32_32x32x16_bf16 v[32:47], v[132:135], v[100:103], v[32:47]
  ds_read_b64_tr_b16 v[84:85], v141 offset:36864
  ds_read_b64_tr_b16 v[86:87], v141 offset:37888
  v_mfma_f32_32x32x16_bf16 v[48:63], v[132:135], v[104:107], v[48:63]
  ds_read_b64_tr_b16 v[88:89], v142 offset:36864
  ds_read_b64_tr_b16 v[90:91], v142 offset:37888
  v_mfma_f32_32x32x16_bf16 v[64:79], v[132:135], v[108:111], v[64:79]
  ds_read_b64_tr_b16 v[92:93], v143 offset:36864
  ds_read_b64_tr_b16 v[94:95], v143 offset:37888
  s_waitcnt lgkmcnt(9)
  v_mfma_f32_32x32x16_bf16 v[16:31], v[136:139], v[112:115], v[16:31]
  ds_read_b128 v[132:135], v144 offset:34816
  ds_read_b64_tr_b16 v[96:97], v140 offset:40960
  ds_read_b64_tr_b16 v[98:99], v140 offset:41984
  v_mfma_f32_32x32x16_bf16 v[32:47], v[136:139], v[116:119], v[32:47]
  ds_read_b64_tr_b16 v[100:101], v141 offset:40960
  ds_read_b64_tr_b16 v[102:103], v141 offset:41984
  v_mfma_f32_32x32x16_bf16 v[48:63], v[136:139], v[120:123], v[48:63]
  ds_read_b64_tr_b16 v[104:105], v142 offset:40960
  ds_read_b64_tr_b16 v[106:107], v142 offset:41984
  v_mfma_f32_32x32x16_bf16 v[64:79], v[136:139], v[124:127], v[64:79]
  ds_read_b64_tr_b16 v[108:109], v143 offset:40960
  ds_read_b64_tr_b16 v[110:111], v143 offset:41984
  s_waitcnt lgkmcnt(9)
  v_mfma_f32_32x32x16_bf16 v[16:31], v[128:131], v[80:83], v[16:31]
  ds_read_b128 v[136:139], v144 offset:35840
  ds_read_b64_tr_b16 v[112:113], v140 offset:45056
  ds_read_b64_tr_b16 v[114:115], v140 offset:46080
  v_mfma_f32_32x32x16_bf16 v[32:47], v[128:131], v[84:87], v[32:47]
  ds_read_b64_tr_b16 v[116:117], v141 offset:45056
  ds_read_b64_tr_b16 v[118:119], v141 offset:46080
  v_mfma_f32_32x32x16_bf16 v[48:63], v[128:131], v[88:91], v[48:63]
  ds_read_b64_tr_b16 v[120:121], v142 offset:45056
  ds_read_b64_tr_b16 v[122:123], v142 offset:46080
  v_mfma_f32_32x32x16_bf16 v[64:79], v[128:131], v[92:95], v[64:79]
  ds_read_b64_tr_b16 v[124:125], v143 offset:45056
  ds_read_b64_tr_b16 v[126:127], v143 offset:46080
  s_waitcnt lgkmcnt(9)
  s_barrier
  v_add_u32 v140, 0x10000, v140
  v_add_u32 v141, 0x10000, v141
  v_add_u32 v142, 0x10000, v142
  v_add_u32 v143, 0x10000, v143
  v_add_u32 v144, 0x10000, v144
  v_mfma_f32_32x32x16_bf16 v[16:31], v[132:135], v[96:99], v[16:31]
  ds_read_b128 v[128:131], v144 offset:0
  ds_read_b64_tr_b16 v[80:81], v140 offset:0
  ds_read_b64_tr_b16 v[82:83], v140 offset:1024
  v_mfma_f32_32x32x16_bf16 v[32:47], v[132:135], v[100:103], v[32:47]
  ds_read_b64_tr_b16 v[84:85], v141 offset:0
  ds_read_b64_tr_b16 v[86:87], v141 offset:1024
  v_mfma_f32_32x32x16_bf16 v[48:63], v[132:135], v[104:107], v[48:63]
  ds_read_b64_tr_b16 v[88:89], v142 offset:0
  ds_read_b64_tr_b16 v[90:91], v142 offset:1024
  v_mfma_f32_32x32x16_bf16 v[64:79], v[132:135], v[108:111], v[64:79]
  ds_read_b64_tr_b16 v[92:93], v143 offset:0
  ds_read_b64_tr_b16 v[94:95], v143 offset:1024
  s_waitcnt lgkmcnt(9)
  v_mfma_f32_32x32x16_bf16 v[16:31], v[136:139], v[112:115], v[16:31]
  ds_read_b128 v[132:135], v144 offset:1024
  ds_read_b64_tr_b16 v[96:97], v140 offset:4096
  ds_read_b64_tr_b16 v[98:99], v140 offset:5120
  v_mfma_f32_32x32x16_bf16 v[32:47], v[136:139], v[116:119], v[32:47]
  ds_read_b64_tr_b16 v[100:101], v141 offset:4096
  ds_read_b64_tr_b16 v[102:103], v141 offset:5120
  v_mfma_f32_32x32x16_bf16 v[48:63], v[136:139], v[120:123], v[48:63]
  ds_read_b64_tr_b16 v[104:105], v142 offset:4096
  ds_read_b64_tr_b16 v[106:107], v142 offset:5120
  v_mfma_f32_32x32x16_bf16 v[64:79], v[136:139], v[124:127], v[64:79]
  ds_read_b64_tr_b16 v[108:109], v143 offset:4096
  ds_read_b64_tr_b16 v[110:111], v143 offset:5120
  s_waitcnt lgkmcnt(9)
  v_mfma_f32_32x32x16_bf16 v[16:31], v[128:131], v[80:83], v[16:31]
  ds_read_b128 v[136:139], v144 offset:2048
  ds_read_b64_tr_b16 v[112:113], v140 offset:8192
  ds_read_b64_tr_b16 v[114:115], v140 offset:9216
  v_mfma_f32_32x32x16_bf16 v[32:47], v[128:131], v[84:87], v[32:47]
  ds_read_b64_tr_b16 v[116:117], v141 offset:8192
  ds_read_b64_tr_b16 v[118:119], v141 offset:9216
  v_mfma_f32_32x32x16_bf16 v[48:63], v[128:131], v[88:91], v[48:63]
  ds_read_b64_tr_b16 v[120:121], v142 offset:8192
  ds_read_b64_tr_b16 v[122:123], v142 offset:9216
  v_mfma_f32_32x32x16_bf16 v[64:79], v[128:131], v[92:95], v[64:79]
  ds_read_b64_tr_b16 v[124:125], v143 offset:8192
  ds_read_b64_tr_b16 v[126:127], v143 offset:9216
  s_waitcnt lgkmcnt(9)
  v_mfma_f32_32x32x16_bf16 v[16:31], v[132:135], v[96:99], v[16:31]
  ds_read_b128 v[128:131], v144 offset:3072
  ds_read_b64_tr_b16 v[80:81], v140 offset:12288
  ds_read_b64_tr_b16 v[82:83], v140 offset:13312
  v_mfma_f32_32x32x16_bf16 v[32:47], v[132:135], v[100:103], v[32:47]
  ds_read_b64_tr_b16 v[84:85], v141 offset:12288
  ds_read_b64_tr_b16 v[86:87], v141 offset:13312
  v_mfma_f32_32x32x16_bf16 v[48:63], v[132:135], v[104:107], v[48:63]
  ds_read_b64_tr_b16 v[88:89], v142 offset:12288
  ds_read_b64_tr_b16 v[90:91], v142 offset:13312
  v_mfma_f32_32x32x16_bf16 v[64:79], v[132:135], v[108:111], v[64:79]
  ds_read_b64_tr_b16 v[92:93], v143 offset:12288
  ds_read_b64_tr_b16 v[94:95], v143 offset:13312
  s_waitcnt lgkmcnt(9)
  s_barrier
  v_mfma_f32_32x32x16_bf16 v[16:31], v[136:139], v[112:115], v[16:31]
  ds_read_b128 v[132:135], v144 offset:32768
  ds_read_b64_tr_b16 v[96:97], v140 offset:32768
  ds_read_b64_tr_b16 v[98:99], v140 offset:33792
  v_mfma_f32_32x32x16_bf16 v[32:47], v[136:139], v[116:119], v[32:47]
  ds_read_b64_tr_b16 v[100:101], v141 offset:32768
  ds_read_b64_tr_b16 v[102:103], v141 offset:33792
  v_mfma_f32_32x32x16_bf16 v[48:63], v[136:139], v[120:123], v[48:63]
  ds_read_b64_tr_b16 v[104:105], v142 offset:32768
  ds_read_b64_tr_b16 v[106:107], v142 offset:33792
  v_mfma_f32_32x32x16_bf16 v[64:79], v[136:139], v[124:127], v[64:79]
  ds_read_b64_tr_b16 v[108:109], v143 offset:32768
  ds_read_b64_tr_b16 v[110:111], v143 offset:33792
  s_waitcnt lgkmcnt(9)
  v_mfma_f32_32x32x16_bf16 v[16:31], v[128:131], v[80:83], v[16:31]
  ds_read_b128 v[136:139], v144 offset:33792
  ds_read_b64_tr_b16 v[112:113], v140 offset:36864
  ds_read_b64_tr_b16 v[114:115], v140 offset:37888
  v_mfma_f32_32x32x16_bf16 v[32:47], v[128:131], v[84:87], v[32:47]
  ds_read_b64_tr_b16 v[116:117], v141 offset:36864
  ds_read_b64_tr_b16 v[118:119], v141 offset:37888
  v_mfma_f32_32x32x16_bf16 v[48:63], v[128:131], v[88:91], v[48:63]
  ds_read_b64_tr_b16 v[120:121], v142 offset:36864
  ds_read_b64_tr_b16 v[122:123], v142 offset:37888
  v_mfma_f32_32x32x16_bf16 v[64:79], v[128:131], v[92:95], v[64:79]
  ds_read_b64_tr_b16 v[124:125], v143 offset:36864
  ds_read_b64_tr_b16 v[126:127], v143 offset:37888
  s_waitcnt lgkmcnt(9)
  v_mfma_f32_32x32x16_bf16 v[16:31], v[132:135], v[96:99], v[16:31]
  ds_read_b128 v[128:131], v144 offset:34816
  ds_read_b64_tr_b16 v[80:81], v140 offset:40960
  ds_read_b64_tr_b16 v[82:83], v140 offset:41984
  v_mfma_f32_32x32x16_bf16 v[32:47], v[132:135], v[100:103], v[32:47]
  ds_read_b64_tr_b16 v[84:85], v141 offset:40960
  ds_read_b64_tr_b16 v[86:87], v141 offset:41984
  v_mfma_f32_32x32x16_bf16 v[48:63], v[132:135], v[104:107], v[48:63]
  ds_read_b64_tr_b16 v[88:89], v142 offset:40960
  ds_read_b64_tr_b16 v[90:91], v142 offset:41984
  v_mfma_f32_32x32x16_bf16 v[64:79], v[132:135], v[108:111], v[64:79]
  ds_read_b64_tr_b16 v[92:93], v143 offset:40960
  ds_read_b64_tr_b16 v[94:95], v143 offset:41984
  s_waitcnt lgkmcnt(9)
  v_mfma_f32_32x32x16_bf16 v[16:31], v[136:139], v[112:115], v[16:31]
  ds_read_b128 v[132:135], v144 offset:35840
  ds_read_b64_tr_b16 v[96:97], v140 offset:45056
  ds_read_b64_tr_b16 v[98:99], v140 offset:46080
  v_mfma_f32_32x32x16_bf16 v[32:47], v[136:139], v[116:119], v[32:47]
  ds_read_b64_tr_b16 v[100:101], v141 offset:45056
  ds_read_b64_tr_b16 v[102:103], v141 offset:46080
  v_mfma_f32_32x32x16_bf16 v[48:63], v[136:139], v[120:123], v[48:63]
  ds_read_b64_tr_b16 v[104:105], v142 offset:45056
  ds_read_b64_tr_b16 v[106:107], v142 offset:46080
  v_mfma_f32_32x32x16_bf16 v[64:79], v[136:139], v[124:127], v[64:79]
  ds_read_b64_tr_b16 v[108:109], v143 offset:45056
  ds_read_b64_tr_b16 v[110:111], v143 offset:46080
  s_waitcnt lgkmcnt(9)
  v_mfma_f32_32x32x16_bf16 v[16:31], v[128:131], v[80:83], v[16:31]
  v_mfma_f32_32x32x16_bf16 v[32:47], v[128:131], v[84:87], v[32:47]
  v_mfma_f32_32x32x16_bf16 v[48:63], v[128:131], v[88:91], v[48:63]
  v_mfma_f32_32x32x16_bf16 v[64:79], v[128:131], v[92:95], v[64:79]
  s_waitcnt lgkmcnt(0)
  v_mfma_f32_32x32x16_bf16 v[16:31], v[132:135], v[96:99], v[16:31]
  v_mfma_f32_32x32x16_bf16 v[32:47], v[132:135], v[100:103], v[32:47]
  v_mfma_f32_32x32x16_bf16 v[48:63], v[132:135], v[104:107], v[48:63]
  v_mfma_f32_32x32x16_bf16 v[64:79], v[132:135], v[108:111], v[64:79]
  v_and_b32 v10, 31, v1
  s_lshl_b32 s30, s22, 7
  v_lshl_add_u32 v10, v10, 2, s30
  v_add_u32 v10, 131584, v10
  ds_read_b32 v12, v10
  ds_read_b32 v13, v10 offset:512
  s_waitcnt lgkmcnt(0)
  v_mul_f32 v12, 0x3b000000, v12
  v_mul_f32 v13, 0x3b000000, v13
  v_fma_f32 v13, -v12, v12, v13
  v_add_f32 v14, 0x3727c5ac, v13
  v_rsq_f32 v14, v14
  s_nop 0
  v_add_f32 v14, 1.0, v14
  v_mul_f32 v15, v14, v14
  v_mul_f32 v15, v15, v13
  v_add_f32 v15, 0x3727c5ac, v15
  v_rsq_f32 v15, v15
  s_nop 0
  v_mul_f32 v13, v14, v15
  v_and_b32 v10, 31, v1
  v_lshlrev_b32 v14, 2, v10
  s_lshl_b32 s30, s22, 8
  s_add_u32 s30, s30, 132608
  v_add_u32 v10, s30, v14
  ds_write_b32 v10, v12
  ds_write_b32 v10, v13 offset:128
  v_add_u32 v14, 131072, v14
  v_lshlrev_b32 v11, 4, v6
  v_add_u32 v11, s30, v11
  s_waitcnt lgkmcnt(0)
  ds_read_b128 v[80:83], v11 offset:0
  ds_read_b128 v[96:99], v11 offset:128
  ds_read_b128 v[84:87], v11 offset:32
  ds_read_b128 v[100:103], v11 offset:160
  ds_read_b128 v[88:91], v11 offset:64
  ds_read_b128 v[104:107], v11 offset:192
  ds_read_b128 v[92:95], v11 offset:96
  ds_read_b128 v[108:111], v11 offset:224
  ds_read_b32 v140, v14 offset:0
  ds_read_b32 v141, v14 offset:128
  ds_read_b32 v142, v14 offset:256
  ds_read_b32 v143, v14 offset:384
  s_sub_u32 s30, s24, 8
  s_lshl_b32 s30, s30, 9
  s_add_u32 s30, s30, s25
  s_lshl_b32 s30, s30, 10
  s_add_u32 s30, s30, 0xc00000
  v_bfe_u32 v9, v1, 4, 1
  v_lshlrev_b32 v9, 16, v9
  v_lshl_add_u32 v9, v6, 8, v9
  v_and_b32 v10, 15, v1
  v_lshl_add_u32 v9, v10, 4, v9
  s_waitcnt lgkmcnt(0)
  v_fma_f32 v16, -v80, v140, v16
  v_mul_f32 v16, v96, v16
  v_fma_f32 v17, -v81, v140, v17
  v_mul_f32 v17, v97, v17
  v_fma_f32 v18, -v82, v140, v18
  v_mul_f32 v18, v98, v18
  v_fma_f32 v19, -v83, v140, v19
  v_mul_f32 v19, v99, v19
  v_fma_f32 v20, -v84, v140, v20
  v_mul_f32 v20, v100, v20
  v_fma_f32 v21, -v85, v140, v21
  v_mul_f32 v21, v101, v21
  v_fma_f32 v22, -v86, v140, v22
  v_mul_f32 v22, v102, v22
  v_fma_f32 v23, -v87, v140, v23
  v_mul_f32 v23, v103, v23
  v_fma_f32 v24, -v88, v140, v24
  v_mul_f32 v24, v104, v24
  v_fma_f32 v25, -v89, v140, v25
  v_mul_f32 v25, v105, v25
  v_fma_f32 v26, -v90, v140, v26
  v_mul_f32 v26, v106, v26
  v_fma_f32 v27, -v91, v140, v27
  v_mul_f32 v27, v107, v27
  v_fma_f32 v28, -v92, v140, v28
  v_mul_f32 v28, v108, v28
  v_fma_f32 v29, -v93, v140, v29
  v_mul_f32 v29, v109, v29
  v_fma_f32 v30, -v94, v140, v30
  v_mul_f32 v30, v110, v30
  v_fma_f32 v31, -v95, v140, v31
  v_mul_f32 v31, v111, v31
  v_cvt_pk_bf16_f32 v112, v16, v17
  v_cvt_pk_bf16_f32 v113, v18, v19
  v_cvt_pk_bf16_f32 v114, v20, v21
  v_cvt_pk_bf16_f32 v115, v22, v23
  v_cvt_pk_bf16_f32 v116, v24, v25
  v_cvt_pk_bf16_f32 v117, v26, v27
  v_cvt_pk_bf16_f32 v118, v28, v29
  v_cvt_pk_bf16_f32 v119, v30, v31
  s_add_u32 s31, s30, 0
  buffer_store_dwordx4 v[112:115], v9, s[16:19], s31 offen sc1
  buffer_store_dwordx4 v[116:119], v9, s[16:19], s31 offen offset:512 sc1
  v_fma_f32 v32, -v80, v141, v32
  v_mul_f32 v32, v96, v32
  v_fma_f32 v33, -v81, v141, v33
  v_mul_f32 v33, v97, v33
  v_fma_f32 v34, -v82, v141, v34
  v_mul_f32 v34, v98, v34
  v_fma_f32 v35, -v83, v141, v35
  v_mul_f32 v35, v99, v35
  v_fma_f32 v36, -v84, v141, v36
  v_mul_f32 v36, v100, v36
  v_fma_f32 v37, -v85, v141, v37
  v_mul_f32 v37, v101, v37
  v_fma_f32 v38, -v86, v141, v38
  v_mul_f32 v38, v102, v38
  v_fma_f32 v39, -v87, v141, v39
  v_mul_f32 v39, v103, v39
  v_fma_f32 v40, -v88, v141, v40
  v_mul_f32 v40, v104, v40
  v_fma_f32 v41, -v89, v141, v41
  v_mul_f32 v41, v105, v41
  v_fma_f32 v42, -v90, v141, v42
  v_mul_f32 v42, v106, v42
  v_fma_f32 v43, -v91, v141, v43
  v_mul_f32 v43, v107, v43
  v_fma_f32 v44, -v92, v141, v44
  v_mul_f32 v44, v108, v44
  v_fma_f32 v45, -v93, v141, v45
  v_mul_f32 v45, v109, v45
  v_fma_f32 v46, -v94, v141, v46
  v_mul_f32 v46, v110, v46
  v_fma_f32 v47, -v95, v141, v47
  v_mul_f32 v47, v111, v47
  v_cvt_pk_bf16_f32 v120, v32, v33
  v_cvt_pk_bf16_f32 v121, v34, v35
  v_cvt_pk_bf16_f32 v122, v36, v37
  v_cvt_pk_bf16_f32 v123, v38, v39
  v_cvt_pk_bf16_f32 v124, v40, v41
  v_cvt_pk_bf16_f32 v125, v42, v43
  v_cvt_pk_bf16_f32 v126, v44, v45
  v_cvt_pk_bf16_f32 v127, v46, v47
  s_add_u32 s31, s30, 131072
  buffer_store_dwordx4 v[120:123], v9, s[16:19], s31 offen sc1
  buffer_store_dwordx4 v[124:127], v9, s[16:19], s31 offen offset:512 sc1
  v_fma_f32 v48, -v80, v142, v48
  v_mul_f32 v48, v96, v48
  v_fma_f32 v49, -v81, v142, v49
  v_mul_f32 v49, v97, v49
  v_fma_f32 v50, -v82, v142, v50
  v_mul_f32 v50, v98, v50
  v_fma_f32 v51, -v83, v142, v51
  v_mul_f32 v51, v99, v51
  v_fma_f32 v52, -v84, v142, v52
  v_mul_f32 v52, v100, v52
  v_fma_f32 v53, -v85, v142, v53
  v_mul_f32 v53, v101, v53
  v_fma_f32 v54, -v86, v142, v54
  v_mul_f32 v54, v102, v54
  v_fma_f32 v55, -v87, v142, v55
  v_mul_f32 v55, v103, v55
  v_fma_f32 v56, -v88, v142, v56
  v_mul_f32 v56, v104, v56
  v_fma_f32 v57, -v89, v142, v57
  v_mul_f32 v57, v105, v57
  v_fma_f32 v58, -v90, v142, v58
  v_mul_f32 v58, v106, v58
  v_fma_f32 v59, -v91, v142, v59
  v_mul_f32 v59, v107, v59
  v_fma_f32 v60, -v92, v142, v60
  v_mul_f32 v60, v108, v60
  v_fma_f32 v61, -v93, v142, v61
  v_mul_f32 v61, v109, v61
  v_fma_f32 v62, -v94, v142, v62
  v_mul_f32 v62, v110, v62
  v_fma_f32 v63, -v95, v142, v63
  v_mul_f32 v63, v111, v63
  v_cvt_pk_bf16_f32 v112, v48, v49
  v_cvt_pk_bf16_f32 v113, v50, v51
  v_cvt_pk_bf16_f32 v114, v52, v53
  v_cvt_pk_bf16_f32 v115, v54, v55
  v_cvt_pk_bf16_f32 v116, v56, v57
  v_cvt_pk_bf16_f32 v117, v58, v59
  v_cvt_pk_bf16_f32 v118, v60, v61
  v_cvt_pk_bf16_f32 v119, v62, v63
  s_add_u32 s31, s30, 262144
  buffer_store_dwordx4 v[112:115], v9, s[16:19], s31 offen sc1
  buffer_store_dwordx4 v[116:119], v9, s[16:19], s31 offen offset:512 sc1
  v_fma_f32 v64, -v80, v143, v64
  v_mul_f32 v64, v96, v64
  v_fma_f32 v65, -v81, v143, v65
  v_mul_f32 v65, v97, v65
  v_fma_f32 v66, -v82, v143, v66
  v_mul_f32 v66, v98, v66
  v_fma_f32 v67, -v83, v143, v67
  v_mul_f32 v67, v99, v67
  v_fma_f32 v68, -v84, v143, v68
  v_mul_f32 v68, v100, v68
  v_fma_f32 v69, -v85, v143, v69
  v_mul_f32 v69, v101, v69
  v_fma_f32 v70, -v86, v143, v70
  v_mul_f32 v70, v102, v70
  v_fma_f32 v71, -v87, v143, v71
  v_mul_f32 v71, v103, v71
  v_fma_f32 v72, -v88, v143, v72
  v_mul_f32 v72, v104, v72
  v_fma_f32 v73, -v89, v143, v73
  v_mul_f32 v73, v105, v73
  v_fma_f32 v74, -v90, v143, v74
  v_mul_f32 v74, v106, v74
  v_fma_f32 v75, -v91, v143, v75
  v_mul_f32 v75, v107, v75
  v_fma_f32 v76, -v92, v143, v76
  v_mul_f32 v76, v108, v76
  v_fma_f32 v77, -v93, v143, v77
  v_mul_f32 v77, v109, v77
  v_fma_f32 v78, -v94, v143, v78
  v_mul_f32 v78, v110, v78
  v_fma_f32 v79, -v95, v143, v79
  v_mul_f32 v79, v111, v79
  v_cvt_pk_bf16_f32 v120, v64, v65
  v_cvt_pk_bf16_f32 v121, v66, v67
  v_cvt_pk_bf16_f32 v122, v68, v69
  v_cvt_pk_bf16_f32 v123, v70, v71
  v_cvt_pk_bf16_f32 v124, v72, v73
  v_cvt_pk_bf16_f32 v125, v74, v75
  v_cvt_pk_bf16_f32 v126, v76, v77
  v_cvt_pk_bf16_f32 v127, v78, v79
  s_add_u32 s31, s30, 393216
  buffer_store_dwordx4 v[120:123], v9, s[16:19], s31 offen sc1
  buffer_store_dwordx4 v[124:127], v9, s[16:19], s31 offen offset:512 sc1
  s_branch qkv2_kernel_done
qkv2_kernel_loader:
  s_sub_u32 s22, s22, 4
  s_mov_b32 s12, s6
  s_and_b32 s13, s7, 0xffff
  s_mov_b32 s14, 0x180000
  s_mov_b32 s15, 0x20000
  v_lshrrev_b32 v3, 4, v1
  v_bfe_u32 v4, v1, 2, 2
  v_xor_b32 v4, v4, v3
  s_lshl_b32 s25, s22, 4
  v_add_u32 v5, s25, v3
  v_mul_u32_u24 v5, 3072, v5
  v_lshl_add_u32 v5, v4, 6, v5
  v_and_b32 v4, 3, v1
  v_lshl_add_u32 v5, v4, 4, v5
  s_lshl_b32 s25, s24, 8
  v_add_u32 v8, s25, v5
  v_lshlrev_b32 v9, 4, v1
  s_lshl_b32 s25, s23, 2
  s_add_u32 s25, s25, s22
  s_lshl_b32 s26, s25, 15
  s_add_u32 s26, s26, 0x1200000
  s_lshl_b32 s29, s22, 12
  s_add_u32 m0, s29, 0
  s_mov_b32 s30, 0
  buffer_load_dwordx4 v8, s[12:15], s30 offen offset:0 lds
  s_mov_b32 s30, 11264
  buffer_load_dwordx4 v8, s[12:15], s30 offen offset:1024 lds
  s_mov_b32 s30, 22528
  buffer_load_dwordx4 v8, s[12:15], s30 offen offset:2048 lds
  s_mov_b32 s30, 33792
  buffer_load_dwordx4 v8, s[12:15], s30 offen offset:3072 lds
  s_add_u32 m0, s29, 16384
  s_add_u32 s31, s26, 0
  buffer_load_dwordx4 v9, s[16:19], s31 offen offset:0 lds
  buffer_load_dwordx4 v9, s[16:19], s31 offen offset:1024 lds
  buffer_load_dwordx4 v9, s[16:19], s31 offen offset:2048 lds
  buffer_load_dwordx4 v9, s[16:19], s31 offen offset:3072 lds
  s_cmp_ge_u32 s22, 3
  s_cbranch_scc1 qkv2_kernel_nosmall
  s_lshl_b32 s30, s24, 9
  s_add_u32 s30, s30, 0x1618000
  s_lshl_b32 s31, s23, 9
  s_add_u32 s31, s31, 0x1600000
  s_add_u32 s32, s31, 8192
  s_cmp_eq_u32 s22, 1
  s_cselect_b32 s30, s31, s30
  s_cmp_eq_u32 s22, 2
  s_cselect_b32 s30, s32, s30
  s_lshl_b32 s31, s22, 9
  s_add_u32 m0, s31, 131072
  s_mov_b32 exec_hi, 0
  buffer_load_dwordx4 v9, s[16:19], s30 offen lds
  s_mov_b64 exec, -1
qkv2_kernel_nosmall:
  s_add_u32 m0, s29, 32768
  s_mov_b32 s30, 196608
  buffer_load_dwordx4 v8, s[12:15], s30 offen offset:0 lds
  s_mov_b32 s30, 207872
  buffer_load_dwordx4 v8, s[12:15], s30 offen offset:1024 lds
  s_mov_b32 s30, 219136
  buffer_load_dwordx4 v8, s[12:15], s30 offen offset:2048 lds
  s_mov_b32 s30, 230400
  buffer_load_dwordx4 v8, s[12:15], s30 offen offset:3072 lds
  s_add_u32 m0, s29, 49152
  s_add_u32 s31, s26, 4096
  buffer_load_dwordx4 v9, s[16:19], s31 offen offset:0 lds
  buffer_load_dwordx4 v9, s[16:19], s31 offen offset:1024 lds
  buffer_load_dwordx4 v9, s[16:19], s31 offen offset:2048 lds
  buffer_load_dwordx4 v9, s[16:19], s31 offen offset:3072 lds
  s_waitcnt vmcnt(8)
  s_barrier
  s_add_u32 m0, s29, 65536
  s_mov_b32 s30, 393216
  buffer_load_dwordx4 v8, s[12:15], s30 offen offset:0 lds
  s_mov_b32 s30, 404480
  buffer_load_dwordx4 v8, s[12:15], s30 offen offset:1024 lds
  s_mov_b32 s30, 415744
  buffer_load_dwordx4 v8, s[12:15], s30 offen offset:2048 lds
  s_mov_b32 s30, 427008
  buffer_load_dwordx4 v8, s[12:15], s30 offen offset:3072 lds
  s_add_u32 m0, s29, 81920
  s_add_u32 s31, s26, 8192
  buffer_load_dwordx4 v9, s[16:19], s31 offen offset:0 lds
  buffer_load_dwordx4 v9, s[16:19], s31 offen offset:1024 lds
  buffer_load_dwordx4 v9, s[16:19], s31 offen offset:2048 lds
  buffer_load_dwordx4 v9, s[16:19], s31 offen offset:3072 lds
  s_waitcnt vmcnt(8)
  s_barrier
  s_add_u32 m0, s29, 98304
  s_mov_b32 s30, 589824
  buffer_load_dwordx4 v8, s[12:15], s30 offen offset:0 lds
  s_mov_b32 s30, 601088
  buffer_load_dwordx4 v8, s[12:15], s30 offen offset:1024 lds
  s_mov_b32 s30, 612352
  buffer_load_dwordx4 v8, s[12:15], s30 offen offset:2048 lds
  s_mov_b32 s30, 623616
  buffer_load_dwordx4 v8, s[12:15], s30 offen offset:3072 lds
  s_add_u32 m0, s29, 114688
  s_add_u32 s31, s26, 12288
  buffer_load_dwordx4 v9, s[16:19], s31 offen offset:0 lds
  buffer_load_dwordx4 v9, s[16:19], s31 offen offset:1024 lds
  buffer_load_dwordx4 v9, s[16:19], s31 offen offset:2048 lds
  buffer_load_dwordx4 v9, s[16:19], s31 offen offset:3072 lds
  s_waitcnt vmcnt(8)
  s_barrier
  s_add_u32 m0, s29, 0
  s_mov_b32 s30, 786432
  buffer_load_dwordx4 v8, s[12:15], s30 offen offset:0 lds
  s_mov_b32 s30, 797696
  buffer_load_dwordx4 v8, s[12:15], s30 offen offset:1024 lds
  s_mov_b32 s30, 808960
  buffer_load_dwordx4 v8, s[12:15], s30 offen offset:2048 lds
  s_mov_b32 s30, 820224
  buffer_load_dwordx4 v8, s[12:15], s30 offen offset:3072 lds
  s_add_u32 m0, s29, 16384
  s_add_u32 s31, s26, 16384
  buffer_load_dwordx4 v9, s[16:19], s31 offen offset:0 lds
  buffer_load_dwordx4 v9, s[16:19], s31 offen offset:1024 lds
  buffer_load_dwordx4 v9, s[16:19], s31 offen offset:2048 lds
  buffer_load_dwordx4 v9, s[16:19], s31 offen offset:3072 lds
  s_waitcnt vmcnt(8)
  s_barrier
  s_add_u32 m0, s29, 32768
  s_mov_b32 s30, 983040
  buffer_load_dwordx4 v8, s[12:15], s30 offen offset:0 lds
  s_mov_b32 s30, 994304
  buffer_load_dwordx4 v8, s[12:15], s30 offen offset:1024 lds
  s_mov_b32 s30, 1005568
  buffer_load_dwordx4 v8, s[12:15], s30 offen offset:2048 lds
  s_mov_b32 s30, 1016832
  buffer_load_dwordx4 v8, s[12:15], s30 offen offset:3072 lds
  s_add_u32 m0, s29, 49152
  s_add_u32 s31, s26, 20480
  buffer_load_dwordx4 v9, s[16:19], s31 offen offset:0 lds
  buffer_load_dwordx4 v9, s[16:19], s31 offen offset:1024 lds
  buffer_load_dwordx4 v9, s[16:19], s31 offen offset:2048 lds
  buffer_load_dwordx4 v9, s[16:19], s31 offen offset:3072 lds
  s_waitcnt vmcnt(8)
  s_barrier
  s_add_u32 m0, s29, 65536
  s_mov_b32 s30, 1179648
  buffer_load_dwordx4 v8, s[12:15], s30 offen offset:0 lds
  s_mov_b32 s30, 1190912
  buffer_load_dwordx4 v8, s[12:15], s30 offen offset:1024 lds
  s_mov_b32 s30, 1202176
  buffer_load_dwordx4 v8, s[12:15], s30 offen offset:2048 lds
  s_mov_b32 s30, 1213440
  buffer_load_dwordx4 v8, s[12:15], s30 offen offset:3072 lds
  s_add_u32 m0, s29, 81920
  s_add_u32 s31, s26, 24576
  buffer_load_dwordx4 v9, s[16:19], s31 offen offset:0 lds
  buffer_load_dwordx4 v9, s[16:19], s31 offen offset:1024 lds
  buffer_load_dwordx4 v9, s[16:19], s31 offen offset:2048 lds
  buffer_load_dwordx4 v9, s[16:19], s31 offen offset:3072 lds
  s_waitcnt vmcnt(8)
  s_barrier
  s_add_u32 m0, s29, 98304
  s_mov_b32 s30, 1376256
  buffer_load_dwordx4 v8, s[12:15], s30 offen offset:0 lds
  s_mov_b32 s30, 1387520
  buffer_load_dwordx4 v8, s[12:15], s30 offen offset:1024 lds
  s_mov_b32 s30, 1398784
  buffer_load_dwordx4 v8, s[12:15], s30 offen offset:2048 lds
  s_mov_b32 s30, 1410048
  buffer_load_dwordx4 v8, s[12:15], s30 offen offset:3072 lds
  s_add_u32 m0, s29, 114688
  s_add_u32 s31, s26, 28672
  buffer_load_dwordx4 v9, s[16:19], s31 offen offset:0 lds
  buffer_load_dwordx4 v9, s[16:19], s31 offen offset:1024 lds
  buffer_load_dwordx4 v9, s[16:19], s31 offen offset:2048 lds
  buffer_load_dwordx4 v9, s[16:19], s31 offen offset:3072 lds
  s_waitcnt vmcnt(8)
  s_barrier
  s_waitcnt vmcnt(0)
  s_barrier
  s_cmp_lg_u32 s22, 3
  s_cbranch_scc1 qkv2_kernel_noct
  s_lshr_b32 s33, s2, 3
  s_getpc_b64 s[36:37]
qkv2_kernel_pc0:
  s_add_u32 s36, s36, (qkv2_kernel_codeend-qkv2_kernel_pc0)
  s_addc_u32 s37, s37, 0
  s_and_b32 s37, s37, 0xffff
  s_mov_b32 s38, (all_code_end-qkv2_kernel_codeend)
  s_mov_b32 s39, 0x20000
  s_mul_i32 s33, s33, 1536
  v_lshlrev_b32 v2, 7, v1
  s_mov_b32 exec_lo, 0xfff
  s_mov_b32 exec_hi, 0
  buffer_load_dword v40, v2, s[36:39], s33 offen
  s_mov_b64 exec, -1
qkv2_kernel_noct:
  s_endpgm
qkv2_kernel_ffn:
  s_sub_u32 s24, s28, 24
  s_mul_i32 s25, s27, 7
  s_add_u32 s24, s24, s25
  v_lshlrev_b32 v3, 4, v1
  s_cmp_ge_u32 s22, 4
  s_cbranch_scc1 qkv2_kernel_ffn_dma
  s_lshl_b32 s30, s22, 11
  v_add_u32 v2, s30, v3
  s_mov_b32 s30, 0x1600000
  s_add_u32 s31, s30, 8192
  s_add_u32 s40, s30, 16384
  s_add_u32 s46, s20, 0x161a200
  s_addc_u32 s47, s21, 0
  s_load_dword s44, s[46:47], 0
  buffer_load_dwordx4 v[16:19], v2, s[16:19], s30 offen offset:0
  buffer_load_dwordx4 v[20:23], v2, s[16:19], s30 offen offset:1024
  buffer_load_dwordx4 v[24:27], v2, s[16:19], s31 offen offset:0
  buffer_load_dwordx4 v[28:31], v2, s[16:19], s31 offen offset:1024
  buffer_load_dwordx4 v[32:35], v2, s[16:19], s40 offen offset:0
  buffer_load_dwordx4 v[36:39], v2, s[16:19], s40 offen offset:1024
  s_barrier
  v_lshrrev_b32 v40, 2, v2
  v_mov_b32 v41, 0xfffff800
  v_mov_b32 v42, 0x44000000
  v_mov_b32 v43, 0x4027c5ac
  s_waitcnt vmcnt(0) lgkmcnt(0)
  v_mov_b32 v44, 0xbb000000
  v_mul_f32 v44, s44, v44
  v_fma_f32 v24, v24, v42, v43
  v_fma_f32 v25, v25, v42, v43
  v_fma_f32 v26, v26, v42, v43
  v_fma_f32 v27, v27, v42, v43
  v_fma_f32 v28, v28, v42, v43
  v_fma_f32 v29, v29, v42, v43
  v_fma_f32 v30, v30, v42, v43
  v_fma_f32 v31, v31, v42, v43
  v_fma_f32 v32, v16, v44, v32
  v_fma_f32 v33, v17, v44, v33
  v_fma_f32 v34, v18, v44, v34
  v_fma_f32 v35, v19, v44, v35
  v_fma_f32 v36, v20, v44, v36
  v_fma_f32 v37, v21, v44, v37
  v_fma_f32 v38, v22, v44, v38
  v_fma_f32 v39, v23, v44, v39
  v_fma_f32 v24, -v16, v16, v24
  v_fma_f32 v25, -v17, v17, v25
  v_fma_f32 v26, -v18, v18, v26
  v_fma_f32 v27, -v19, v19, v27
  v_fma_f32 v28, -v20, v20, v28
  v_fma_f32 v29, -v21, v21, v29
  v_fma_f32 v30, -v22, v22, v30
  v_fma_f32 v31, -v23, v23, v31
  v_rsq_f32 v24, v24
  v_rsq_f32 v25, v25
  v_rsq_f32 v26, v26
  v_rsq_f32 v27, v27
  v_rsq_f32 v28, v28
  v_rsq_f32 v29, v29
  v_rsq_f32 v30, v30
  v_rsq_f32 v31, v31
  v_add_u32 v16, 0, v40
  v_add_u32 v17, 1, v40
  v_add_u32 v18, 2, v40
  v_add_u32 v19, 3, v40
  v_add_u32 v20, 256, v40
  v_add_u32 v21, 257, v40
  v_add_u32 v22, 258, v40
  v_add_u32 v23, 259, v40
  v_mul_f32 v32, v32, v24
  v_mul_f32 v33, v33, v25
  v_mul_f32 v34, v34, v26
  v_mul_f32 v35, v35, v27
  v_mul_f32 v36, v36, v28
  v_mul_f32 v37, v37, v29
  v_mul_f32 v38, v38, v30
  v_mul_f32 v39, v39, v31
  v_and_or_b32 v32, v32, v41, v16
  v_and_or_b32 v33, v33, v41, v17
  v_and_or_b32 v34, v34, v41, v18
  v_and_or_b32 v35, v35, v41, v19
  v_and_or_b32 v36, v36, v41, v20
  v_and_or_b32 v37, v37, v41, v21
  v_and_or_b32 v38, v38, v41, v22
  v_and_or_b32 v39, v39, v41, v23
  v_max3_f32 v45, v32, v33, v34
  v_max3_f32 v46, v35, v36, v37
  v_max3_f32 v45, v45, v38, v39
  v_max_f32 v45, v45, v46
  s_nop 1
  v_max_f32_dpp v45, v45, v45 quad_perm:[1,0,3,2] row_mask:0xf bank_mask:0xf
  s_nop 1
  v_max_f32_dpp v45, v45, v45 quad_perm:[2,3,0,1] row_mask:0xf bank_mask:0xf
  s_nop 1
  v_max_f32_dpp v45, v45, v45 row_half_mirror row_mask:0xf bank_mask:0xf
  s_nop 1
  v_max_f32_dpp v45, v45, v45 row_mirror row_mask:0xf bank_mask:0xf
  v_mov_b32 v46, v45
  s_nop 1
  v_permlane16_swap_b32 v45, v46
  v_max_f32 v45, v45, v46
  v_mov_b32 v46, v45
  s_nop 1
  v_permlane32_swap_b32 v45, v46
  v_max_f32 v45, v45, v46
  s_lshl_b32 s41, s22, 2
  v_mov_b32 v46, s41
  ds_write_b32 v46, v45 offset:4096
  s_waitcnt lgkmcnt(0)
  s_barrier
  v_mov_b32 v46, 0
  ds_read_b128 v[48:51], v46 offset:4096
  s_waitcnt lgkmcnt(0)
  v_max3_f32 v48, v48, v49, v50
  v_max_f32 v48, v48, v51
  v_and_b32 v48, 0x7ff, v48
  s_nop 0
  v_readfirstlane_b32 s45, v48
  s_nop 0
  s_lshr_b32 s41, s45, 5
  s_lshl_b32 s41, s41, 15
  s_and_b32 s42, s45, 31
  s_lshl_b32 s42, s42, 4
  s_add_u32 s41, s41, s42
  s_add_u32 s41, s41, 0x1200000
  v_lshlrev_b32 v5, 9, v1
  buffer_load_dwordx4 v[8:11], v5, s[16:19], s41 offen
  s_lshl_b32 s42, s45, 2
  s_add_u32 s42, s42, 0x1600000
  s_add_u32 s46, s20, s42
  s_addc_u32 s47, s21, 0
  s_load_dword s40, s[46:47], 0
  s_load_dword s41, s[46:47], 8192
  s_load_dword s42, s[46:47], 16384
  s_barrier
  v_lshrrev_b32 v4, 4, v1
  v_bfe_u32 v5, v1, 2, 2
  v_lshl_add_u32 v6, v4, 3, v5
  v_lshlrev_b32 v7, 6, v6
  v_and_b32 v12, 1, v1
  v_lshl_add_u32 v7, v12, 3, v7
  s_lshl_b32 s43, s22, 4
  v_add_u32 v7, s43, v7
  v_bfe_u32 v12, v1, 1, 1
  v_mul_u32_u24 v12, 32800, v12
  v_add_u32 v7, v7, v12
  v_add_u32 v7, 4352, v7
  v_mul_u32_u24 v6, 1088, v6
  v_and_b32 v12, 3, v1
  v_lshl_add_u32 v6, v12, 3, v6
  s_lshl_b32 s43, s22, 8
  v_add_u32 v6, s43, v6
  v_add_u32 v6, 69952, v6
  ds_read_b64_tr_b16 v[64:65], v7 offset:0
  ds_read_b64_tr_b16 v[66:67], v7 offset:256
  ds_read_b64_tr_b16 v[68:69], v7 offset:2048
  ds_read_b64_tr_b16 v[70:71], v7 offset:2304
  ds_read_b64_tr_b16 v[72:73], v7 offset:4096
  ds_read_b64_tr_b16 v[74:75], v7 offset:4352
  ds_read_b64_tr_b16 v[76:77], v7 offset:6144
  ds_read_b64_tr_b16 v[78:79], v7 offset:6400
  ds_read_b64_tr_b16 v[80:81], v7 offset:8192
  ds_read_b64_tr_b16 v[82:83], v7 offset:8448
  ds_read_b64_tr_b16 v[84:85], v7 offset:10240
  ds_read_b64_tr_b16 v[86:87], v7 offset:10496
  ds_read_b64_tr_b16 v[88:89], v7 offset:12288
  ds_read_b64_tr_b16 v[90:91], v7 offset:12544
  ds_read_b64_tr_b16 v[92:93], v7 offset:14336
  ds_read_b64_tr_b16 v[94:95], v7 offset:14592
  ds_read_b64_tr_b16 v[96:97], v7 offset:16384
  ds_read_b64_tr_b16 v[98:99], v7 offset:16640
  ds_read_b64_tr_b16 v[100:101], v7 offset:18432
  ds_read_b64_tr_b16 v[102:103], v7 offset:18688
  ds_read_b64_tr_b16 v[104:105], v7 offset:20480
  ds_read_b64_tr_b16 v[106:107], v7 offset:20736
  ds_read_b64_tr_b16 v[108:109], v7 offset:22528
  ds_read_b64_tr_b16 v[110:111], v7 offset:22784
  ds_read_b64_tr_b16 v[112:113], v7 offset:24576
  ds_read_b64_tr_b16 v[114:115], v7 offset:24832
  ds_read_b64_tr_b16 v[116:117], v7 offset:26624
  ds_read_b64_tr_b16 v[118:119], v7 offset:26880
  ds_read_b64_tr_b16 v[120:121], v7 offset:28672
  ds_read_b64_tr_b16 v[122:123], v7 offset:28928
  ds_read_b64_tr_b16 v[124:125], v7 offset:30720
  ds_read_b64_tr_b16 v[126:127], v7 offset:30976
  ds_read_b64_tr_b16 v[128:129], v6 offset:0
  ds_read_b64_tr_b16 v[130:131], v6 offset:4352
  ds_read_b64_tr_b16 v[132:133], v6 offset:32
  ds_read_b64_tr_b16 v[134:135], v6 offset:4384
  ds_read_b64_tr_b16 v[136:137], v6 offset:64
  ds_read_b64_tr_b16 v[138:139], v6 offset:4416
  ds_read_b64_tr_b16 v[140:141], v6 offset:96
  ds_read_b64_tr_b16 v[142:143], v6 offset:4448
  ds_read_b64_tr_b16 v[144:145], v6 offset:128
  ds_read_b64_tr_b16 v[146:147], v6 offset:4480
  ds_read_b64_tr_b16 v[148:149], v6 offset:160
  ds_read_b64_tr_b16 v[150:151], v6 offset:4512
  ds_read_b64_tr_b16 v[152:153], v6 offset:192
  ds_read_b64_tr_b16 v[154:155], v6 offset:4544
  ds_read_b64_tr_b16 v[156:157], v6 offset:224
  ds_read_b64_tr_b16 v[158:159], v6 offset:4576
  s_waitcnt lgkmcnt(0)
  v_mov_b32 v16, s40
  v_mov_b32 v17, s41
  v_mul_f32 v16, 0x3b000000, v16
  v_mul_f32 v17, 0x3b000000, v17
  v_fma_f32 v17, -v16, v16, v17
  v_add_f32 v17, 0x3727c5ac, v17
  v_rsq_f32 v17, v17
  s_waitcnt vmcnt(0)
  s_or_b32 s43, s24, s22
  s_cmp_lg_u32 s43, 0
  s_cbranch_scc1 qkv2_kernel_ffn_noxb
  v_add_f32 v18, 1.0, v17
  v_mul_f32 v19, v16, v17
  v_lshlrev_b32 v28, 16, v8
  v_and_b32 v29, 0xffff0000, v8
  v_fma_f32 v28, v28, v18, -v19
  v_fma_f32 v29, v29, v18, -v19
  v_lshlrev_b32 v30, 16, v9
  v_and_b32 v31, 0xffff0000, v9
  v_fma_f32 v30, v30, v18, -v19
  v_fma_f32 v31, v31, v18, -v19
  v_lshlrev_b32 v32, 16, v10
  v_and_b32 v33, 0xffff0000, v10
  v_fma_f32 v32, v32, v18, -v19
  v_fma_f32 v33, v33, v18, -v19
  v_lshlrev_b32 v34, 16, v11
  v_and_b32 v35, 0xffff0000, v11
  v_fma_f32 v34, v34, v18, -v19
  v_fma_f32 v35, v35, v18, -v19
  v_lshlrev_b32 v5, 5, v1
  s_mov_b32 s43, 0x161c000
  buffer_store_dwordx4 v[28:31], v5, s[16:19], s43 offen sc1
  buffer_store_dwordx4 v[32:35], v5, s[16:19], s43 offen offset:16 sc1
qkv2_kernel_ffn_noxb:
  v_lshlrev_b32 v18, 16, v8
  v_and_b32 v19, 0xffff0000, v8
  v_sub_f32 v18, v18, v16
  v_sub_f32 v19, v19, v16
  v_mul_f32 v18, v18, v17
  v_mul_f32 v19, v19, v17
  v_cvt_pk_bf16_f32 v8, v18, v19
  v_lshlrev_b32 v18, 16, v9
  v_and_b32 v19, 0xffff0000, v9
  v_sub_f32 v18, v18, v16
  v_sub_f32 v19, v19, v16
  v_mul_f32 v18, v18, v17
  v_mul_f32 v19, v19, v17
  v_cvt_pk_bf16_f32 v9, v18, v19
  v_lshlrev_b32 v18, 16, v10
  v_and_b32 v19, 0xffff0000, v10
  v_sub_f32 v18, v18, v16
  v_sub_f32 v19, v19, v16
  v_mul_f32 v18, v18, v17
  v_mul_f32 v19, v19, v17
  v_cvt_pk_bf16_f32 v10, v18, v19
  v_lshlrev_b32 v18, 16, v11
  v_and_b32 v19, 0xffff0000, v11
  v_sub_f32 v18, v18, v16
  v_sub_f32 v19, v19, v16
  v_mul_f32 v18, v18, v17
  v_mul_f32 v19, v19, v17
  v_cvt_pk_bf16_f32 v11, v18, v19
  s_lshl_b32 s43, s22, 10
  v_add_u32 v5, s43, v3
  ds_write_b128 v5, v[8:11] offset:0
  v_lshl_add_u32 v5, v4, 4, s43
  s_waitcnt lgkmcnt(0)
  ds_read_b128 v[160:163], v5 offset:0
  ds_read_b128 v[164:167], v5 offset:64
  ds_read_b128 v[168:171], v5 offset:128
  ds_read_b128 v[172:175], v5 offset:192
  ds_read_b128 v[176:179], v5 offset:256
  ds_read_b128 v[180:183], v5 offset:320
  ds_read_b128 v[184:187], v5 offset:384
  ds_read_b128 v[188:191], v5 offset:448
  s_waitcnt lgkmcnt(0)
  v_mfma_f32_16x16x32_bf16 v[20:23], v[64:67], v[160:163], 0
  v_mfma_f32_16x16x32_bf16 v[24:27], v[68:71], v[164:167], 0
  v_mfma_f32_16x16x32_bf16 v[20:23], v[72:75], v[168:171], v[20:23]
  v_mfma_f32_16x16x32_bf16 v[24:27], v[76:79], v[172:175], v[24:27]
  v_mfma_f32_16x16x32_bf16 v[20:23], v[80:83], v[176:179], v[20:23]
  v_mfma_f32_16x16x32_bf16 v[24:27], v[84:87], v[180:183], v[24:27]
  v_mfma_f32_16x16x32_bf16 v[20:23], v[88:91], v[184:187], v[20:23]
  v_mfma_f32_16x16x32_bf16 v[24:27], v[92:95], v[188:191], v[24:27]
  ds_read_b128 v[160:163], v5 offset:512
  ds_read_b128 v[164:167], v5 offset:576
  ds_read_b128 v[168:171], v5 offset:640
  ds_read_b128 v[172:175], v5 offset:704
  ds_read_b128 v[176:179], v5 offset:768
  ds_read_b128 v[180:183], v5 offset:832
  ds_read_b128 v[184:187], v5 offset:896
  ds_read_b128 v[188:191], v5 offset:960
  s_waitcnt lgkmcnt(0)
  v_mfma_f32_16x16x32_bf16 v[20:23], v[96:99], v[160:163], v[20:23]
  v_mfma_f32_16x16x32_bf16 v[24:27], v[100:103], v[164:167], v[24:27]
  v_mfma_f32_16x16x32_bf16 v[20:23], v[104:107], v[168:171], v[20:23]
  v_mfma_f32_16x16x32_bf16 v[24:27], v[108:111], v[172:175], v[24:27]
  v_mfma_f32_16x16x32_bf16 v[20:23], v[112:115], v[176:179], v[20:23]
  v_mfma_f32_16x16x32_bf16 v[24:27], v[116:119], v[180:183], v[24:27]
  v_mfma_f32_16x16x32_bf16 v[20:23], v[120:123], v[184:187], v[20:23]
  v_mfma_f32_16x16x32_bf16 v[24:27], v[124:127], v[188:191], v[24:27]
  s_cmp_lg_u32 s24, 0
  s_cbranch_scc1 qkv2_kernel_ffn_nosel
  s_cmp_lg_u32 s22, 0
  s_cbranch_scc1 qkv2_kernel_ffn_nosel
  v_mov_b32 v29, s42
  v_mul_f32 v28, s44, v16
  v_sub_f32 v29, v29, v28
  v_mul_f32 v29, v29, v17
  v_mul_f32 v29, 0xbfb8aa3b, v29
  v_exp_f32 v29, v29
  s_nop 0
  v_add_f32 v29, 1.0, v29
  v_rcp_f32 v37, v29
  v_mov_b32 v36, s45
  v_mov_b32 v38, v16
  v_mov_b32 v39, v17
  v_mov_b32 v29, 0
  s_mov_b32 s41, 0x161a000
  s_mov_b64 s[46:47], exec
  s_mov_b64 exec, 1
  buffer_store_dwordx4 v[36:39], v29, s[16:19], s41 offen sc1
  s_mov_b64 exec, s[46:47]
qkv2_kernel_ffn_nosel:
  s_nop 5
  v_add_f32 v20, v20, v24
  v_add_f32 v21, v21, v25
  v_add_f32 v22, v22, v26
  v_add_f32 v23, v23, v27
  v_mov_b32 v24, v20
  v_mov_b32 v25, v21
  v_mov_b32 v26, v22
  v_mov_b32 v27, v23
  v_permlane32_swap_b32 v20, v24
  v_permlane32_swap_b32 v21, v25
  v_permlane32_swap_b32 v22, v26
  v_permlane32_swap_b32 v23, v27
  v_mul_f32 v28, 0xbfb8aa3b, v20
  v_mul_f32 v29, 0xbfb8aa3b, v21
  v_mul_f32 v30, 0xbfb8aa3b, v22
  v_mul_f32 v31, 0xbfb8aa3b, v23
  v_exp_f32 v28, v28
  v_exp_f32 v29, v29
  v_exp_f32 v30, v30
  v_exp_f32 v31, v31
  v_add_f32 v28, 1.0, v28
  v_add_f32 v29, 1.0, v29
  v_add_f32 v30, 1.0, v30
  v_add_f32 v31, 1.0, v31
  v_rcp_f32 v28, v28
  v_rcp_f32 v29, v29
  v_rcp_f32 v30, v30
  v_rcp_f32 v31, v31
  v_mul_f32 v20, v20, v24
  v_mul_f32 v21, v21, v25
  v_mul_f32 v22, v22, v26
  v_mul_f32 v23, v23, v27
  v_mul_f32 v20, v20, v28
  v_mul_f32 v21, v21, v29
  v_mul_f32 v22, v22, v30
  v_mul_f32 v23, v23, v31
  v_cvt_pk_bf16_f32 v20, v20, v21
  v_cvt_pk_bf16_f32 v21, v22, v23
  s_lshl_b32 s43, s22, 4
  v_lshl_add_u32 v5, v4, 3, s43
  s_mov_b64 s[46:47], exec
  s_mov_b64 exec, 0x10001
  ds_write_b64 v5, v[20:21] offset:4160
  s_mov_b64 exec, s[46:47]
  s_waitcnt lgkmcnt(0)
  s_barrier
  v_lshlrev_b32 v5, 4, v4
  ds_read_b128 v[8:11], v5 offset:4160
  s_waitcnt lgkmcnt(0)
  v_mfma_f32_16x16x32_bf16 v[64:67], v[8:11], v[128:131], 0
  v_mfma_f32_16x16x32_bf16 v[68:71], v[8:11], v[132:135], 0
  v_mfma_f32_16x16x32_bf16 v[72:75], v[8:11], v[136:139], 0
  v_mfma_f32_16x16x32_bf16 v[76:79], v[8:11], v[140:143], 0
  v_mfma_f32_16x16x32_bf16 v[80:83], v[8:11], v[144:147], 0
  v_mfma_f32_16x16x32_bf16 v[84:87], v[8:11], v[148:151], 0
  v_mfma_f32_16x16x32_bf16 v[88:91], v[8:11], v[152:155], 0
  v_mfma_f32_16x16x32_bf16 v[92:95], v[8:11], v[156:159], 0
  v_cmp_eq_u32 s[40:41], 1, v4
  v_cmp_eq_u32 s[42:43], 2, v4
  v_cmp_eq_u32 s[46:47], 3, v4
  s_and_b32 s44, s24, 7
  s_lshl_b32 s44, s44, 11
  s_lshl_b32 s30, s22, 9
  s_add_u32 s44, s44, s30
  s_add_u32 s44, s44, 0x160c000
  v_lshlrev_b32 v5, 2, v1
  v_cndmask_b32 v64, v64, v68, s[40:41]
  v_cndmask_b32 v64, v64, v72, s[42:43]
  v_cndmask_b32 v64, v64, v76, s[46:47]
  buffer_atomic_add_f32 v64, v5, s[16:19], s44 offen offset:0
  v_cndmask_b32 v80, v80, v84, s[40:41]
  v_cndmask_b32 v80, v80, v88, s[42:43]
  v_cndmask_b32 v80, v80, v92, s[46:47]
  buffer_atomic_add_f32 v80, v5, s[16:19], s44 offen offset:256
  s_branch qkv2_kernel_ffn_end
qkv2_kernel_ffn_dma:
  s_load_dwordx4 s[4:7], s[0:1], 40
  s_load_dwordx2 s[26:27], s[0:1], 56
  s_sub_u32 s45, s22, 4
  v_lshrrev_b32 v4, 2, v1
  s_lshl_b32 s41, s45, 7
  v_add_u32 v4, s41, v4
  s_movk_i32 s42, 3584
  v_mul_lo_u32 v4, v4, s42
  v_and_b32 v5, 3, v1
  v_lshl_add_u32 v4, v5, 4, v4
  s_lshl_b32 s41, s24, 6
  v_add_u32 v4, s41, v4
  s_lshl_b32 s43, s45, 13
  s_waitcnt lgkmcnt(0)
  s_mov_b32 s8, s4
  s_and_b32 s9, s5, 0xffff
  s_mov_b32 s10, 0x1c0000
  s_mov_b32 s11, 0x20000
  s_mov_b32 s12, s6
  s_and_b32 s13, s7, 0xffff
  s_mov_b32 s14, 0x1c0000
  s_mov_b32 s15, 0x20000
  s_mov_b32 s32, s26
  s_and_b32 s33, s27, 0xffff
  s_mov_b32 s34, 0x1c0000
  s_mov_b32 s35, 0x20000
  s_barrier
  s_add_u32 m0, s43, 4352
  s_mov_b32 s44, 0
  buffer_load_dwordx4 v4, s[8:11], s44 offen lds
  s_add_u32 m0, s43, 37152
  s_mov_b32 s44, 0
  buffer_load_dwordx4 v4, s[12:15], s44 offen lds
  s_add_u32 m0, s43, 5376
  s_mov_b32 s44, 57344
  buffer_load_dwordx4 v4, s[8:11], s44 offen lds
  s_add_u32 m0, s43, 38176
  s_mov_b32 s44, 57344
  buffer_load_dwordx4 v4, s[12:15], s44 offen lds
  s_add_u32 m0, s43, 6400
  s_mov_b32 s44, 114688
  buffer_load_dwordx4 v4, s[8:11], s44 offen lds
  s_add_u32 m0, s43, 39200
  s_mov_b32 s44, 114688
  buffer_load_dwordx4 v4, s[12:15], s44 offen lds
  s_add_u32 m0, s43, 7424
  s_mov_b32 s44, 172032
  buffer_load_dwordx4 v4, s[8:11], s44 offen lds
  s_add_u32 m0, s43, 40224
  s_mov_b32 s44, 172032
  buffer_load_dwordx4 v4, s[12:15], s44 offen lds
  s_add_u32 m0, s43, 8448
  s_mov_b32 s44, 229376
  buffer_load_dwordx4 v4, s[8:11], s44 offen lds
  s_add_u32 m0, s43, 41248
  s_mov_b32 s44, 229376
  buffer_load_dwordx4 v4, s[12:15], s44 offen lds
  s_add_u32 m0, s43, 9472
  s_mov_b32 s44, 286720
  buffer_load_dwordx4 v4, s[8:11], s44 offen lds
  s_add_u32 m0, s43, 42272
  s_mov_b32 s44, 286720
  buffer_load_dwordx4 v4, s[12:15], s44 offen lds
  s_add_u32 m0, s43, 10496
  s_mov_b32 s44, 344064
  buffer_load_dwordx4 v4, s[8:11], s44 offen lds
  s_add_u32 m0, s43, 43296
  s_mov_b32 s44, 344064
  buffer_load_dwordx4 v4, s[12:15], s44 offen lds
  s_add_u32 m0, s43, 11520
  s_mov_b32 s44, 401408
  buffer_load_dwordx4 v4, s[8:11], s44 offen lds
  s_add_u32 m0, s43, 44320
  s_mov_b32 s44, 401408
  buffer_load_dwordx4 v4, s[12:15], s44 offen lds
  s_lshl_b32 s41, s24, 5
  s_lshl_b32 s42, s45, 3
  s_add_u32 s41, s41, s42
  s_lshl_b32 s41, s41, 10
  s_mul_i32 s43, s42, 1088
  s_add_u32 s43, s43, 69952
  s_mov_b32 m0, s43
  s_add_u32 s43, s43, 1088
  buffer_load_dwordx4 v3, s[32:35], s41 offen lds
  s_add_u32 s41, s41, 1024
  s_mov_b32 m0, s43
  s_add_u32 s43, s43, 1088
  buffer_load_dwordx4 v3, s[32:35], s41 offen lds
  s_add_u32 s41, s41, 1024
  s_mov_b32 m0, s43
  s_add_u32 s43, s43, 1088
  buffer_load_dwordx4 v3, s[32:35], s41 offen lds
  s_add_u32 s41, s41, 1024
  s_mov_b32 m0, s43
  s_add_u32 s43, s43, 1088
  buffer_load_dwordx4 v3, s[32:35], s41 offen lds
  s_add_u32 s41, s41, 1024
  s_mov_b32 m0, s43
  s_add_u32 s43, s43, 1088
  buffer_load_dwordx4 v3, s[32:35], s41 offen lds
  s_add_u32 s41, s41, 1024
  s_mov_b32 m0, s43
  s_add_u32 s43, s43, 1088
  buffer_load_dwordx4 v3, s[32:35], s41 offen lds
  s_add_u32 s41, s41, 1024
  s_mov_b32 m0, s43
  s_add_u32 s43, s43, 1088
  buffer_load_dwordx4 v3, s[32:35], s41 offen lds
  s_add_u32 s41, s41, 1024
  s_mov_b32 m0, s43
  s_add_u32 s43, s43, 1088
  buffer_load_dwordx4 v3, s[32:35], s41 offen lds
  s_add_u32 s41, s41, 1024
  s_barrier
  s_waitcnt vmcnt(0)
  s_barrier
  s_endpgm
qkv2_kernel_ffn_end:
qkv2_kernel_done:
qkv2_kernel_end:
  s_endpgm
qkv2_kernel_codeend:
.globl attn2_kernel
.p2align 8
.type attn2_kernel,@function
attn2_kernel:
  s_cmp_ge_u32 s2, 304
  s_cbranch_scc1 attn2_kernel_end
  s_load_dwordx2 s[20:21], s[0:1], 80
  v_lshrrev_b32 v2, 6, v0
  v_and_b32 v1, 63, v0
  v_readfirstlane_b32 s22, v2
  s_and_b32 s23, s2, 7
  s_lshr_b32 s24, s2, 3
  s_sub_u32 s24, s24, 6
  s_load_dwordx2 s[6:7], s[0:1], 8
  s_load_dwordx4 s[32:35], s[0:1], 40
  s_load_dwordx2 s[36:37], s[0:1], 56
  s_waitcnt lgkmcnt(0)
  s_mov_b32 s16, s20
  s_and_b32 s17, s21, 0xffff
  s_mov_b32 s18, 0x10000000
  s_mov_b32 s19, 0x20000
  s_cmp_lt_u32 s2, 48
  s_cbranch_scc1 attn2_kernel_finisher
  v_lshrrev_b32 v3, 4, v0
  s_lshl_b32 s25, s23, 3
  v_add_u32 v3, s25, v3
  v_mov_b32 v5, 0x3f803f80
  v_cmp_le_u32 s[26:27], 8, v3
  v_lshlrev_b32 v6, 2, v0
  s_nop 0
  v_cndmask_b32 v5, 0, v5, s[26:27]
  v_cmp_gt_u32 vcc, 256, v0
  s_nop 0
  s_and_saveexec_b64 s[28:29], vcc
  ds_write_b32 v6, v5 offset:32768
  s_mov_b64 exec, s[28:29]
  s_waitcnt lgkmcnt(0)
  s_add_u32 s4, s20, 0x161a000
  s_addc_u32 s5, s21, 0
  s_load_dwordx4 s[56:59], s[4:5], 0
  s_mov_b32 s16, s20
  s_and_b32 s17, s21, 0xffff
  s_mov_b32 s18, 0x10000000
  s_mov_b32 s19, 0x20000
  s_lshl_b32 s25, s24, 16
  s_add_u32 s8, s20, s25
  s_addc_u32 s9, s21, 0
  s_add_u32 s12, s8, 0xc00000
  s_addc_u32 s13, s9, 0
  s_add_u32 s8, s8, 0xa00000
  s_addc_u32 s9, s9, 0
  s_and_b32 s9, s9, 0xffff
  s_and_b32 s13, s13, 0xffff
  s_mov_b32 s10, 0x10000
  s_mov_b32 s11, 0x20000
  s_mov_b32 s14, 0x10000
  s_mov_b32 s15, 0x20000
  s_lshl_b32 s25, s23, 3
  s_add_u32 s25, s25, s22
  s_lshl_b32 s26, s25, 10
  s_sub_u32 s25, s25, 8
  s_lshl_b32 s25, s25, 10
  s_cmp_lt_i32 s25, 0
  s_cselect_b32 s25, 0x40000000, s25
  v_lshl_add_u32 v3, v1, 4, s25
  v_lshl_add_u32 v2, v1, 4, s26
  s_lshl_b32 s27, s22, 10
  s_add_u32 m0, s27, 0
  s_nop 0
  buffer_load_dwordx4 v3, s[8:11], 0 offen lds
  s_add_u32 m0, s27, 16384
  s_nop 0
  buffer_load_dwordx4 v3, s[12:15], 0 offen lds
  s_lshl_b32 s25, s24, 16
  s_add_u32 s25, s25, s26
  s_add_u32 s25, s25, 0x800000
  v_lshlrev_b32 v3, 4, v1
  buffer_load_dwordx4 v[4:7], v3, s[16:19], s25 offen
  s_add_u32 m0, s27, 8192
  s_nop 0
  buffer_load_dwordx4 v2, s[8:11], 0 offen lds
  s_add_u32 m0, s27, 24576
  s_nop 0
  buffer_load_dwordx4 v2, s[12:15], 0 offen lds
  v_and_b32 v2, 31, v1
  v_lshrrev_b32 v3, 5, v1
  v_lshlrev_b32 v3, 2, v3
  v_sub_u32 v2, v2, v3
  v_mov_b32 v8, 0xf149f2ca
  v_mov_b32 v9, 0
  v_cmp_gt_i32 s[26:27], 0, v2
  s_nop 1
  v_cndmask_b32 v88, v8, v9, s[26:27]
  v_cndmask_b32 v104, v9, v8, s[26:27]
  v_cmp_gt_i32 s[28:29], 1, v2
  s_nop 1
  v_cndmask_b32 v89, v8, v9, s[28:29]
  v_cndmask_b32 v105, v9, v8, s[28:29]
  v_cmp_gt_i32 s[26:27], 2, v2
  s_nop 1
  v_cndmask_b32 v90, v8, v9, s[26:27]
  v_cndmask_b32 v106, v9, v8, s[26:27]
  v_cmp_gt_i32 s[28:29], 3, v2
  s_nop 1
  v_cndmask_b32 v91, v8, v9, s[28:29]
  v_cndmask_b32 v107, v9, v8, s[28:29]
  v_cmp_gt_i32 s[26:27], 8, v2
  s_nop 1
  v_cndmask_b32 v92, v8, v9, s[26:27]
  v_cndmask_b32 v108, v9, v8, s[26:27]
  v_cmp_gt_i32 s[28:29], 9, v2
  s_nop 1
  v_cndmask_b32 v93, v8, v9, s[28:29]
  v_cndmask_b32 v109, v9, v8, s[28:29]
  v_cmp_gt_i32 s[26:27], 10, v2
  s_nop 1
  v_cndmask_b32 v94, v8, v9, s[26:27]
  v_cndmask_b32 v110, v9, v8, s[26:27]
  v_cmp_gt_i32 s[28:29], 11, v2
  s_nop 1
  v_cndmask_b32 v95, v8, v9, s[28:29]
  v_cndmask_b32 v111, v9, v8, s[28:29]
  v_cmp_gt_i32 s[26:27], 16, v2
  s_nop 1
  v_cndmask_b32 v96, v8, v9, s[26:27]
  v_cndmask_b32 v112, v9, v8, s[26:27]
  v_cmp_gt_i32 s[28:29], 17, v2
  s_nop 1
  v_cndmask_b32 v97, v8, v9, s[28:29]
  v_cndmask_b32 v113, v9, v8, s[28:29]
  v_cmp_gt_i32 s[26:27], 18, v2
  s_nop 1
  v_cndmask_b32 v98, v8, v9, s[26:27]
  v_cndmask_b32 v114, v9, v8, s[26:27]
  v_cmp_gt_i32 s[28:29], 19, v2
  s_nop 1
  v_cndmask_b32 v99, v8, v9, s[28:29]
  v_cndmask_b32 v115, v9, v8, s[28:29]
  v_cmp_gt_i32 s[26:27], 24, v2
  s_nop 1
  v_cndmask_b32 v100, v8, v9, s[26:27]
  v_cndmask_b32 v116, v9, v8, s[26:27]
  v_cmp_gt_i32 s[28:29], 25, v2
  s_nop 1
  v_cndmask_b32 v101, v8, v9, s[28:29]
  v_cndmask_b32 v117, v9, v8, s[28:29]
  v_cmp_gt_i32 s[26:27], 26, v2
  s_nop 1
  v_cndmask_b32 v102, v8, v9, s[26:27]
  v_cndmask_b32 v118, v9, v8, s[26:27]
  v_cmp_gt_i32 s[28:29], 27, v2
  s_nop 1
  v_cndmask_b32 v103, v8, v9, s[28:29]
  v_cndmask_b32 v119, v9, v8, s[28:29]
  s_lshl_b32 s25, s22, 10
  v_lshl_add_u32 v120, v1, 4, s25
  v_bfe_u32 v2, v1, 4, 1
  v_lshrrev_b32 v3, 5, v1
  v_and_b32 v8, 15, v1
  v_lshlrev_b32 v9, 8, v3
  v_lshl_add_u32 v9, v8, 4, v9
  v_add_u32 v9, s25, v9
  v_add_u32 v9, 16384, v9
  s_lshl_b32 s26, s22, 6
  v_lshlrev_b32 v10, 4, v3
  v_add_u32 v10, s26, v10
  v_add_u32 v10, 32768, v10
  v_cmp_eq_u32 s[26:27], 0, v2
  v_mov_b32 v11, 1024
  s_nop 0
  v_cndmask_b32 v121, v10, v9, s[26:27]
  v_cndmask_b32 v122, 64, v11, s[26:27]
  v_mov_b32 v11, 512
  v_cndmask_b32 v123, 32, v11, s[26:27]
  v_add_u32 v123, v123, v121
  s_waitcnt lgkmcnt(0)
  s_lshr_b32 s25, s56, 8
  s_sub_u32 s26, s23, s25
  s_cmp_le_u32 s26, 1
  s_cbranch_scc1 attn2_kernel_patch
  s_cmp_lt_u32 s22, 2
  s_cbranch_scc1 attn2_kernel_pa0
  s_waitcnt vmcnt(2)
  s_branch attn2_kernel_pa1
attn2_kernel_pa0:
  s_waitcnt vmcnt(0)
attn2_kernel_pa1:
  s_barrier
  s_branch attn2_kernel_nopatch
attn2_kernel_patch:
  s_waitcnt vmcnt(0)
  s_barrier
  s_cmp_lg_u32 s22, 0
  s_cbranch_scc1 attn2_kernel_patchdone
  v_lshrrev_b32 v20, 4, v1
  v_and_b32 v21, 15, v1
  v_min_u32 v20, 2, v20
  v_lshlrev_b32 v8, 11, v20
  v_lshl_add_u32 v8, v21, 2, v8
  s_lshl_b32 s25, s24, 6
  s_add_u32 s25, s25, 0x1614000
  s_mov_b32 s26, 0
attn2_kernel_poll:
  buffer_load_dword v12, v8, s[16:19], s25 offen sc1
  s_add_u32 s26, s26, 1
  s_waitcnt vmcnt(0)
  v_lshrrev_b32 v13, 16, v12
  v_cmp_ne_u32 vcc, 0x5a5a, v13
  s_cmp_ge_u32 s26, 0x40000
  s_cbranch_scc1 attn2_kernel_pollend
  s_cbranch_vccnz attn2_kernel_poll
attn2_kernel_pollend:
  v_and_b32 v22, 3, v21
  v_bfe_u32 v23, v21, 3, 1
  v_lshl_add_u32 v22, v23, 2, v22
  v_bfe_u32 v23, v21, 2, 1
  v_lshl_add_u32 v22, v23, 3, v22
  s_lshr_b32 s25, s56, 5
  s_lshl_b32 s30, s23, 3
  s_sub_u32 s25, s25, s30
  s_add_u32 s25, s25, 8
  s_lshl_b32 s25, s25, 10
  s_and_b32 s30, s56, 31
  v_lshrrev_b32 v15, 3, v21
  v_lshlrev_b32 v15, 9, v15
  v_and_b32 v16, 7, v21
  v_lshl_add_u32 v15, v16, 1, v15
  s_lshl_b32 s31, s30, 4
  s_add_u32 s31, s31, s25
  v_add_u32 v15, s31, v15
  s_lshr_b32 s31, s30, 4
  s_lshl_b32 s31, s31, 9
  s_add_u32 s25, s25, s31
  s_bfe_u32 s31, s30, 0x10002
  s_lshl_b32 s31, s31, 8
  s_add_u32 s25, s25, s31
  s_and_b32 s31, s30, 3
  s_bfe_u32 s39, s30, 0x10003
  s_lshl_b32 s39, s39, 2
  s_add_u32 s31, s31, s39
  s_lshl_b32 s31, s31, 1
  s_add_u32 s25, s25, s31
  s_add_u32 s25, s25, 16384
  v_lshlrev_b32 v16, 4, v22
  v_add_u32 v16, s25, v16
  v_lshlrev_b32 v17, 1, v21
  v_add_u32 v17, 33792, v17
  v_cmp_eq_u32 s[28:29], 1, v20
  s_nop 1
  v_cndmask_b32 v17, v17, v15, s[28:29]
  v_cmp_eq_u32 s[28:29], 2, v20
  s_nop 1
  v_cndmask_b32 v17, v17, v16, s[28:29]
  ds_write_b16 v17, v12
attn2_kernel_patchdone:
  s_waitcnt lgkmcnt(0)
  s_barrier
  s_lshr_b32 s25, s56, 5
  s_lshl_b32 s26, s23, 3
  s_add_u32 s26, s26, s22
  s_cmp_lg_u32 s25, s26
  s_cbranch_scc1 attn2_kernel_nopatch
  v_lshrrev_b32 v8, 5, v1
  v_lshlrev_b32 v8, 4, v8
  ds_read_b128 v[12:15], v8 offset:33792
  v_and_b32 v9, 31, v1
  s_and_b32 s25, s56, 31
  v_cmp_eq_u32 s[26:27], s25, v9
  s_waitcnt lgkmcnt(0)
  s_nop 0
  v_cndmask_b32 v4, v4, v12, s[26:27]
  v_cndmask_b32 v5, v5, v13, s[26:27]
  v_cndmask_b32 v6, v6, v14, s[26:27]
  v_cndmask_b32 v7, v7, v15, s[26:27]
attn2_kernel_nopatch:
  ds_read_b128 v[8:11], v120 offset:0
  ds_read_b128 v[12:15], v120 offset:1024
  ds_read_b128 v[16:19], v121
  ds_read_b128 v[20:23], v123
  v_add_u32 v121, v122, v121
  v_add_u32 v123, v122, v123
  s_waitcnt lgkmcnt(3)
  v_mfma_f32_32x32x16_bf16 v[32:47], v[8:11], v[4:7], v[88:103]
  s_waitcnt lgkmcnt(2)
  v_mfma_f32_32x32x16_bf16 v[48:63], v[12:15], v[4:7], 0
  ds_read_b128 v[8:11], v120 offset:2048
  ds_read_b128 v[24:27], v121
  ds_read_b128 v[28:31], v123
  v_add_u32 v121, v122, v121
  v_add_u32 v123, v122, v123
  s_nop 4
  v_exp_f32 v32, v32
  v_exp_f32 v33, v33
  v_exp_f32 v34, v34
  v_exp_f32 v35, v35
  v_exp_f32 v36, v36
  v_exp_f32 v37, v37
  v_exp_f32 v38, v38
  v_exp_f32 v39, v39
  v_exp_f32 v40, v40
  v_exp_f32 v41, v41
  v_exp_f32 v42, v42
  v_exp_f32 v43, v43
  v_exp_f32 v44, v44
  v_exp_f32 v45, v45
  v_exp_f32 v46, v46
  v_exp_f32 v47, v47
  v_cvt_pk_bf16_f32 v64, v32, v33
  v_cvt_pk_bf16_f32 v65, v34, v35
  v_cvt_pk_bf16_f32 v66, v36, v37
  v_cvt_pk_bf16_f32 v67, v38, v39
  v_cvt_pk_bf16_f32 v68, v40, v41
  v_cvt_pk_bf16_f32 v69, v42, v43
  v_cvt_pk_bf16_f32 v70, v44, v45
  v_cvt_pk_bf16_f32 v71, v46, v47
  s_waitcnt lgkmcnt(3)
  v_mfma_f32_32x32x16_bf16 v[72:87], v[16:19], v[64:67], 0
  v_mfma_f32_32x32x16_bf16 v[72:87], v[20:23], v[68:71], v[72:87]
  s_waitcnt vmcnt(0)
  s_barrier
  s_cmp_lg_u32 s22, 7
  s_cbranch_scc1 attn2_kernel_noct
  s_mov_b32 s31, s24
  s_getpc_b64 s[76:77]
attn2_kernel_pc0:
  s_add_u32 s76, s76, (attn2_kernel_codeend-attn2_kernel_pc0)
  s_addc_u32 s77, s77, 0
  s_and_b32 s77, s77, 0xffff
  s_mov_b32 s78, (all_code_end-attn2_kernel_codeend)
  s_mov_b32 s79, 0x20000
  s_mul_i32 s31, s31, 1536
  v_lshlrev_b32 v2, 7, v1
  s_mov_b32 exec_lo, 0xfff
  s_mov_b32 exec_hi, 0
  buffer_load_dword v127, v2, s[76:79], s31 offen
  s_mov_b64 exec, -1
attn2_kernel_noct:
  s_lshl_b32 s30, s24, 3
  s_add_u32 s30, s30, s22
  s_mov_b32 s60, s32
  s_and_b32 s61, s33, 0xffff
  s_mov_b32 s62, 0x1c0000
  s_mov_b32 s63, 0x20000
  s_mov_b32 s64, s34
  s_and_b32 s65, s35, 0xffff
  s_mov_b32 s66, 0x1c0000
  s_mov_b32 s67, 0x20000
  s_mov_b32 s68, s36
  s_and_b32 s69, s37, 0xffff
  s_mov_b32 s70, 0x1c0000
  s_mov_b32 s71, 0x20000
  v_mul_u32_u24 v2, 205, v1
  v_lshrrev_b32 v2, 10, v2
  v_mul_u32_u24 v3, 5, v2
  v_sub_u32 v3, v1, v3
  s_lshl_b32 s31, s30, 1
  v_add_u32 v2, s31, v2
  s_movk_i32 s31, 3584
  v_mul_lo_u32 v2, v2, s31
  s_mul_i32 s31, s23, 448
  s_and_b32 s31, s31, 0xffffff80
  v_lshl_add_u32 v2, v3, 7, v2
  v_add_u32 v2, s31, v2
  s_mov_b32 exec_lo, 0x3ff
  s_mov_b32 exec_hi, 0
  buffer_load_dword v124, v2, s[60:63], 0 offen
  buffer_load_dword v125, v2, s[64:67], 0 offen
  s_mov_b64 exec, -1
  s_mul_i32 s38, s23, 229376
  s_mul_i32 s31, s30, 896
  s_add_u32 s31, s31, s38
  v_lshlrev_b32 v2, 7, v1
  s_mov_b32 exec_lo, 0x7f
  s_mov_b32 exec_hi, 0x0
  buffer_load_dword v126, v2, s[68:71], s31 offen
  s_mov_b64 exec, -1
  s_waitcnt lgkmcnt(2)
  v_mfma_f32_32x32x16_bf16 v[32:47], v[8:11], v[4:7], 0
  ds_read_b128 v[12:15], v120 offset:3072
  ds_read_b128 v[16:19], v121
  ds_read_b128 v[20:23], v123
  v_add_u32 v121, v122, v121
  v_add_u32 v123, v122, v123
  v_exp_f32 v48, v48
  v_exp_f32 v49, v49
  v_exp_f32 v50, v50
  v_exp_f32 v51, v51
  v_exp_f32 v52, v52
  v_exp_f32 v53, v53
  v_exp_f32 v54, v54
  v_exp_f32 v55, v55
  v_exp_f32 v56, v56
  v_exp_f32 v57, v57
  v_exp_f32 v58, v58
  v_exp_f32 v59, v59
  v_exp_f32 v60, v60
  v_exp_f32 v61, v61
  v_exp_f32 v62, v62
  v_exp_f32 v63, v63
  v_cvt_pk_bf16_f32 v64, v48, v49
  v_cvt_pk_bf16_f32 v65, v50, v51
  v_cvt_pk_bf16_f32 v66, v52, v53
  v_cvt_pk_bf16_f32 v67, v54, v55
  v_cvt_pk_bf16_f32 v68, v56, v57
  v_cvt_pk_bf16_f32 v69, v58, v59
  v_cvt_pk_bf16_f32 v70, v60, v61
  v_cvt_pk_bf16_f32 v71, v62, v63
  s_waitcnt lgkmcnt(3)
  v_mfma_f32_32x32x16_bf16 v[72:87], v[24:27], v[64:67], v[72:87]
  v_mfma_f32_32x32x16_bf16 v[72:87], v[28:31], v[68:71], v[72:87]
  s_waitcnt lgkmcnt(2)
  v_mfma_f32_32x32x16_bf16 v[48:63], v[12:15], v[4:7], 0
  ds_read_b128 v[8:11], v120 offset:4096
  ds_read_b128 v[24:27], v121
  ds_read_b128 v[28:31], v123
  v_add_u32 v121, v122, v121
  v_add_u32 v123, v122, v123
  v_exp_f32 v32, v32
  v_exp_f32 v33, v33
  v_exp_f32 v34, v34
  v_exp_f32 v35, v35
  v_exp_f32 v36, v36
  v_exp_f32 v37, v37
  v_exp_f32 v38, v38
  v_exp_f32 v39, v39
  v_exp_f32 v40, v40
  v_exp_f32 v41, v41
  v_exp_f32 v42, v42
  v_exp_f32 v43, v43
  v_exp_f32 v44, v44
  v_exp_f32 v45, v45
  v_exp_f32 v46, v46
  v_exp_f32 v47, v47
  v_cvt_pk_bf16_f32 v64, v32, v33
  v_cvt_pk_bf16_f32 v65, v34, v35
  v_cvt_pk_bf16_f32 v66, v36, v37
  v_cvt_pk_bf16_f32 v67, v38, v39
  v_cvt_pk_bf16_f32 v68, v40, v41
  v_cvt_pk_bf16_f32 v69, v42, v43
  v_cvt_pk_bf16_f32 v70, v44, v45
  v_cvt_pk_bf16_f32 v71, v46, v47
  s_waitcnt lgkmcnt(3)
  v_mfma_f32_32x32x16_bf16 v[72:87], v[16:19], v[64:67], v[72:87]
  v_mfma_f32_32x32x16_bf16 v[72:87], v[20:23], v[68:71], v[72:87]
  s_waitcnt lgkmcnt(2)
  v_mfma_f32_32x32x16_bf16 v[32:47], v[8:11], v[4:7], 0
  ds_read_b128 v[12:15], v120 offset:5120
  ds_read_b128 v[16:19], v121
  ds_read_b128 v[20:23], v123
  v_add_u32 v121, v122, v121
  v_add_u32 v123, v122, v123
  v_exp_f32 v48, v48
  v_exp_f32 v49, v49
  v_exp_f32 v50, v50
  v_exp_f32 v51, v51
  v_exp_f32 v52, v52
  v_exp_f32 v53, v53
  v_exp_f32 v54, v54
  v_exp_f32 v55, v55
  v_exp_f32 v56, v56
  v_exp_f32 v57, v57
  v_exp_f32 v58, v58
  v_exp_f32 v59, v59
  v_exp_f32 v60, v60
  v_exp_f32 v61, v61
  v_exp_f32 v62, v62
  v_exp_f32 v63, v63
  v_cvt_pk_bf16_f32 v64, v48, v49
  v_cvt_pk_bf16_f32 v65, v50, v51
  v_cvt_pk_bf16_f32 v66, v52, v53
  v_cvt_pk_bf16_f32 v67, v54, v55
  v_cvt_pk_bf16_f32 v68, v56, v57
  v_cvt_pk_bf16_f32 v69, v58, v59
  v_cvt_pk_bf16_f32 v70, v60, v61
  v_cvt_pk_bf16_f32 v71, v62, v63
  s_waitcnt lgkmcnt(3)
  v_mfma_f32_32x32x16_bf16 v[72:87], v[24:27], v[64:67], v[72:87]
  v_mfma_f32_32x32x16_bf16 v[72:87], v[28:31], v[68:71], v[72:87]
  s_waitcnt lgkmcnt(2)
  v_mfma_f32_32x32x16_bf16 v[48:63], v[12:15], v[4:7], 0
  ds_read_b128 v[8:11], v120 offset:6144
  ds_read_b128 v[24:27], v121
  ds_read_b128 v[28:31], v123
  v_add_u32 v121, v122, v121
  v_add_u32 v123, v122, v123
  v_exp_f32 v32, v32
  v_exp_f32 v33, v33
  v_exp_f32 v34, v34
  v_exp_f32 v35, v35
  v_exp_f32 v36, v36
  v_exp_f32 v37, v37
  v_exp_f32 v38, v38
  v_exp_f32 v39, v39
  v_exp_f32 v40, v40
  v_exp_f32 v41, v41
  v_exp_f32 v42, v42
  v_exp_f32 v43, v43
  v_exp_f32 v44, v44
  v_exp_f32 v45, v45
  v_exp_f32 v46, v46
  v_exp_f32 v47, v47
  v_cvt_pk_bf16_f32 v64, v32, v33
  v_cvt_pk_bf16_f32 v65, v34, v35
  v_cvt_pk_bf16_f32 v66, v36, v37
  v_cvt_pk_bf16_f32 v67, v38, v39
  v_cvt_pk_bf16_f32 v68, v40, v41
  v_cvt_pk_bf16_f32 v69, v42, v43
  v_cvt_pk_bf16_f32 v70, v44, v45
  v_cvt_pk_bf16_f32 v71, v46, v47
  s_waitcnt lgkmcnt(3)
  v_mfma_f32_32x32x16_bf16 v[72:87], v[16:19], v[64:67], v[72:87]
  v_mfma_f32_32x32x16_bf16 v[72:87], v[20:23], v[68:71], v[72:87]
  s_waitcnt lgkmcnt(2)
  v_mfma_f32_32x32x16_bf16 v[32:47], v[8:11], v[4:7], 0
  ds_read_b128 v[12:15], v120 offset:7168
  ds_read_b128 v[16:19], v121
  ds_read_b128 v[20:23], v123
  v_add_u32 v121, v122, v121
  v_add_u32 v123, v122, v123
  v_exp_f32 v48, v48
  v_exp_f32 v49, v49
  v_exp_f32 v50, v50
  v_exp_f32 v51, v51
  v_exp_f32 v52, v52
  v_exp_f32 v53, v53
  v_exp_f32 v54, v54
  v_exp_f32 v55, v55
  v_exp_f32 v56, v56
  v_exp_f32 v57, v57
  v_exp_f32 v58, v58
  v_exp_f32 v59, v59
  v_exp_f32 v60, v60
  v_exp_f32 v61, v61
  v_exp_f32 v62, v62
  v_exp_f32 v63, v63
  v_cvt_pk_bf16_f32 v64, v48, v49
  v_cvt_pk_bf16_f32 v65, v50, v51
  v_cvt_pk_bf16_f32 v66, v52, v53
  v_cvt_pk_bf16_f32 v67, v54, v55
  v_cvt_pk_bf16_f32 v68, v56, v57
  v_cvt_pk_bf16_f32 v69, v58, v59
  v_cvt_pk_bf16_f32 v70, v60, v61
  v_cvt_pk_bf16_f32 v71, v62, v63
  s_waitcnt lgkmcnt(3)
  v_mfma_f32_32x32x16_bf16 v[72:87], v[24:27], v[64:67], v[72:87]
  v_mfma_f32_32x32x16_bf16 v[72:87], v[28:31], v[68:71], v[72:87]
  s_waitcnt lgkmcnt(2)
  v_mfma_f32_32x32x16_bf16 v[48:63], v[12:15], v[4:7], 0
  ds_read_b128 v[8:11], v120 offset:8192
  ds_read_b128 v[24:27], v121
  ds_read_b128 v[28:31], v123
  v_add_u32 v121, v122, v121
  v_add_u32 v123, v122, v123
  v_exp_f32 v32, v32
  v_exp_f32 v33, v33
  v_exp_f32 v34, v34
  v_exp_f32 v35, v35
  v_exp_f32 v36, v36
  v_exp_f32 v37, v37
  v_exp_f32 v38, v38
  v_exp_f32 v39, v39
  v_exp_f32 v40, v40
  v_exp_f32 v41, v41
  v_exp_f32 v42, v42
  v_exp_f32 v43, v43
  v_exp_f32 v44, v44
  v_exp_f32 v45, v45
  v_exp_f32 v46, v46
  v_exp_f32 v47, v47
  v_cvt_pk_bf16_f32 v64, v32, v33
  v_cvt_pk_bf16_f32 v65, v34, v35
  v_cvt_pk_bf16_f32 v66, v36, v37
  v_cvt_pk_bf16_f32 v67, v38, v39
  v_cvt_pk_bf16_f32 v68, v40, v41
  v_cvt_pk_bf16_f32 v69, v42, v43
  v_cvt_pk_bf16_f32 v70, v44, v45
  v_cvt_pk_bf16_f32 v71, v46, v47
  s_waitcnt lgkmcnt(3)
  v_mfma_f32_32x32x16_bf16 v[72:87], v[16:19], v[64:67], v[72:87]
  v_mfma_f32_32x32x16_bf16 v[72:87], v[20:23], v[68:71], v[72:87]
  s_waitcnt lgkmcnt(2)
  v_mfma_f32_32x32x16_bf16 v[32:47], v[8:11], v[4:7], v[104:119]
  ds_read_b128 v[16:19], v121
  ds_read_b128 v[20:23], v123
  v_add_u32 v121, v122, v121
  v_add_u32 v123, v122, v123
  v_exp_f32 v48, v48
  v_exp_f32 v49, v49
  v_exp_f32 v50, v50
  v_exp_f32 v51, v51
  v_exp_f32 v52, v52
  v_exp_f32 v53, v53
  v_exp_f32 v54, v54
  v_exp_f32 v55, v55
  v_exp_f32 v56, v56
  v_exp_f32 v57, v57
  v_exp_f32 v58, v58
  v_exp_f32 v59, v59
  v_exp_f32 v60, v60
  v_exp_f32 v61, v61
  v_exp_f32 v62, v62
  v_exp_f32 v63, v63
  v_cvt_pk_bf16_f32 v64, v48, v49
  v_cvt_pk_bf16_f32 v65, v50, v51
  v_cvt_pk_bf16_f32 v66, v52, v53
  v_cvt_pk_bf16_f32 v67, v54, v55
  v_cvt_pk_bf16_f32 v68, v56, v57
  v_cvt_pk_bf16_f32 v69, v58, v59
  v_cvt_pk_bf16_f32 v70, v60, v61
  v_cvt_pk_bf16_f32 v71, v62, v63
  s_waitcnt lgkmcnt(2)
  v_mfma_f32_32x32x16_bf16 v[72:87], v[24:27], v[64:67], v[72:87]
  v_mfma_f32_32x32x16_bf16 v[72:87], v[28:31], v[68:71], v[72:87]
  v_exp_f32 v32, v32
  v_exp_f32 v33, v33
  v_exp_f32 v34, v34
  v_exp_f32 v35, v35
  v_exp_f32 v36, v36
  v_exp_f32 v37, v37
  v_exp_f32 v38, v38
  v_exp_f32 v39, v39
  v_exp_f32 v40, v40
  v_exp_f32 v41, v41
  v_exp_f32 v42, v42
  v_exp_f32 v43, v43
  v_exp_f32 v44, v44
  v_exp_f32 v45, v45
  v_exp_f32 v46, v46
  v_exp_f32 v47, v47
  v_cvt_pk_bf16_f32 v64, v32, v33
  v_cvt_pk_bf16_f32 v65, v34, v35
  v_cvt_pk_bf16_f32 v66, v36, v37
  v_cvt_pk_bf16_f32 v67, v38, v39
  v_cvt_pk_bf16_f32 v68, v40, v41
  v_cvt_pk_bf16_f32 v69, v42, v43
  v_cvt_pk_bf16_f32 v70, v44, v45
  v_cvt_pk_bf16_f32 v71, v46, v47
  s_waitcnt lgkmcnt(0)
  v_mfma_f32_32x32x16_bf16 v[72:87], v[16:19], v[64:67], v[72:87]
  v_mfma_f32_32x32x16_bf16 v[72:87], v[20:23], v[68:71], v[72:87]
  v_mov_b32 v8, 0x21800000
  v_mov_b32 v9, 0x5d800000
  s_nop 9
  v_cmp_le_f32 s[26:27], v8, v80
  v_cmp_ge_f32 s[28:29], v9, v80
  s_nop 0
  s_and_b64 s[26:27], s[26:27], s[28:29]
  s_cmp_eq_u64 s[26:27], -1
  s_cbranch_scc0 attn2_kernel_fallback
attn2_kernel_finish:
  v_rcp_f32 v8, v80
  s_nop 0
  v_mul_f32 v72, v8, v72
  v_mul_f32 v73, v8, v73
  v_mul_f32 v74, v8, v74
  v_mul_f32 v75, v8, v75
  v_mul_f32 v76, v8, v76
  v_mul_f32 v77, v8, v77
  v_mul_f32 v78, v8, v78
  v_mul_f32 v79, v8, v79
  v_cvt_pk_bf16_f32 v64, v72, v73
  v_cvt_pk_bf16_f32 v65, v74, v75
  v_cvt_pk_bf16_f32 v66, v76, v77
  v_cvt_pk_bf16_f32 v67, v78, v79
  s_lshl_b32 s25, s23, 3
  s_add_u32 s25, s25, s22
  s_lshl_b32 s25, s25, 5
  s_add_u32 s25, s25, s24
  s_lshl_b32 s25, s25, 10
  s_add_u32 s25, s25, 0xe00000
  v_lshlrev_b32 v3, 4, v1
  buffer_store_dwordx4 v[64:67], v3, s[16:19], s25 offen sc1
  s_endpgm
attn2_kernel_fallback:
  s_waitcnt vmcnt(0)
  s_mov_b32 s30, 0
  s_cmp_lg_u32 s23, 0
  s_cbranch_scc1 attn2_kernel_fb_j
  s_sub_u32 s30, 8, s22
attn2_kernel_fb_j:
  v_mov_b32 v124, 0xff61b1e6
  s_mov_b32 s31, s30
attn2_kernel_fb_p1:
  s_lshl_b32 s25, s31, 10
  v_add_u32 v125, s25, v120
  ds_read_b128 v[8:11], v125 offset:0
  s_waitcnt lgkmcnt(0)
  v_mfma_f32_32x32x16_bf16 v[32:47], v[8:11], v[4:7], 0
  s_nop 15
  s_cmp_lg_u32 s31, 0
  s_cbranch_scc1 attn2_kernel_m1a
  v_add_f32 v32, v88, v32
  v_add_f32 v33, v89, v33
  v_add_f32 v34, v90, v34
  v_add_f32 v35, v91, v35
  v_add_f32 v36, v92, v36
  v_add_f32 v37, v93, v37
  v_add_f32 v38, v94, v38
  v_add_f32 v39, v95, v39
  v_add_f32 v40, v96, v40
  v_add_f32 v41, v97, v41
  v_add_f32 v42, v98, v42
  v_add_f32 v43, v99, v43
  v_add_f32 v44, v100, v44
  v_add_f32 v45, v101, v45
  v_add_f32 v46, v102, v46
  v_add_f32 v47, v103, v47
attn2_kernel_m1a:
  s_cmp_lg_u32 s31, 8
  s_cbranch_scc1 attn2_kernel_m1b
  v_add_f32 v32, v104, v32
  v_add_f32 v33, v105, v33
  v_add_f32 v34, v106, v34
  v_add_f32 v35, v107, v35
  v_add_f32 v36, v108, v36
  v_add_f32 v37, v109, v37
  v_add_f32 v38, v110, v38
  v_add_f32 v39, v111, v39
  v_add_f32 v40, v112, v40
  v_add_f32 v41, v113, v41
  v_add_f32 v42, v114, v42
  v_add_f32 v43, v115, v43
  v_add_f32 v44, v116, v44
  v_add_f32 v45, v117, v45
  v_add_f32 v46, v118, v46
  v_add_f32 v47, v119, v47
attn2_kernel_m1b:
  v_max3_f32 v124, v32, v33, v124
  v_max3_f32 v124, v34, v35, v124
  v_max3_f32 v124, v36, v37, v124
  v_max3_f32 v124, v38, v39, v124
  v_max3_f32 v124, v40, v41, v124
  v_max3_f32 v124, v42, v43, v124
  v_max3_f32 v124, v44, v45, v124
  v_max3_f32 v124, v46, v47, v124
  s_add_u32 s31, s31, 1
  s_cmp_le_u32 s31, 8
  s_cbranch_scc1 attn2_kernel_fb_p1
  v_mov_b32 v125, v124
  s_nop 1
  v_permlane32_swap_b32 v124, v125
  s_nop 1
  v_max_f32 v124, v124, v125
  s_mov_b32 s31, s30
  v_mov_b32 v72, 0
  v_mov_b32 v73, 0
  v_mov_b32 v74, 0
  v_mov_b32 v75, 0
  v_mov_b32 v76, 0
  v_mov_b32 v77, 0
  v_mov_b32 v78, 0
  v_mov_b32 v79, 0
  v_mov_b32 v80, 0
  v_mov_b32 v81, 0
  v_mov_b32 v82, 0
  v_mov_b32 v83, 0
  v_mov_b32 v84, 0
  v_mov_b32 v85, 0
  v_mov_b32 v86, 0
  v_mov_b32 v87, 0
  v_mul_u32_u24 v125, 9, v122
  v_sub_u32 v121, v121, v125
  v_sub_u32 v123, v123, v125
attn2_kernel_fb_p2:
  s_lshl_b32 s25, s31, 10
  v_add_u32 v125, s25, v120
  ds_read_b128 v[8:11], v125 offset:0
  v_mul_lo_u32 v126, s31, v122
  v_add_u32 v127, v126, v121
  v_add_u32 v126, v126, v123
  ds_read_b128 v[16:19], v127
  ds_read_b128 v[20:23], v126
  s_waitcnt lgkmcnt(0)
  v_mfma_f32_32x32x16_bf16 v[32:47], v[8:11], v[4:7], 0
  s_nop 15
  s_cmp_lg_u32 s31, 0
  s_cbranch_scc1 attn2_kernel_m2a
  v_add_f32 v32, v88, v32
  v_add_f32 v33, v89, v33
  v_add_f32 v34, v90, v34
  v_add_f32 v35, v91, v35
  v_add_f32 v36, v92, v36
  v_add_f32 v37, v93, v37
  v_add_f32 v38, v94, v38
  v_add_f32 v39, v95, v39
  v_add_f32 v40, v96, v40
  v_add_f32 v41, v97, v41
  v_add_f32 v42, v98, v42
  v_add_f32 v43, v99, v43
  v_add_f32 v44, v100, v44
  v_add_f32 v45, v101, v45
  v_add_f32 v46, v102, v46
  v_add_f32 v47, v103, v47
attn2_kernel_m2a:
  s_cmp_lg_u32 s31, 8
  s_cbranch_scc1 attn2_kernel_m2b
  v_add_f32 v32, v104, v32
  v_add_f32 v33, v105, v33
  v_add_f32 v34, v106, v34
  v_add_f32 v35, v107, v35
  v_add_f32 v36, v108, v36
  v_add_f32 v37, v109, v37
  v_add_f32 v38, v110, v38
  v_add_f32 v39, v111, v39
  v_add_f32 v40, v112, v40
  v_add_f32 v41, v113, v41
  v_add_f32 v42, v114, v42
  v_add_f32 v43, v115, v43
  v_add_f32 v44, v116, v44
  v_add_f32 v45, v117, v45
  v_add_f32 v46, v118, v46
  v_add_f32 v47, v119, v47
attn2_kernel_m2b:
  v_sub_f32 v32, v32, v124
  v_sub_f32 v33, v33, v124
  v_sub_f32 v34, v34, v124
  v_sub_f32 v35, v35, v124
  v_sub_f32 v36, v36, v124
  v_sub_f32 v37, v37, v124
  v_sub_f32 v38, v38, v124
  v_sub_f32 v39, v39, v124
  v_sub_f32 v40, v40, v124
  v_sub_f32 v41, v41, v124
  v_sub_f32 v42, v42, v124
  v_sub_f32 v43, v43, v124
  v_sub_f32 v44, v44, v124
  v_sub_f32 v45, v45, v124
  v_sub_f32 v46, v46, v124
  v_sub_f32 v47, v47, v124
  v_exp_f32 v32, v32
  v_exp_f32 v33, v33
  v_exp_f32 v34, v34
  v_exp_f32 v35, v35
  v_exp_f32 v36, v36
  v_exp_f32 v37, v37
  v_exp_f32 v38, v38
  v_exp_f32 v39, v39
  v_exp_f32 v40, v40
  v_exp_f32 v41, v41
  v_exp_f32 v42, v42
  v_exp_f32 v43, v43
  v_exp_f32 v44, v44
  v_exp_f32 v45, v45
  v_exp_f32 v46, v46
  v_exp_f32 v47, v47
  s_nop 1
  v_cvt_pk_bf16_f32 v64, v32, v33
  v_cvt_pk_bf16_f32 v65, v34, v35
  v_cvt_pk_bf16_f32 v66, v36, v37
  v_cvt_pk_bf16_f32 v67, v38, v39
  v_cvt_pk_bf16_f32 v68, v40, v41
  v_cvt_pk_bf16_f32 v69, v42, v43
  v_cvt_pk_bf16_f32 v70, v44, v45
  v_cvt_pk_bf16_f32 v71, v46, v47
  s_nop 1
  v_mfma_f32_32x32x16_bf16 v[72:87], v[16:19], v[64:67], v[72:87]
  v_mfma_f32_32x32x16_bf16 v[72:87], v[20:23], v[68:71], v[72:87]
  s_nop 15
  s_add_u32 s31, s31, 1
  s_cmp_le_u32 s31, 8
  s_cbranch_scc1 attn2_kernel_fb_p2
  s_nop 7
  s_branch attn2_kernel_finish
  s_branch attn2_kernel_end
attn2_kernel_finisher:
  s_setprio 3
  s_mov_b32 s24, s2
  s_add_u32 s4, s20, 0x161a000
  s_addc_u32 s5, s21, 0
  s_load_dwordx4 s[56:59], s[4:5], 0
  s_mov_b32 s8, s6
  s_and_b32 s9, s7, 0xffff
  s_mov_b32 s10, 0x180000
  s_mov_b32 s11, 0x20000
  v_lshrrev_b32 v2, 2, v1
  s_lshl_b32 s25, s22, 6
  v_add_u32 v2, s25, v2
  v_mul_u32_u24 v2, 3072, v2
  v_and_b32 v3, 3, v1
  v_lshl_add_u32 v2, v3, 4, v2
  s_lshl_b32 s25, s24, 6
  v_add_u32 v2, s25, v2
  s_lshl_b32 s26, s22, 12
  s_add_u32 m0, s26, 0
  s_mov_b32 s25, 0
  buffer_load_dwordx4 v2, s[8:11], s25 offen lds
  s_add_u32 m0, s26, 1024
  s_mov_b32 s25, 49152
  buffer_load_dwordx4 v2, s[8:11], s25 offen lds
  s_add_u32 m0, s26, 2048
  s_mov_b32 s25, 98304
  buffer_load_dwordx4 v2, s[8:11], s25 offen lds
  s_add_u32 m0, s26, 3072
  s_mov_b32 s25, 147456
  buffer_load_dwordx4 v2, s[8:11], s25 offen lds
  v_lshlrev_b32 v8, 2, v0
  s_mov_b32 s25, 0x160c000
  buffer_load_dword v12, v8, s[16:19], s25 offen
  s_add_u32 s25, s25, 2048
  buffer_load_dword v13, v8, s[16:19], s25 offen
  s_add_u32 s25, s25, 2048
  buffer_load_dword v14, v8, s[16:19], s25 offen
  s_add_u32 s25, s25, 2048
  buffer_load_dword v15, v8, s[16:19], s25 offen
  s_add_u32 s25, s25, 2048
  buffer_load_dword v16, v8, s[16:19], s25 offen
  s_add_u32 s25, s25, 2048
  buffer_load_dword v17, v8, s[16:19], s25 offen
  s_add_u32 s25, s25, 2048
  buffer_load_dword v18, v8, s[16:19], s25 offen
  s_add_u32 s25, s25, 2048
  buffer_load_dword v19, v8, s[16:19], s25 offen
  v_and_b32 v21, 31, v1
  v_and_b32 v22, 0x13, v21
  v_bfe_u32 v23, v21, 3, 1
  v_lshl_add_u32 v22, v23, 2, v22
  v_bfe_u32 v23, v21, 2, 1
  v_lshl_add_u32 v22, v23, 3, v22
  v_lshlrev_b32 v22, 2, v22
  s_lshl_b32 s25, s24, 7
  s_add_u32 s25, s25, 0x1618000
  buffer_load_dword v24, v22, s[16:19], s25 offen
  s_mov_b32 s25, 0x161c000
  buffer_load_dword v10, v8, s[16:19], s25 offen
  v_lshrrev_b32 v2, 4, v1
  v_bfe_u32 v3, v1, 2, 2
  v_lshl_add_u32 v3, v2, 3, v3
  v_lshlrev_b32 v3, 6, v3
  v_and_b32 v9, 3, v1
  v_lshl_add_u32 v3, v9, 3, v3
  s_lshl_b32 s25, s22, 12
  v_add_u32 v3, s25, v3
  s_waitcnt vmcnt(0) lgkmcnt(0)
  ds_read_b64_tr_b16 v[28:29], v3 offset:0
  ds_read_b64_tr_b16 v[30:31], v3 offset:256
  ds_read_b64_tr_b16 v[32:33], v3 offset:2048
  ds_read_b64_tr_b16 v[34:35], v3 offset:2304
  ds_read_b64_tr_b16 v[36:37], v3 offset:32
  ds_read_b64_tr_b16 v[38:39], v3 offset:288
  ds_read_b64_tr_b16 v[40:41], v3 offset:2080
  ds_read_b64_tr_b16 v[42:43], v3 offset:2336
  v_add_f32 v12, v12, v13
  v_add_f32 v14, v14, v15
  v_add_f32 v16, v16, v17
  v_add_f32 v18, v18, v19
  v_add_f32 v12, v12, v14
  v_add_f32 v16, v16, v18
  v_add_f32 v12, v12, v16
  v_fma_f32 v13, v12, s57, v10
  s_cmp_lg_u32 s24, 0
  s_cbranch_scc1 attn2_kernel_nox2s
  s_mov_b32 s25, 0x161b000
  buffer_store_dword v13, v8, s[16:19], s25 offen sc1
attn2_kernel_nox2s:
  v_cvt_pk_bf16_f32 v14, v13, v13
  s_lshl_b32 s25, s22, 7
  v_lshl_add_u32 v15, v1, 1, s25
  ds_write_b16 v15, v14 offset:32768
  v_lshl_add_u32 v8, v2, 4, s25
  v_lshlrev_b32 v16, 16, v14
  v_mul_f32 v17, v16, v16
  s_waitcnt lgkmcnt(0)
  ds_read_b128 v[44:47], v8 offset:32768
  ds_read_b128 v[48:51], v8 offset:32832
  v_add_f32_dpp v16, v16, v16 quad_perm:[1,0,3,2] row_mask:0xf bank_mask:0xf
  v_add_f32_dpp v17, v17, v17 quad_perm:[1,0,3,2] row_mask:0xf bank_mask:0xf
  s_nop 0
  v_add_f32_dpp v16, v16, v16 quad_perm:[2,3,0,1] row_mask:0xf bank_mask:0xf
  v_add_f32_dpp v17, v17, v17 quad_perm:[2,3,0,1] row_mask:0xf bank_mask:0xf
  s_nop 0
  v_add_f32_dpp v16, v16, v16 row_half_mirror row_mask:0xf bank_mask:0xf
  v_add_f32_dpp v17, v17, v17 row_half_mirror row_mask:0xf bank_mask:0xf
  s_nop 0
  v_add_f32_dpp v16, v16, v16 row_mirror row_mask:0xf bank_mask:0xf
  v_add_f32_dpp v17, v17, v17 row_mirror row_mask:0xf bank_mask:0xf
  v_mov_b32 v18, v16
  v_mov_b32 v19, v17
  s_nop 0
  v_permlane16_swap_b32 v16, v18
  v_permlane16_swap_b32 v17, v19
  v_add_f32 v16, v16, v18
  v_add_f32 v17, v17, v19
  v_mov_b32 v18, v16
  v_mov_b32 v19, v17
  s_nop 0
  v_permlane32_swap_b32 v16, v18
  v_permlane32_swap_b32 v17, v19
  v_add_f32 v16, v16, v18
  v_add_f32 v17, v17, v19
  s_lshl_b32 s26, s22, 3
  v_mov_b32 v18, s26
  ds_write_b64 v18, v[16:17] offset:33792
  s_waitcnt lgkmcnt(0)
  v_mfma_f32_16x16x32_bf16 v[52:55], v[28:31], v[44:47], 0
  v_mfma_f32_16x16x32_bf16 v[56:59], v[36:39], v[44:47], 0
  v_mfma_f32_16x16x32_bf16 v[52:55], v[32:35], v[48:51], v[52:55]
  v_mfma_f32_16x16x32_bf16 v[56:59], v[40:43], v[48:51], v[56:59]
  v_and_b32 v9, 15, v1
  v_cmp_eq_u32 vcc, 0, v9
  s_lshl_b32 s25, s22, 7
  v_lshl_add_u32 v9, v2, 4, s25
  s_and_saveexec_b64 s[26:27], vcc
  s_nop 1
  ds_write_b128 v9, v[52:55] offset:33856
  ds_write_b128 v9, v[56:59] offset:33920
  s_mov_b64 exec, s[26:27]
  s_waitcnt lgkmcnt(0)
  s_barrier
  s_cmp_lg_u32 s22, 0
  s_cbranch_scc1 attn2_kernel_end
  v_lshlrev_b32 v9, 2, v21
  v_mov_b32 v2, 0
  ds_read_b32 v12, v9 offset:33856
  ds_read_b32 v13, v9 offset:33984
  ds_read_b32 v14, v9 offset:34112
  ds_read_b32 v15, v9 offset:34240
  ds_read_b32 v16, v9 offset:34368
  ds_read_b32 v17, v9 offset:34496
  ds_read_b32 v18, v9 offset:34624
  ds_read_b32 v19, v9 offset:34752
  ds_read_b128 v[28:31], v2 offset:33792
  ds_read_b128 v[32:35], v2 offset:33808
  ds_read_b128 v[36:39], v2 offset:33824
  ds_read_b128 v[40:43], v2 offset:33840
  s_waitcnt lgkmcnt(0)
  v_add_f32 v12, v12, v13
  v_add_f32 v14, v14, v15
  v_add_f32 v16, v16, v17
  v_add_f32 v18, v18, v19
  v_add_f32 v28, v28, v30
  v_add_f32 v29, v29, v31
  v_add_f32 v32, v32, v34
  v_add_f32 v33, v33, v35
  v_add_f32 v36, v36, v38
  v_add_f32 v37, v37, v39
  v_add_f32 v40, v40, v42
  v_add_f32 v41, v41, v43
  v_add_f32 v12, v12, v14
  v_add_f32 v16, v16, v18
  v_add_f32 v28, v28, v32
  v_add_f32 v29, v29, v33
  v_add_f32 v36, v36, v40
  v_add_f32 v37, v37, v41
  v_add_f32 v12, v12, v16
  v_add_f32 v28, v28, v36
  v_add_f32 v29, v29, v37
  v_mul_f32 v28, 0x3b000000, v28
  v_mul_f32 v29, 0x3b000000, v29
  v_fma_f32 v29, -v28, v28, v29
  v_add_f32 v29, 0x3727c5ac, v29
  v_rsq_f32 v29, v29
  v_fma_f32 v12, -v28, v24, v12
  s_cmp_lt_u32 s24, 16
  s_cselect_b32 s25, 0x3eb8aa3b, 1.0
  v_mul_f32 v29, s25, v29
  v_mul_f32 v12, v12, v29
  v_cvt_pk_bf16_f32 v12, v12, v12
  v_and_b32 v12, 0xffff, v12
  v_or_b32 v12, 0x5a5a0000, v12
  s_lshl_b32 s25, s24, 7
  s_add_u32 s25, s25, 0x1614000
  s_mov_b32 exec_hi, 0
  buffer_store_dword v12, v9, s[16:19], s25 offen sc1
  s_endpgm
attn2_kernel_end:
  s_endpgm
attn2_kernel_codeend:
.globl wo2_kernel
.p2align 8
.type wo2_kernel,@function
wo2_kernel:
  s_cmp_ge_u32 s2, 256
  s_cbranch_scc1 wo2_kernel_end
  s_load_dwordx2 s[4:5], s[0:1], 16
  s_load_dwordx2 s[6:7], s[0:1], 32
  s_load_dwordx2 s[20:21], s[0:1], 80
  v_lshrrev_b32 v2, 6, v0
  v_and_b32 v1, 63, v0
  v_readfirstlane_b32 s22, v2
  s_and_b32 s25, s2, 7
  s_lshr_b32 s26, s2, 3
  s_and_b32 s23, s26, 3
  s_lshl2_add_u32 s23, s25, s23
  s_lshr_b32 s24, s26, 2
  s_and_b32 s27, s22, 1
  s_lshr_b32 s28, s22, 1
  v_lshlrev_b32 v82, 4, v1
  v_lshrrev_b32 v3, 3, v1
  s_lshl_b32 s25, s22, 4
  v_add_u32 v3, s25, v3
  v_lshlrev_b32 v3, 10, v3
  v_bfe_u32 v4, v1, 2, 1
  v_bfe_u32 v5, v1, 4, 1
  v_xor_b32 v4, v4, v5
  v_lshl_add_u32 v3, v4, 6, v3
  v_and_b32 v4, 3, v1
  v_lshl_add_u32 v3, v4, 4, v3
  s_lshl_b32 s25, s24, 7
  v_add_u32 v83, s25, v3
  s_lshl_b32 s25, s27, 15
  v_lshl_add_u32 v80, v1, 4, s25
  v_lshrrev_b32 v6, 5, v1
  v_bfe_u32 v7, v1, 2, 2
  v_lshl_add_u32 v8, v6, 3, v7
  v_lshlrev_b32 v8, 7, v8
  v_bfe_u32 v9, v1, 3, 1
  v_xor_b32 v9, s28, v9
  v_lshl_add_u32 v8, v9, 6, v8
  v_bfe_u32 v9, v1, 4, 1
  v_lshl_add_u32 v8, v9, 5, v8
  v_and_b32 v9, 1, v1
  v_lshl_add_u32 v8, v9, 4, v8
  v_bfe_u32 v9, v1, 1, 1
  v_lshl_add_u32 v8, v9, 3, v8
  v_add_u32 v81, 0x10000, v8
  s_lshl_b32 s25, s23, 1
  s_add_u32 s25, s25, s27
  s_lshl_b32 s34, s25, 5
  s_lshl_b32 s26, s28, 1
  s_add_u32 s29, s34, s26
  s_lshl_b32 s29, s29, 10
  s_add_u32 s29, s29, 0xe00000
  s_lshl_b32 s30, s27, 15
  s_lshl_b32 s26, s28, 11
  s_add_u32 s30, s30, s26
  s_lshl_b32 s31, s22, 11
  s_add_u32 s31, s31, 0x10000
  s_waitcnt lgkmcnt(0)
  s_mov_b32 s8, s4
  s_and_b32 s9, s5, 0xffff
  s_mov_b32 s10, 0x80000
  s_mov_b32 s11, 0x20000
  s_mov_b32 s12, s6
  s_and_b32 s13, s7, 0xffff
  s_mov_b32 s14, 0x400
  s_mov_b32 s15, 0x20000
  s_mov_b32 s16, s20
  s_and_b32 s17, s21, 0xffff
  s_mov_b32 s18, 0x10000000
  s_mov_b32 s19, 0x20000
  s_add_u32 m0, s30, 0
  s_add_u32 s32, s29, 0
  buffer_load_dwordx4 v82, s[16:19], s32 offen lds
  buffer_load_dwordx4 v82, s[16:19], s32 offen offset:1024 lds
  s_add_u32 m0, s31, 0
  s_mov_b32 s33, 0
  buffer_load_dwordx4 v83, s[8:11], s33 offen lds
  s_mov_b32 s33, 7168
  buffer_load_dwordx4 v83, s[8:11], s33 offen offset:1024 lds
  s_add_u32 m0, s30, 4096
  s_add_u32 s32, s29, 4096
  buffer_load_dwordx4 v82, s[16:19], s32 offen lds
  buffer_load_dwordx4 v82, s[16:19], s32 offen offset:1024 lds
  s_add_u32 m0, s31, 8192
  s_mov_b32 s33, 65536
  buffer_load_dwordx4 v83, s[8:11], s33 offen lds
  s_mov_b32 s33, 72704
  buffer_load_dwordx4 v83, s[8:11], s33 offen offset:1024 lds
  s_add_u32 m0, s30, 8192
  s_add_u32 s32, s29, 8192
  buffer_load_dwordx4 v82, s[16:19], s32 offen lds
  buffer_load_dwordx4 v82, s[16:19], s32 offen offset:1024 lds
  s_add_u32 m0, s31, 16384
  s_mov_b32 s33, 131072
  buffer_load_dwordx4 v83, s[8:11], s33 offen lds
  s_mov_b32 s33, 138240
  buffer_load_dwordx4 v83, s[8:11], s33 offen offset:1024 lds
  s_lshl_b32 s26, s24, 2
  s_add_u32 s34, s34, s26
  s_lshl_b32 s26, s28, 1
  s_add_u32 s34, s34, s26
  s_lshl_b32 s34, s34, 10
  s_add_u32 s35, s34, 0x1200000
  s_lshl_b32 s36, s24, 7
  s_lshl_b32 s26, s28, 6
  s_add_u32 s36, s36, s26
  v_lshlrev_b32 v10, 4, v6
  buffer_load_dwordx4 v[64:67], v82, s[16:19], s35 offen
  buffer_load_dwordx4 v[68:71], v82, s[16:19], s35 offen offset:1024
  buffer_load_dwordx4 v[72:75], v10, s[12:15], s36 offen
  buffer_load_dwordx4 v[76:79], v10, s[12:15], s36 offen offset:32
  v_and_b32 v11, 31, v1
  s_lshl_b32 s26, s25, 5
  v_add_u32 v11, s26, v11
  v_lshlrev_b32 v12, 2, v11
  s_mov_b32 s37, 0x1600000
  s_add_u32 s38, s37, 8192
  buffer_load_dword v84, v12, s[16:19], s37 offen
  buffer_load_dword v85, v12, s[16:19], s38 offen
  s_add_u32 s4, s20, 0x161a000
  s_addc_u32 s5, s21, 0
  s_load_dword s39, s[4:5], 0
  s_waitcnt vmcnt(14)
  s_barrier
  ds_read_b128 v[32:35], v80 offset:0
  ds_read_b64_tr_b16 v[48:49], v81 offset:0
  ds_read_b64_tr_b16 v[50:51], v81 offset:512
  ds_read_b128 v[36:39], v80 offset:1024
  ds_read_b64_tr_b16 v[52:53], v81 offset:2048
  ds_read_b64_tr_b16 v[54:55], v81 offset:2560
  ds_read_b128 v[40:43], v80 offset:2048
  ds_read_b64_tr_b16 v[56:57], v81 offset:4096
  ds_read_b64_tr_b16 v[58:59], v81 offset:4608
  ds_read_b128 v[44:47], v80 offset:3072
  ds_read_b64_tr_b16 v[60:61], v81 offset:6144
  ds_read_b64_tr_b16 v[62:63], v81 offset:6656
  s_add_u32 m0, s30, 12288
  s_add_u32 s32, s29, 12288
  buffer_load_dwordx4 v82, s[16:19], s32 offen lds
  s_waitcnt lgkmcnt(9)
  v_mfma_f32_32x32x16_bf16 v[16:31], v[48:51], v[32:35], 0
  buffer_load_dwordx4 v82, s[16:19], s32 offen offset:1024 lds
  s_waitcnt lgkmcnt(6)
  v_mfma_f32_32x32x16_bf16 v[16:31], v[52:55], v[36:39], v[16:31]
  s_add_u32 m0, s31, 24576
  s_mov_b32 s33, 196608
  buffer_load_dwordx4 v83, s[8:11], s33 offen lds
  s_waitcnt lgkmcnt(3)
  v_mfma_f32_32x32x16_bf16 v[16:31], v[56:59], v[40:43], v[16:31]
  s_mov_b32 s33, 203776
  buffer_load_dwordx4 v83, s[8:11], s33 offen offset:1024 lds
  s_waitcnt lgkmcnt(0)
  v_mfma_f32_32x32x16_bf16 v[16:31], v[60:63], v[44:47], v[16:31]
  s_waitcnt vmcnt(14)
  s_barrier
  ds_read_b128 v[32:35], v80 offset:4096
  ds_read_b64_tr_b16 v[48:49], v81 offset:8192
  ds_read_b64_tr_b16 v[50:51], v81 offset:8704
  ds_read_b128 v[36:39], v80 offset:5120
  ds_read_b64_tr_b16 v[52:53], v81 offset:10240
  ds_read_b64_tr_b16 v[54:55], v81 offset:10752
  ds_read_b128 v[40:43], v80 offset:6144
  ds_read_b64_tr_b16 v[56:57], v81 offset:12288
  ds_read_b64_tr_b16 v[58:59], v81 offset:12800
  ds_read_b128 v[44:47], v80 offset:7168
  ds_read_b64_tr_b16 v[60:61], v81 offset:14336
  ds_read_b64_tr_b16 v[62:63], v81 offset:14848
  s_add_u32 m0, s30, 16384
  s_add_u32 s32, s29, 16384
  buffer_load_dwordx4 v82, s[16:19], s32 offen lds
  s_waitcnt lgkmcnt(9)
  v_mfma_f32_32x32x16_bf16 v[16:31], v[48:51], v[32:35], v[16:31]
  buffer_load_dwordx4 v82, s[16:19], s32 offen offset:1024 lds
  s_waitcnt lgkmcnt(6)
  v_mfma_f32_32x32x16_bf16 v[16:31], v[52:55], v[36:39], v[16:31]
  s_add_u32 m0, s31, 32768
  s_mov_b32 s33, 262144
  buffer_load_dwordx4 v83, s[8:11], s33 offen lds
  s_waitcnt lgkmcnt(3)
  v_mfma_f32_32x32x16_bf16 v[16:31], v[56:59], v[40:43], v[16:31]
  s_mov_b32 s33, 269312
  buffer_load_dwordx4 v83, s[8:11], s33 offen offset:1024 lds
  s_waitcnt lgkmcnt(0)
  v_mfma_f32_32x32x16_bf16 v[16:31], v[60:63], v[44:47], v[16:31]
  s_waitcnt vmcnt(14)
  s_barrier
  ds_read_b128 v[32:35], v80 offset:8192
  ds_read_b64_tr_b16 v[48:49], v81 offset:16384
  ds_read_b64_tr_b16 v[50:51], v81 offset:16896
  ds_read_b128 v[36:39], v80 offset:9216
  ds_read_b64_tr_b16 v[52:53], v81 offset:18432
  ds_read_b64_tr_b16 v[54:55], v81 offset:18944
  ds_read_b128 v[40:43], v80 offset:10240
  ds_read_b64_tr_b16 v[56:57], v81 offset:20480
  ds_read_b64_tr_b16 v[58:59], v81 offset:20992
  ds_read_b128 v[44:47], v80 offset:11264
  ds_read_b64_tr_b16 v[60:61], v81 offset:22528
  ds_read_b64_tr_b16 v[62:63], v81 offset:23040
  s_add_u32 m0, s30, 20480
  s_add_u32 s32, s29, 20480
  buffer_load_dwordx4 v82, s[16:19], s32 offen lds
  s_waitcnt lgkmcnt(9)
  v_mfma_f32_32x32x16_bf16 v[16:31], v[48:51], v[32:35], v[16:31]
  buffer_load_dwordx4 v82, s[16:19], s32 offen offset:1024 lds
  s_waitcnt lgkmcnt(6)
  v_mfma_f32_32x32x16_bf16 v[16:31], v[52:55], v[36:39], v[16:31]
  s_add_u32 m0, s31, 40960
  s_mov_b32 s33, 327680
  buffer_load_dwordx4 v83, s[8:11], s33 offen lds
  s_waitcnt lgkmcnt(3)
  v_mfma_f32_32x32x16_bf16 v[16:31], v[56:59], v[40:43], v[16:31]
  s_mov_b32 s33, 334848
  buffer_load_dwordx4 v83, s[8:11], s33 offen offset:1024 lds
  s_waitcnt lgkmcnt(0)
  v_mfma_f32_32x32x16_bf16 v[16:31], v[60:63], v[44:47], v[16:31]
  s_waitcnt vmcnt(8)
  s_barrier
  ds_read_b128 v[32:35], v80 offset:12288
  ds_read_b64_tr_b16 v[48:49], v81 offset:24576
  ds_read_b64_tr_b16 v[50:51], v81 offset:25088
  ds_read_b128 v[36:39], v80 offset:13312
  ds_read_b64_tr_b16 v[52:53], v81 offset:26624
  ds_read_b64_tr_b16 v[54:55], v81 offset:27136
  ds_read_b128 v[40:43], v80 offset:14336
  ds_read_b64_tr_b16 v[56:57], v81 offset:28672
  ds_read_b64_tr_b16 v[58:59], v81 offset:29184
  ds_read_b128 v[44:47], v80 offset:15360
  ds_read_b64_tr_b16 v[60:61], v81 offset:30720
  ds_read_b64_tr_b16 v[62:63], v81 offset:31232
  s_add_u32 m0, s30, 24576
  s_add_u32 s32, s29, 24576
  buffer_load_dwordx4 v82, s[16:19], s32 offen lds
  s_waitcnt lgkmcnt(9)
  v_mfma_f32_32x32x16_bf16 v[16:31], v[48:51], v[32:35], v[16:31]
  buffer_load_dwordx4 v82, s[16:19], s32 offen offset:1024 lds
  s_waitcnt lgkmcnt(6)
  v_mfma_f32_32x32x16_bf16 v[16:31], v[52:55], v[36:39], v[16:31]
  s_add_u32 m0, s31, 49152
  s_mov_b32 s33, 393216
  buffer_load_dwordx4 v83, s[8:11], s33 offen lds
  s_waitcnt lgkmcnt(3)
  v_mfma_f32_32x32x16_bf16 v[16:31], v[56:59], v[40:43], v[16:31]
  s_mov_b32 s33, 400384
  buffer_load_dwordx4 v83, s[8:11], s33 offen offset:1024 lds
  s_waitcnt lgkmcnt(0)
  v_mfma_f32_32x32x16_bf16 v[16:31], v[60:63], v[44:47], v[16:31]
  s_waitcnt vmcnt(8)
  s_barrier
  ds_read_b128 v[32:35], v80 offset:16384
  ds_read_b64_tr_b16 v[48:49], v81 offset:32768
  ds_read_b64_tr_b16 v[50:51], v81 offset:33280
  ds_read_b128 v[36:39], v80 offset:17408
  ds_read_b64_tr_b16 v[52:53], v81 offset:34816
  ds_read_b64_tr_b16 v[54:55], v81 offset:35328
  ds_read_b128 v[40:43], v80 offset:18432
  ds_read_b64_tr_b16 v[56:57], v81 offset:36864
  ds_read_b64_tr_b16 v[58:59], v81 offset:37376
  ds_read_b128 v[44:47], v80 offset:19456
  ds_read_b64_tr_b16 v[60:61], v81 offset:38912
  ds_read_b64_tr_b16 v[62:63], v81 offset:39424
  s_add_u32 m0, s30, 28672
  s_add_u32 s32, s29, 28672
  buffer_load_dwordx4 v82, s[16:19], s32 offen lds
  s_waitcnt lgkmcnt(9)
  v_mfma_f32_32x32x16_bf16 v[16:31], v[48:51], v[32:35], v[16:31]
  buffer_load_dwordx4 v82, s[16:19], s32 offen offset:1024 lds
  s_waitcnt lgkmcnt(6)
  v_mfma_f32_32x32x16_bf16 v[16:31], v[52:55], v[36:39], v[16:31]
  s_add_u32 m0, s31, 57344
  s_mov_b32 s33, 458752
  buffer_load_dwordx4 v83, s[8:11], s33 offen lds
  s_waitcnt lgkmcnt(3)
  v_mfma_f32_32x32x16_bf16 v[16:31], v[56:59], v[40:43], v[16:31]
  s_mov_b32 s33, 465920
  buffer_load_dwordx4 v83, s[8:11], s33 offen offset:1024 lds
  s_waitcnt lgkmcnt(0)
  v_mfma_f32_32x32x16_bf16 v[16:31], v[60:63], v[44:47], v[16:31]
  s_waitcnt vmcnt(8)
  s_barrier
  ds_read_b128 v[32:35], v80 offset:20480
  ds_read_b64_tr_b16 v[48:49], v81 offset:40960
  ds_read_b64_tr_b16 v[50:51], v81 offset:41472
  ds_read_b128 v[36:39], v80 offset:21504
  ds_read_b64_tr_b16 v[52:53], v81 offset:43008
  ds_read_b64_tr_b16 v[54:55], v81 offset:43520
  ds_read_b128 v[40:43], v80 offset:22528
  ds_read_b64_tr_b16 v[56:57], v81 offset:45056
  ds_read_b64_tr_b16 v[58:59], v81 offset:45568
  ds_read_b128 v[44:47], v80 offset:23552
  ds_read_b64_tr_b16 v[60:61], v81 offset:47104
  ds_read_b64_tr_b16 v[62:63], v81 offset:47616
  s_waitcnt lgkmcnt(9)
  v_mfma_f32_32x32x16_bf16 v[16:31], v[48:51], v[32:35], v[16:31]
  s_waitcnt lgkmcnt(6)
  v_mfma_f32_32x32x16_bf16 v[16:31], v[52:55], v[36:39], v[16:31]
  s_waitcnt lgkmcnt(3)
  v_mfma_f32_32x32x16_bf16 v[16:31], v[56:59], v[40:43], v[16:31]
  s_waitcnt lgkmcnt(0)
  v_mfma_f32_32x32x16_bf16 v[16:31], v[60:63], v[44:47], v[16:31]
  s_waitcnt vmcnt(4)
  s_barrier
  ds_read_b128 v[32:35], v80 offset:24576
  ds_read_b64_tr_b16 v[48:49], v81 offset:49152
  ds_read_b64_tr_b16 v[50:51], v81 offset:49664
  ds_read_b128 v[36:39], v80 offset:25600
  ds_read_b64_tr_b16 v[52:53], v81 offset:51200
  ds_read_b64_tr_b16 v[54:55], v81 offset:51712
  ds_read_b128 v[40:43], v80 offset:26624
  ds_read_b64_tr_b16 v[56:57], v81 offset:53248
  ds_read_b64_tr_b16 v[58:59], v81 offset:53760
  ds_read_b128 v[44:47], v80 offset:27648
  ds_read_b64_tr_b16 v[60:61], v81 offset:55296
  ds_read_b64_tr_b16 v[62:63], v81 offset:55808
  s_waitcnt lgkmcnt(9)
  v_mfma_f32_32x32x16_bf16 v[16:31], v[48:51], v[32:35], v[16:31]
  s_waitcnt lgkmcnt(6)
  v_mfma_f32_32x32x16_bf16 v[16:31], v[52:55], v[36:39], v[16:31]
  s_waitcnt lgkmcnt(3)
  v_mfma_f32_32x32x16_bf16 v[16:31], v[56:59], v[40:43], v[16:31]
  s_waitcnt lgkmcnt(0)
  v_mfma_f32_32x32x16_bf16 v[16:31], v[60:63], v[44:47], v[16:31]
  s_waitcnt vmcnt(0)
  s_barrier
  ds_read_b128 v[32:35], v80 offset:28672
  ds_read_b64_tr_b16 v[48:49], v81 offset:57344
  ds_read_b64_tr_b16 v[50:51], v81 offset:57856
  ds_read_b128 v[36:39], v80 offset:29696
  ds_read_b64_tr_b16 v[52:53], v81 offset:59392
  ds_read_b64_tr_b16 v[54:55], v81 offset:59904
  ds_read_b128 v[40:43], v80 offset:30720
  ds_read_b64_tr_b16 v[56:57], v81 offset:61440
  ds_read_b64_tr_b16 v[58:59], v81 offset:61952
  ds_read_b128 v[44:47], v80 offset:31744
  ds_read_b64_tr_b16 v[60:61], v81 offset:63488
  ds_read_b64_tr_b16 v[62:63], v81 offset:64000
  s_waitcnt lgkmcnt(9)
  v_mfma_f32_32x32x16_bf16 v[16:31], v[48:51], v[32:35], v[16:31]
  s_waitcnt lgkmcnt(6)
  v_mfma_f32_32x32x16_bf16 v[16:31], v[52:55], v[36:39], v[16:31]
  s_waitcnt lgkmcnt(3)
  v_mfma_f32_32x32x16_bf16 v[16:31], v[56:59], v[40:43], v[16:31]
  s_waitcnt lgkmcnt(0)
  v_mfma_f32_32x32x16_bf16 v[16:31], v[60:63], v[44:47], v[16:31]
  s_cmp_lg_u32 s22, 3
  s_cbranch_scc1 wo2_kernel_noct
  s_lshr_b32 s47, s2, 3
  s_getpc_b64 s[48:49]
wo2_kernel_pc0:
  s_add_u32 s48, s48, (wo2_kernel_codeend-wo2_kernel_pc0)
  s_addc_u32 s49, s49, 0
  s_and_b32 s49, s49, 0xffff
  s_mov_b32 s50, (all_code_end-wo2_kernel_codeend)
  s_mov_b32 s51, 0x20000
  s_mul_i32 s47, s47, 1536
  v_lshlrev_b32 v14, 7, v1
  s_mov_b32 exec_lo, 0xfff
  s_mov_b32 exec_hi, 0
  buffer_load_dword v15, v14, s[48:51], s47 offen
  s_mov_b64 exec, -1
wo2_kernel_noct:
  v_lshlrev_b32 v32, 16, v64
  v_and_b32 v33, 0xffff0000, v64
  v_lshlrev_b32 v48, 16, v72
  v_and_b32 v49, 0xffff0000, v72
  v_lshlrev_b32 v34, 16, v65
  v_and_b32 v35, 0xffff0000, v65
  v_lshlrev_b32 v50, 16, v73
  v_and_b32 v51, 0xffff0000, v73
  v_lshlrev_b32 v36, 16, v66
  v_and_b32 v37, 0xffff0000, v66
  v_lshlrev_b32 v52, 16, v74
  v_and_b32 v53, 0xffff0000, v74
  v_lshlrev_b32 v38, 16, v67
  v_and_b32 v39, 0xffff0000, v67
  v_lshlrev_b32 v54, 16, v75
  v_and_b32 v55, 0xffff0000, v75
  v_lshlrev_b32 v40, 16, v68
  v_and_b32 v41, 0xffff0000, v68
  v_lshlrev_b32 v56, 16, v76
  v_and_b32 v57, 0xffff0000, v76
  v_lshlrev_b32 v42, 16, v69
  v_and_b32 v43, 0xffff0000, v69
  v_lshlrev_b32 v58, 16, v77
  v_and_b32 v59, 0xffff0000, v77
  v_lshlrev_b32 v44, 16, v70
  v_and_b32 v45, 0xffff0000, v70
  v_lshlrev_b32 v60, 16, v78
  v_and_b32 v61, 0xffff0000, v78
  v_lshlrev_b32 v46, 16, v71
  v_and_b32 v47, 0xffff0000, v71
  v_lshlrev_b32 v62, 16, v79
  v_and_b32 v63, 0xffff0000, v79
  v_mul_f32 v84, 0x3b000000, v84
  v_mul_f32 v85, 0x3b000000, v85
  v_fma_f32 v85, -v84, v84, v85
  v_add_f32 v85, 0x3727c5ac, v85
  v_rsq_f32 v85, v85
  s_nop 0
  v_mul_f32 v84, v84, v85
  v_add_f32 v85, 1.0, v85
  v_fma_f32 v32, v32, v85, -v84
  v_fma_f32 v33, v33, v85, -v84
  v_fma_f32 v34, v34, v85, -v84
  v_fma_f32 v35, v35, v85, -v84
  v_fma_f32 v36, v36, v85, -v84
  v_fma_f32 v37, v37, v85, -v84
  v_fma_f32 v38, v38, v85, -v84
  v_fma_f32 v39, v39, v85, -v84
  v_fma_f32 v40, v40, v85, -v84
  v_fma_f32 v41, v41, v85, -v84
  v_fma_f32 v42, v42, v85, -v84
  v_fma_f32 v43, v43, v85, -v84
  v_fma_f32 v44, v44, v85, -v84
  v_fma_f32 v45, v45, v85, -v84
  v_fma_f32 v46, v46, v85, -v84
  v_fma_f32 v47, v47, v85, -v84
  s_waitcnt lgkmcnt(0)
  s_lshr_b32 s26, s39, 5
  s_cmp_lg_u32 s26, s25
  s_cbranch_scc1 wo2_kernel_nosel
  s_lshl_b32 s26, s36, 1
  s_add_u32 s26, s26, 0x161b000
  v_lshlrev_b32 v13, 5, v6
  buffer_load_dwordx4 v[64:67], v13, s[16:19], s26 offen
  buffer_load_dwordx4 v[68:71], v13, s[16:19], s26 offen offset:16
  buffer_load_dwordx4 v[72:75], v13, s[16:19], s26 offen offset:64
  buffer_load_dwordx4 v[76:79], v13, s[16:19], s26 offen offset:80
  v_cmp_eq_u32 s[26:27], s39, v11
  s_waitcnt vmcnt(0)
  s_nop 0
  v_cndmask_b32 v32, v32, v64, s[26:27]
  v_cndmask_b32 v33, v33, v65, s[26:27]
  v_cndmask_b32 v34, v34, v66, s[26:27]
  v_cndmask_b32 v35, v35, v67, s[26:27]
  v_cndmask_b32 v36, v36, v68, s[26:27]
  v_cndmask_b32 v37, v37, v69, s[26:27]
  v_cndmask_b32 v38, v38, v70, s[26:27]
  v_cndmask_b32 v39, v39, v71, s[26:27]
  v_cndmask_b32 v40, v40, v72, s[26:27]
  v_cndmask_b32 v41, v41, v73, s[26:27]
  v_cndmask_b32 v42, v42, v74, s[26:27]
  v_cndmask_b32 v43, v43, v75, s[26:27]
  v_cndmask_b32 v44, v44, v76, s[26:27]
  v_cndmask_b32 v45, v45, v77, s[26:27]
  v_cndmask_b32 v46, v46, v78, s[26:27]
  v_cndmask_b32 v47, v47, v79, s[26:27]
wo2_kernel_nosel:
  v_add_f32 v16, v16, v32
  v_add_f32 v17, v17, v33
  v_add_f32 v18, v18, v34
  v_add_f32 v19, v19, v35
  v_add_f32 v20, v20, v36
  v_add_f32 v21, v21, v37
  v_add_f32 v22, v22, v38
  v_add_f32 v23, v23, v39
  v_add_f32 v24, v24, v40
  v_add_f32 v25, v25, v41
  v_add_f32 v26, v26, v42
  v_add_f32 v27, v27, v43
  v_add_f32 v28, v28, v44
  v_add_f32 v29, v29, v45
  v_add_f32 v30, v30, v46
  v_add_f32 v31, v31, v47
  v_mov_b32 v4, v16
  v_mul_f32 v5, v16, v16
  v_mul_f32 v7, v16, v48
  v_add_f32 v4, v4, v17
  v_fmac_f32 v5, v17, v17
  v_fmac_f32 v7, v17, v49
  v_add_f32 v4, v4, v18
  v_fmac_f32 v5, v18, v18
  v_fmac_f32 v7, v18, v50
  v_add_f32 v4, v4, v19
  v_fmac_f32 v5, v19, v19
  v_fmac_f32 v7, v19, v51
  v_add_f32 v4, v4, v20
  v_fmac_f32 v5, v20, v20
  v_fmac_f32 v7, v20, v52
  v_add_f32 v4, v4, v21
  v_fmac_f32 v5, v21, v21
  v_fmac_f32 v7, v21, v53
  v_add_f32 v4, v4, v22
  v_fmac_f32 v5, v22, v22
  v_fmac_f32 v7, v22, v54
  v_add_f32 v4, v4, v23
  v_fmac_f32 v5, v23, v23
  v_fmac_f32 v7, v23, v55
  v_add_f32 v4, v4, v24
  v_fmac_f32 v5, v24, v24
  v_fmac_f32 v7, v24, v56
  v_add_f32 v4, v4, v25
  v_fmac_f32 v5, v25, v25
  v_fmac_f32 v7, v25, v57
  v_add_f32 v4, v4, v26
  v_fmac_f32 v5, v26, v26
  v_fmac_f32 v7, v26, v58
  v_add_f32 v4, v4, v27
  v_fmac_f32 v5, v27, v27
  v_fmac_f32 v7, v27, v59
  v_add_f32 v4, v4, v28
  v_fmac_f32 v5, v28, v28
  v_fmac_f32 v7, v28, v60
  v_add_f32 v4, v4, v29
  v_fmac_f32 v5, v29, v29
  v_fmac_f32 v7, v29, v61
  v_add_f32 v4, v4, v30
  v_fmac_f32 v5, v30, v30
  v_fmac_f32 v7, v30, v62
  v_add_f32 v4, v4, v31
  v_fmac_f32 v5, v31, v31
  v_fmac_f32 v7, v31, v63
  v_cvt_pk_bf16_f32 v64, v16, v17
  v_cvt_pk_bf16_f32 v65, v18, v19
  v_cvt_pk_bf16_f32 v66, v20, v21
  v_cvt_pk_bf16_f32 v67, v22, v23
  v_cvt_pk_bf16_f32 v68, v24, v25
  v_cvt_pk_bf16_f32 v69, v26, v27
  v_cvt_pk_bf16_f32 v70, v28, v29
  v_cvt_pk_bf16_f32 v71, v30, v31
  s_add_u32 s35, s34, 0x1400000
  buffer_store_dwordx4 v[64:67], v82, s[16:19], s35 offen sc1
  buffer_store_dwordx4 v[68:71], v82, s[16:19], s35 offen offset:1024 sc1
  v_mov_b32 v8, v4
  v_mov_b32 v9, v5
  v_mov_b32 v13, v7
  s_nop 0
  v_permlane32_swap_b32 v4, v8
  v_permlane32_swap_b32 v5, v9
  v_permlane32_swap_b32 v7, v13
  v_add_f32 v4, v4, v8
  v_add_f32 v5, v5, v9
  v_add_f32 v7, v7, v13
  v_cmp_eq_u32 s[26:27], 0, v6
  v_lshl_add_u32 v8, v6, 13, v12
  s_mov_b32 s37, 0x1606000
  s_add_u32 s38, s37, 16384
  v_cndmask_b32 v4, v5, v4, s[26:27]
  buffer_atomic_add_f32 v4, v8, s[16:19], s37 offen
  s_mov_b32 exec_hi, 0
  buffer_atomic_add_f32 v7, v12, s[16:19], s38 offen
wo2_kernel_end:
  s_endpgm
wo2_kernel_codeend:
.globl tail_kernel
.p2align 8
.type tail_kernel,@function
tail_kernel:
  s_cmp_ge_u32 s2, 184
  s_cbranch_scc1 tail_kernel_end
  s_load_dwordx2 s[6:7], s[0:1], 64
  s_load_dwordx2 s[20:21], s[0:1], 80
  v_lshrrev_b32 v2, 6, v0
  v_and_b32 v1, 63, v0
  v_readfirstlane_b32 s22, v2
  s_and_b32 s27, s2, 7
  s_lshr_b32 s28, s2, 3
  s_waitcnt lgkmcnt(0)
  s_mov_b32 s16, s20
  s_and_b32 s17, s21, 0xffff
  s_mov_b32 s18, 0x10000000
  s_mov_b32 s19, 0x20000
  s_cmp_ge_u32 s28, 16
  s_cbranch_scc1 tail_kernel_ffn
  s_mov_b32 s12, s6
  s_and_b32 s13, s7, 0xffff
  s_mov_b32 s14, 0x200000
  s_mov_b32 s15, 0x20000
  s_lshr_b32 s23, s28, 1
  s_lshl3_add_u32 s23, s27, s23
  s_and_b32 s24, s28, 1
  s_lshl_b32 s24, s24, 4
  s_lshl_b32 s25, s22, 1
  s_add_u32 s24, s24, s25
  s_lshl_b32 s25, s23, 5
  s_add_u32 s25, s25, s24
  s_lshl_b32 s25, s25, 10
  s_add_u32 s25, s25, 0x1400000
  v_lshlrev_b32 v3, 4, v1
  v_and_b32 v4, 31, v1
  s_lshl_b32 s26, s23, 5
  v_add_u32 v4, s26, v4
  v_lshlrev_b32 v5, 2, v4
  s_mov_b32 s30, 0x1606000
  s_add_u32 s31, s30, 8192
  buffer_load_dword v8, v5, s[16:19], s30 offen
  buffer_load_dword v9, v5, s[16:19], s31 offen
  buffer_load_dwordx4 v[16:19], v3, s[16:19], s25 offen offset:0
  buffer_load_dwordx4 v[20:23], v3, s[16:19], s25 offen offset:1024
  v_lshlrev_b32 v6, 10, v4
  v_lshrrev_b32 v7, 5, v1
  v_lshl_add_u32 v6, v7, 4, v6
  s_lshl_b32 s26, s24, 5
  s_waitcnt vmcnt(2)
  v_mul_f32 v8, 0x3b000000, v8
  v_mul_f32 v9, 0x3b000000, v9
  v_fma_f32 v9, -v8, v8, v9
  v_add_f32 v9, 0x3727c5ac, v9
  v_rsq_f32 v9, v9
  s_nop 0
  v_mul_f32 v8, v8, v9
  v_add_f32 v9, 1.0, v9
  s_waitcnt vmcnt(1)
  v_lshlrev_b32 v10, 16, v16
  v_and_b32 v11, 0xffff0000, v16
  v_fma_f32 v10, v10, v9, -v8
  v_fma_f32 v11, v11, v9, -v8
  v_cvt_pk_bf16_f32 v16, v10, v11
  v_lshlrev_b32 v10, 16, v17
  v_and_b32 v11, 0xffff0000, v17
  v_fma_f32 v10, v10, v9, -v8
  v_fma_f32 v11, v11, v9, -v8
  v_cvt_pk_bf16_f32 v17, v10, v11
  v_lshlrev_b32 v10, 16, v18
  v_and_b32 v11, 0xffff0000, v18
  v_fma_f32 v10, v10, v9, -v8
  v_fma_f32 v11, v11, v9, -v8
  v_cvt_pk_bf16_f32 v18, v10, v11
  v_lshlrev_b32 v10, 16, v19
  v_and_b32 v11, 0xffff0000, v19
  v_fma_f32 v10, v10, v9, -v8
  v_fma_f32 v11, v11, v9, -v8
  v_cvt_pk_bf16_f32 v19, v10, v11
  buffer_store_dwordx4 v[16:19], v6, s[12:15], s26 offen offset:0 sc1
  s_waitcnt vmcnt(1)
  v_lshlrev_b32 v10, 16, v20
  v_and_b32 v11, 0xffff0000, v20
  v_fma_f32 v10, v10, v9, -v8
  v_fma_f32 v11, v11, v9, -v8
  v_cvt_pk_bf16_f32 v20, v10, v11
  v_lshlrev_b32 v10, 16, v21
  v_and_b32 v11, 0xffff0000, v21
  v_fma_f32 v10, v10, v9, -v8
  v_fma_f32 v11, v11, v9, -v8
  v_cvt_pk_bf16_f32 v21, v10, v11
  v_lshlrev_b32 v10, 16, v22
  v_and_b32 v11, 0xffff0000, v22
  v_fma_f32 v10, v10, v9, -v8
  v_fma_f32 v11, v11, v9, -v8
  v_cvt_pk_bf16_f32 v22, v10, v11
  v_lshlrev_b32 v10, 16, v23
  v_and_b32 v11, 0xffff0000, v23
  v_fma_f32 v10, v10, v9, -v8
  v_fma_f32 v11, v11, v9, -v8
  v_cvt_pk_bf16_f32 v23, v10, v11
  buffer_store_dwordx4 v[20:23], v6, s[12:15], s26 offen offset:32 sc1
  s_branch tail_kernel_done
tail_kernel_ffn:
  s_sub_u32 s24, s28, 16
  s_mul_i32 s25, s27, 7
  s_add_u32 s24, s24, s25
  v_lshlrev_b32 v3, 4, v1
  s_cmp_ge_u32 s22, 4
  s_cbranch_scc1 tail_kernel_ffn_dma
  s_lshl_b32 s30, s22, 11
  v_add_u32 v2, s30, v3
  s_mov_b32 s30, 0x1606000
  s_add_u32 s31, s30, 8192
  s_add_u32 s40, s30, 16384
  s_add_u32 s46, s20, 0x161a200
  s_addc_u32 s47, s21, 0
  s_load_dword s44, s[46:47], 0
  buffer_load_dwordx4 v[16:19], v2, s[16:19], s30 offen offset:0
  buffer_load_dwordx4 v[20:23], v2, s[16:19], s30 offen offset:1024
  buffer_load_dwordx4 v[24:27], v2, s[16:19], s31 offen offset:0
  buffer_load_dwordx4 v[28:31], v2, s[16:19], s31 offen offset:1024
  buffer_load_dwordx4 v[32:35], v2, s[16:19], s40 offen offset:0
  buffer_load_dwordx4 v[36:39], v2, s[16:19], s40 offen offset:1024
  s_barrier
  v_lshrrev_b32 v40, 2, v2
  v_mov_b32 v41, 0xfffff800
  v_mov_b32 v42, 0x44000000
  v_mov_b32 v43, 0x4027c5ac
  s_waitcnt vmcnt(0) lgkmcnt(0)
  v_mov_b32 v44, 0xbb000000
  v_mul_f32 v44, s44, v44
  v_fma_f32 v24, v24, v42, v43
  v_fma_f32 v25, v25, v42, v43
  v_fma_f32 v26, v26, v42, v43
  v_fma_f32 v27, v27, v42, v43
  v_fma_f32 v28, v28, v42, v43
  v_fma_f32 v29, v29, v42, v43
  v_fma_f32 v30, v30, v42, v43
  v_fma_f32 v31, v31, v42, v43
  v_fma_f32 v32, v16, v44, v32
  v_fma_f32 v33, v17, v44, v33
  v_fma_f32 v34, v18, v44, v34
  v_fma_f32 v35, v19, v44, v35
  v_fma_f32 v36, v20, v44, v36
  v_fma_f32 v37, v21, v44, v37
  v_fma_f32 v38, v22, v44, v38
  v_fma_f32 v39, v23, v44, v39
  v_fma_f32 v24, -v16, v16, v24
  v_fma_f32 v25, -v17, v17, v25
  v_fma_f32 v26, -v18, v18, v26
  v_fma_f32 v27, -v19, v19, v27
  v_fma_f32 v28, -v20, v20, v28
  v_fma_f32 v29, -v21, v21, v29
  v_fma_f32 v30, -v22, v22, v30
  v_fma_f32 v31, -v23, v23, v31
  v_rsq_f32 v24, v24
  v_rsq_f32 v25, v25
  v_rsq_f32 v26, v26
  v_rsq_f32 v27, v27
  v_rsq_f32 v28, v28
  v_rsq_f32 v29, v29
  v_rsq_f32 v30, v30
  v_rsq_f32 v31, v31
  v_add_u32 v16, 0, v40
  v_add_u32 v17, 1, v40
  v_add_u32 v18, 2, v40
  v_add_u32 v19, 3, v40
  v_add_u32 v20, 256, v40
  v_add_u32 v21, 257, v40
  v_add_u32 v22, 258, v40
  v_add_u32 v23, 259, v40
  v_mul_f32 v32, v32, v24
  v_mul_f32 v33, v33, v25
  v_mul_f32 v34, v34, v26
  v_mul_f32 v35, v35, v27
  v_mul_f32 v36, v36, v28
  v_mul_f32 v37, v37, v29
  v_mul_f32 v38, v38, v30
  v_mul_f32 v39, v39, v31
  v_and_or_b32 v32, v32, v41, v16
  v_and_or_b32 v33, v33, v41, v17
  v_and_or_b32 v34, v34, v41, v18
  v_and_or_b32 v35, v35, v41, v19
  v_and_or_b32 v36, v36, v41, v20
  v_and_or_b32 v37, v37, v41, v21
  v_and_or_b32 v38, v38, v41, v22
  v_and_or_b32 v39, v39, v41, v23
  v_max3_f32 v45, v32, v33, v34
  v_max3_f32 v46, v35, v36, v37
  v_max3_f32 v45, v45, v38, v39
  v_max_f32 v45, v45, v46
  s_nop 1
  v_max_f32_dpp v45, v45, v45 quad_perm:[1,0,3,2] row_mask:0xf bank_mask:0xf
  s_nop 1
  v_max_f32_dpp v45, v45, v45 quad_perm:[2,3,0,1] row_mask:0xf bank_mask:0xf
  s_nop 1
  v_max_f32_dpp v45, v45, v45 row_half_mirror row_mask:0xf bank_mask:0xf
  s_nop 1
  v_max_f32_dpp v45, v45, v45 row_mirror row_mask:0xf bank_mask:0xf
  v_mov_b32 v46, v45
  s_nop 1
  v_permlane16_swap_b32 v45, v46
  v_max_f32 v45, v45, v46
  v_mov_b32 v46, v45
  s_nop 1
  v_permlane32_swap_b32 v45, v46
  v_max_f32 v45, v45, v46
  s_lshl_b32 s41, s22, 2
  v_mov_b32 v46, s41
  ds_write_b32 v46, v45 offset:4096
  s_waitcnt lgkmcnt(0)
  s_barrier
  v_mov_b32 v46, 0
  ds_read_b128 v[48:51], v46 offset:4096
  s_waitcnt lgkmcnt(0)
  v_max3_f32 v48, v48, v49, v50
  v_max_f32 v48, v48, v51
  v_and_b32 v48, 0x7ff, v48
  s_nop 0
  v_readfirstlane_b32 s45, v48
  s_nop 0
  s_lshr_b32 s41, s45, 5
  s_lshl_b32 s41, s41, 15
  s_and_b32 s42, s45, 31
  s_lshl_b32 s42, s42, 4
  s_add_u32 s41, s41, s42
  s_add_u32 s41, s41, 0x1400000
  v_lshlrev_b32 v5, 9, v1
  buffer_load_dwordx4 v[8:11], v5, s[16:19], s41 offen
  s_lshl_b32 s42, s45, 2
  s_add_u32 s42, s42, 0x1606000
  s_add_u32 s46, s20, s42
  s_addc_u32 s47, s21, 0
  s_load_dword s40, s[46:47], 0
  s_load_dword s41, s[46:47], 8192
  s_load_dword s42, s[46:47], 16384
  s_barrier
  v_lshrrev_b32 v4, 4, v1
  v_bfe_u32 v5, v1, 2, 2
  v_lshl_add_u32 v6, v4, 3, v5
  v_lshlrev_b32 v7, 6, v6
  v_and_b32 v12, 1, v1
  v_lshl_add_u32 v7, v12, 3, v7
  s_lshl_b32 s43, s22, 4
  v_add_u32 v7, s43, v7
  v_bfe_u32 v12, v1, 1, 1
  v_mul_u32_u24 v12, 32800, v12
  v_add_u32 v7, v7, v12
  v_add_u32 v7, 4352, v7
  v_mul_u32_u24 v6, 1088, v6
  v_and_b32 v12, 3, v1
  v_lshl_add_u32 v6, v12, 3, v6
  s_lshl_b32 s43, s22, 8
  v_add_u32 v6, s43, v6
  v_add_u32 v6, 69952, v6
  ds_read_b64_tr_b16 v[64:65], v7 offset:0
  ds_read_b64_tr_b16 v[66:67], v7 offset:256
  ds_read_b64_tr_b16 v[68:69], v7 offset:2048
  ds_read_b64_tr_b16 v[70:71], v7 offset:2304
  ds_read_b64_tr_b16 v[72:73], v7 offset:4096
  ds_read_b64_tr_b16 v[74:75], v7 offset:4352
  ds_read_b64_tr_b16 v[76:77], v7 offset:6144
  ds_read_b64_tr_b16 v[78:79], v7 offset:6400
  ds_read_b64_tr_b16 v[80:81], v7 offset:8192
  ds_read_b64_tr_b16 v[82:83], v7 offset:8448
  ds_read_b64_tr_b16 v[84:85], v7 offset:10240
  ds_read_b64_tr_b16 v[86:87], v7 offset:10496
  ds_read_b64_tr_b16 v[88:89], v7 offset:12288
  ds_read_b64_tr_b16 v[90:91], v7 offset:12544
  ds_read_b64_tr_b16 v[92:93], v7 offset:14336
  ds_read_b64_tr_b16 v[94:95], v7 offset:14592
  ds_read_b64_tr_b16 v[96:97], v7 offset:16384
  ds_read_b64_tr_b16 v[98:99], v7 offset:16640
  ds_read_b64_tr_b16 v[100:101], v7 offset:18432
  ds_read_b64_tr_b16 v[102:103], v7 offset:18688
  ds_read_b64_tr_b16 v[104:105], v7 offset:20480
  ds_read_b64_tr_b16 v[106:107], v7 offset:20736
  ds_read_b64_tr_b16 v[108:109], v7 offset:22528
  ds_read_b64_tr_b16 v[110:111], v7 offset:22784
  ds_read_b64_tr_b16 v[112:113], v7 offset:24576
  ds_read_b64_tr_b16 v[114:115], v7 offset:24832
  ds_read_b64_tr_b16 v[116:117], v7 offset:26624
  ds_read_b64_tr_b16 v[118:119], v7 offset:26880
  ds_read_b64_tr_b16 v[120:121], v7 offset:28672
  ds_read_b64_tr_b16 v[122:123], v7 offset:28928
  ds_read_b64_tr_b16 v[124:125], v7 offset:30720
  ds_read_b64_tr_b16 v[126:127], v7 offset:30976
  ds_read_b64_tr_b16 v[128:129], v6 offset:0
  ds_read_b64_tr_b16 v[130:131], v6 offset:4352
  ds_read_b64_tr_b16 v[132:133], v6 offset:32
  ds_read_b64_tr_b16 v[134:135], v6 offset:4384
  ds_read_b64_tr_b16 v[136:137], v6 offset:64
  ds_read_b64_tr_b16 v[138:139], v6 offset:4416
  ds_read_b64_tr_b16 v[140:141], v6 offset:96
  ds_read_b64_tr_b16 v[142:143], v6 offset:4448
  ds_read_b64_tr_b16 v[144:145], v6 offset:128
  ds_read_b64_tr_b16 v[146:147], v6 offset:4480
  ds_read_b64_tr_b16 v[148:149], v6 offset:160
  ds_read_b64_tr_b16 v[150:151], v6 offset:4512
  ds_read_b64_tr_b16 v[152:153], v6 offset:192
  ds_read_b64_tr_b16 v[154:155], v6 offset:4544
  ds_read_b64_tr_b16 v[156:157], v6 offset:224
  ds_read_b64_tr_b16 v[158:159], v6 offset:4576
  s_waitcnt lgkmcnt(0)
  v_mov_b32 v16, s40
  v_mov_b32 v17, s41
  v_mul_f32 v16, 0x3b000000, v16
  v_mul_f32 v17, 0x3b000000, v17
  v_fma_f32 v17, -v16, v16, v17
  v_add_f32 v17, 0x3727c5ac, v17
  v_rsq_f32 v17, v17
  s_waitcnt vmcnt(0)
  s_or_b32 s43, s24, s22
  s_cmp_lg_u32 s43, 0
  s_cbranch_scc1 tail_kernel_ffn_noxb
  v_add_f32 v18, 1.0, v17
  v_mul_f32 v19, v16, v17
  v_lshlrev_b32 v28, 16, v8
  v_and_b32 v29, 0xffff0000, v8
  v_fma_f32 v28, v28, v18, -v19
  v_fma_f32 v29, v29, v18, -v19
  v_lshlrev_b32 v30, 16, v9
  v_and_b32 v31, 0xffff0000, v9
  v_fma_f32 v30, v30, v18, -v19
  v_fma_f32 v31, v31, v18, -v19
  v_lshlrev_b32 v32, 16, v10
  v_and_b32 v33, 0xffff0000, v10
  v_fma_f32 v32, v32, v18, -v19
  v_fma_f32 v33, v33, v18, -v19
  v_lshlrev_b32 v34, 16, v11
  v_and_b32 v35, 0xffff0000, v11
  v_fma_f32 v34, v34, v18, -v19
  v_fma_f32 v35, v35, v18, -v19
  v_lshlrev_b32 v5, 5, v1
  s_mov_b32 s43, 0x161d000
  buffer_store_dwordx4 v[28:31], v5, s[16:19], s43 offen sc1
  buffer_store_dwordx4 v[32:35], v5, s[16:19], s43 offen offset:16 sc1
tail_kernel_ffn_noxb:
  v_lshlrev_b32 v18, 16, v8
  v_and_b32 v19, 0xffff0000, v8
  v_sub_f32 v18, v18, v16
  v_sub_f32 v19, v19, v16
  v_mul_f32 v18, v18, v17
  v_mul_f32 v19, v19, v17
  v_cvt_pk_bf16_f32 v8, v18, v19
  v_lshlrev_b32 v18, 16, v9
  v_and_b32 v19, 0xffff0000, v9
  v_sub_f32 v18, v18, v16
  v_sub_f32 v19, v19, v16
  v_mul_f32 v18, v18, v17
  v_mul_f32 v19, v19, v17
  v_cvt_pk_bf16_f32 v9, v18, v19
  v_lshlrev_b32 v18, 16, v10
  v_and_b32 v19, 0xffff0000, v10
  v_sub_f32 v18, v18, v16
  v_sub_f32 v19, v19, v16
  v_mul_f32 v18, v18, v17
  v_mul_f32 v19, v19, v17
  v_cvt_pk_bf16_f32 v10, v18, v19
  v_lshlrev_b32 v18, 16, v11
  v_and_b32 v19, 0xffff0000, v11
  v_sub_f32 v18, v18, v16
  v_sub_f32 v19, v19, v16
  v_mul_f32 v18, v18, v17
  v_mul_f32 v19, v19, v17
  v_cvt_pk_bf16_f32 v11, v18, v19
  s_lshl_b32 s43, s22, 10
  v_add_u32 v5, s43, v3
  ds_write_b128 v5, v[8:11] offset:0
  v_lshl_add_u32 v5, v4, 4, s43
  s_waitcnt lgkmcnt(0)
  ds_read_b128 v[160:163], v5 offset:0
  ds_read_b128 v[164:167], v5 offset:64
  ds_read_b128 v[168:171], v5 offset:128
  ds_read_b128 v[172:175], v5 offset:192
  ds_read_b128 v[176:179], v5 offset:256
  ds_read_b128 v[180:183], v5 offset:320
  ds_read_b128 v[184:187], v5 offset:384
  ds_read_b128 v[188:191], v5 offset:448
  s_waitcnt lgkmcnt(0)
  v_mfma_f32_16x16x32_bf16 v[20:23], v[64:67], v[160:163], 0
  v_mfma_f32_16x16x32_bf16 v[24:27], v[68:71], v[164:167], 0
  v_mfma_f32_16x16x32_bf16 v[20:23], v[72:75], v[168:171], v[20:23]
  v_mfma_f32_16x16x32_bf16 v[24:27], v[76:79], v[172:175], v[24:27]
  v_mfma_f32_16x16x32_bf16 v[20:23], v[80:83], v[176:179], v[20:23]
  v_mfma_f32_16x16x32_bf16 v[24:27], v[84:87], v[180:183], v[24:27]
  v_mfma_f32_16x16x32_bf16 v[20:23], v[88:91], v[184:187], v[20:23]
  v_mfma_f32_16x16x32_bf16 v[24:27], v[92:95], v[188:191], v[24:27]
  ds_read_b128 v[160:163], v5 offset:512
  ds_read_b128 v[164:167], v5 offset:576
  ds_read_b128 v[168:171], v5 offset:640
  ds_read_b128 v[172:175], v5 offset:704
  ds_read_b128 v[176:179], v5 offset:768
  ds_read_b128 v[180:183], v5 offset:832
  ds_read_b128 v[184:187], v5 offset:896
  ds_read_b128 v[188:191], v5 offset:960
  s_waitcnt lgkmcnt(0)
  v_mfma_f32_16x16x32_bf16 v[20:23], v[96:99], v[160:163], v[20:23]
  v_mfma_f32_16x16x32_bf16 v[24:27], v[100:103], v[164:167], v[24:27]
  v_mfma_f32_16x16x32_bf16 v[20:23], v[104:107], v[168:171], v[20:23]
  v_mfma_f32_16x16x32_bf16 v[24:27], v[108:111], v[172:175], v[24:27]
  v_mfma_f32_16x16x32_bf16 v[20:23], v[112:115], v[176:179], v[20:23]
  v_mfma_f32_16x16x32_bf16 v[24:27], v[116:119], v[180:183], v[24:27]
  v_mfma_f32_16x16x32_bf16 v[20:23], v[120:123], v[184:187], v[20:23]
  v_mfma_f32_16x16x32_bf16 v[24:27], v[124:127], v[188:191], v[24:27]
  s_cmp_lg_u32 s24, 0
  s_cbranch_scc1 tail_kernel_ffn_nosel
  s_cmp_lg_u32 s22, 0
  s_cbranch_scc1 tail_kernel_ffn_nosel
  v_mov_b32 v29, s42
  v_mul_f32 v28, s44, v16
  v_sub_f32 v29, v29, v28
  v_mul_f32 v29, v29, v17
  v_mul_f32 v29, 0xbfb8aa3b, v29
  v_exp_f32 v29, v29
  s_nop 0
  v_add_f32 v29, 1.0, v29
  v_rcp_f32 v37, v29
  v_mov_b32 v36, s45
  v_mov_b32 v38, v16
  v_mov_b32 v39, v17
  v_mov_b32 v29, 0
  s_mov_b32 s41, 0x161a100
  s_mov_b64 s[46:47], exec
  s_mov_b64 exec, 1
  buffer_store_dwordx4 v[36:39], v29, s[16:19], s41 offen sc1
  s_mov_b64 exec, s[46:47]
tail_kernel_ffn_nosel:
  s_nop 5
  v_add_f32 v20, v20, v24
  v_add_f32 v21, v21, v25
  v_add_f32 v22, v22, v26
  v_add_f32 v23, v23, v27
  v_mov_b32 v24, v20
  v_mov_b32 v25, v21
  v_mov_b32 v26, v22
  v_mov_b32 v27, v23
  v_permlane32_swap_b32 v20, v24
  v_permlane32_swap_b32 v21, v25
  v_permlane32_swap_b32 v22, v26
  v_permlane32_swap_b32 v23, v27
  v_mul_f32 v28, 0xbfb8aa3b, v20
  v_mul_f32 v29, 0xbfb8aa3b, v21
  v_mul_f32 v30, 0xbfb8aa3b, v22
  v_mul_f32 v31, 0xbfb8aa3b, v23
  v_exp_f32 v28, v28
  v_exp_f32 v29, v29
  v_exp_f32 v30, v30
  v_exp_f32 v31, v31
  v_add_f32 v28, 1.0, v28
  v_add_f32 v29, 1.0, v29
  v_add_f32 v30, 1.0, v30
  v_add_f32 v31, 1.0, v31
  v_rcp_f32 v28, v28
  v_rcp_f32 v29, v29
  v_rcp_f32 v30, v30
  v_rcp_f32 v31, v31
  v_mul_f32 v20, v20, v24
  v_mul_f32 v21, v21, v25
  v_mul_f32 v22, v22, v26
  v_mul_f32 v23, v23, v27
  v_mul_f32 v20, v20, v28
  v_mul_f32 v21, v21, v29
  v_mul_f32 v22, v22, v30
  v_mul_f32 v23, v23, v31
  v_cvt_pk_bf16_f32 v20, v20, v21
  v_cvt_pk_bf16_f32 v21, v22, v23
  s_lshl_b32 s43, s22, 4
  v_lshl_add_u32 v5, v4, 3, s43
  s_mov_b64 s[46:47], exec
  s_mov_b64 exec, 0x10001
  ds_write_b64 v5, v[20:21] offset:4160
  s_mov_b64 exec, s[46:47]
  s_waitcnt lgkmcnt(0)
  s_barrier
  v_lshlrev_b32 v5, 4, v4
  ds_read_b128 v[8:11], v5 offset:4160
  s_waitcnt lgkmcnt(0)
  v_mfma_f32_16x16x32_bf16 v[64:67], v[8:11], v[128:131], 0
  v_mfma_f32_16x16x32_bf16 v[68:71], v[8:11], v[132:135], 0
  v_mfma_f32_16x16x32_bf16 v[72:75], v[8:11], v[136:139], 0
  v_mfma_f32_16x16x32_bf16 v[76:79], v[8:11], v[140:143], 0
  v_mfma_f32_16x16x32_bf16 v[80:83], v[8:11], v[144:147], 0
  v_mfma_f32_16x16x32_bf16 v[84:87], v[8:11], v[148:151], 0
  v_mfma_f32_16x16x32_bf16 v[88:91], v[8:11], v[152:155], 0
  v_mfma_f32_16x16x32_bf16 v[92:95], v[8:11], v[156:159], 0
  v_cmp_eq_u32 s[40:41], 1, v4
  v_cmp_eq_u32 s[42:43], 2, v4
  v_cmp_eq_u32 s[46:47], 3, v4
  s_and_b32 s44, s24, 7
  s_lshl_b32 s44, s44, 11
  s_lshl_b32 s30, s22, 9
  s_add_u32 s44, s44, s30
  s_add_u32 s44, s44, 0x1610000
  v_lshlrev_b32 v5, 2, v1
  v_cndmask_b32 v64, v64, v68, s[40:41]
  v_cndmask_b32 v64, v64, v72, s[42:43]
  v_cndmask_b32 v64, v64, v76, s[46:47]
  buffer_atomic_add_f32 v64, v5, s[16:19], s44 offen offset:0
  v_cndmask_b32 v80, v80, v84, s[40:41]
  v_cndmask_b32 v80, v80, v88, s[42:43]
  v_cndmask_b32 v80, v80, v92, s[46:47]
  buffer_atomic_add_f32 v80, v5, s[16:19], s44 offen offset:256
  s_branch tail_kernel_ffn_end
tail_kernel_ffn_dma:
  s_load_dwordx4 s[4:7], s[0:1], 40
  s_load_dwordx2 s[26:27], s[0:1], 56
  s_sub_u32 s45, s22, 4
  v_lshrrev_b32 v4, 2, v1
  s_lshl_b32 s41, s45, 7
  v_add_u32 v4, s41, v4
  s_movk_i32 s42, 3584
  v_mul_lo_u32 v4, v4, s42
  v_and_b32 v5, 3, v1
  v_lshl_add_u32 v4, v5, 4, v4
  s_lshl_b32 s41, s24, 6
  v_add_u32 v4, s41, v4
  s_lshl_b32 s43, s45, 13
  s_waitcnt lgkmcnt(0)
  s_mov_b32 s8, s4
  s_and_b32 s9, s5, 0xffff
  s_mov_b32 s10, 0x1c0000
  s_mov_b32 s11, 0x20000
  s_mov_b32 s12, s6
  s_and_b32 s13, s7, 0xffff
  s_mov_b32 s14, 0x1c0000
  s_mov_b32 s15, 0x20000
  s_mov_b32 s32, s26
  s_and_b32 s33, s27, 0xffff
  s_mov_b32 s34, 0x1c0000
  s_mov_b32 s35, 0x20000
  s_barrier
  s_add_u32 m0, s43, 4352
  s_mov_b32 s44, 0
  buffer_load_dwordx4 v4, s[8:11], s44 offen lds
  s_add_u32 m0, s43, 37152
  s_mov_b32 s44, 0
  buffer_load_dwordx4 v4, s[12:15], s44 offen lds
  s_add_u32 m0, s43, 5376
  s_mov_b32 s44, 57344
  buffer_load_dwordx4 v4, s[8:11], s44 offen lds
  s_add_u32 m0, s43, 38176
  s_mov_b32 s44, 57344
  buffer_load_dwordx4 v4, s[12:15], s44 offen lds
  s_add_u32 m0, s43, 6400
  s_mov_b32 s44, 114688
  buffer_load_dwordx4 v4, s[8:11], s44 offen lds
  s_add_u32 m0, s43, 39200
  s_mov_b32 s44, 114688
  buffer_load_dwordx4 v4, s[12:15], s44 offen lds
  s_add_u32 m0, s43, 7424
  s_mov_b32 s44, 172032
  buffer_load_dwordx4 v4, s[8:11], s44 offen lds
  s_add_u32 m0, s43, 40224
  s_mov_b32 s44, 172032
  buffer_load_dwordx4 v4, s[12:15], s44 offen lds
  s_add_u32 m0, s43, 8448
  s_mov_b32 s44, 229376
  buffer_load_dwordx4 v4, s[8:11], s44 offen lds
  s_add_u32 m0, s43, 41248
  s_mov_b32 s44, 229376
  buffer_load_dwordx4 v4, s[12:15], s44 offen lds
  s_add_u32 m0, s43, 9472
  s_mov_b32 s44, 286720
  buffer_load_dwordx4 v4, s[8:11], s44 offen lds
  s_add_u32 m0, s43, 42272
  s_mov_b32 s44, 286720
  buffer_load_dwordx4 v4, s[12:15], s44 offen lds
  s_add_u32 m0, s43, 10496
  s_mov_b32 s44, 344064
  buffer_load_dwordx4 v4, s[8:11], s44 offen lds
  s_add_u32 m0, s43, 43296
  s_mov_b32 s44, 344064
  buffer_load_dwordx4 v4, s[12:15], s44 offen lds
  s_add_u32 m0, s43, 11520
  s_mov_b32 s44, 401408
  buffer_load_dwordx4 v4, s[8:11], s44 offen lds
  s_add_u32 m0, s43, 44320
  s_mov_b32 s44, 401408
  buffer_load_dwordx4 v4, s[12:15], s44 offen lds
  s_lshl_b32 s41, s24, 5
  s_lshl_b32 s42, s45, 3
  s_add_u32 s41, s41, s42
  s_lshl_b32 s41, s41, 10
  s_mul_i32 s43, s42, 1088
  s_add_u32 s43, s43, 69952
  s_mov_b32 m0, s43
  s_add_u32 s43, s43, 1088
  buffer_load_dwordx4 v3, s[32:35], s41 offen lds
  s_add_u32 s41, s41, 1024
  s_mov_b32 m0, s43
  s_add_u32 s43, s43, 1088
  buffer_load_dwordx4 v3, s[32:35], s41 offen lds
  s_add_u32 s41, s41, 1024
  s_mov_b32 m0, s43
  s_add_u32 s43, s43, 1088
  buffer_load_dwordx4 v3, s[32:35], s41 offen lds
  s_add_u32 s41, s41, 1024
  s_mov_b32 m0, s43
  s_add_u32 s43, s43, 1088
  buffer_load_dwordx4 v3, s[32:35], s41 offen lds
  s_add_u32 s41, s41, 1024
  s_mov_b32 m0, s43
  s_add_u32 s43, s43, 1088
  buffer_load_dwordx4 v3, s[32:35], s41 offen lds
  s_add_u32 s41, s41, 1024
  s_mov_b32 m0, s43
  s_add_u32 s43, s43, 1088
  buffer_load_dwordx4 v3, s[32:35], s41 offen lds
  s_add_u32 s41, s41, 1024
  s_mov_b32 m0, s43
  s_add_u32 s43, s43, 1088
  buffer_load_dwordx4 v3, s[32:35], s41 offen lds
  s_add_u32 s41, s41, 1024
  s_mov_b32 m0, s43
  s_add_u32 s43, s43, 1088
  buffer_load_dwordx4 v3, s[32:35], s41 offen lds
  s_add_u32 s41, s41, 1024
  s_barrier
  s_waitcnt vmcnt(0)
  s_barrier
  s_endpgm
tail_kernel_ffn_end:
tail_kernel_done:
tail_kernel_end:
  s_endpgm
tail_kernel_codeend:
.globl fin_kernel
.p2align 8
.type fin_kernel,@function
fin_kernel:
  s_cmp_ge_u32 s2, 8
  s_cbranch_scc1 fin_kernel_end
  s_load_dwordx2 s[6:7], s[0:1], 64
  s_load_dwordx2 s[20:21], s[0:1], 80
  v_lshrrev_b32 v2, 6, v0
  v_and_b32 v1, 63, v0
  v_readfirstlane_b32 s22, v2
  s_waitcnt lgkmcnt(0)
  s_mov_b32 s16, s20
  s_and_b32 s17, s21, 0xffff
  s_mov_b32 s18, 0x10000000
  s_mov_b32 s19, 0x20000
  s_mov_b32 s12, s6
  s_and_b32 s13, s7, 0xffff
  s_mov_b32 s14, 0x200000
  s_mov_b32 s15, 0x20000
  s_cmp_lg_u32 s22, 0
  s_cbranch_scc1 fin_kernel_done
  s_add_u32 s4, s20, 0x161a100
  s_addc_u32 s5, s21, 0
  s_load_dwordx4 s[28:31], s[4:5], 0
  v_lshlrev_b32 v5, 2, v1
  s_lshl_b32 s25, s2, 8
  s_add_u32 s25, s25, 0x1610000
  s_add_u32 s26, s25, 0
  buffer_load_dword v8, v5, s[16:19], s26 offen
  s_add_u32 s26, s25, 2048
  buffer_load_dword v9, v5, s[16:19], s26 offen
  s_add_u32 s26, s25, 4096
  buffer_load_dword v10, v5, s[16:19], s26 offen
  s_add_u32 s26, s25, 6144
  buffer_load_dword v11, v5, s[16:19], s26 offen
  s_add_u32 s26, s25, 8192
  buffer_load_dword v12, v5, s[16:19], s26 offen
  s_add_u32 s26, s25, 10240
  buffer_load_dword v13, v5, s[16:19], s26 offen
  s_add_u32 s26, s25, 12288
  buffer_load_dword v14, v5, s[16:19], s26 offen
  s_add_u32 s26, s25, 14336
  buffer_load_dword v15, v5, s[16:19], s26 offen
  s_lshl_b32 s25, s2, 6
  v_add_u32 v6, s25, v1
  s_lshl_b32 s25, s2, 8
  s_add_u32 s25, s25, 0x161d000
  buffer_load_dword v24, v5, s[16:19], s25 offen
  s_waitcnt vmcnt(0) lgkmcnt(0)
  v_add_f32 v8, v8, v9
  v_add_f32 v8, v8, v10
  v_add_f32 v8, v8, v11
  v_add_f32 v8, v8, v12
  v_add_f32 v8, v8, v13
  v_add_f32 v8, v8, v14
  v_add_f32 v8, v8, v15
  s_nop 0
  v_fma_f32 v25, v8, s29, v24
  v_cvt_pk_bf16_f32 v25, v25, v25
  s_lshl_b32 s25, s28, 10
  v_lshlrev_b32 v6, 1, v6
  buffer_store_short v25, v6, s[12:15], s25 offen sc1
fin_kernel_done:
fin_kernel_end:
  s_endpgm
fin_kernel_codeend:
all_code_end:
  s_endpgm
.section .rodata,"a"
.p2align 6
.amdhsa_kernel qkv1_kernel
  .amdhsa_next_free_vgpr 152
  .amdhsa_next_free_sgpr 96
  .amdhsa_accum_offset 152
  .amdhsa_group_segment_fixed_size 0
  .amdhsa_kernarg_size 88
  .amdhsa_user_sgpr_count 2
  .amdhsa_user_sgpr_kernarg_segment_ptr 1
  .amdhsa_system_sgpr_workgroup_id_x 1
  .amdhsa_float_denorm_mode_32 3
.end_amdhsa_kernel
.p2align 6
.amdhsa_kernel attn1_kernel
  .amdhsa_next_free_vgpr 128
  .amdhsa_next_free_sgpr 84
  .amdhsa_accum_offset 128
  .amdhsa_group_segment_fixed_size 0
  .amdhsa_kernarg_size 88
  .amdhsa_user_sgpr_count 2
  .amdhsa_user_sgpr_kernarg_segment_ptr 1
  .amdhsa_system_sgpr_workgroup_id_x 1
  .amdhsa_float_denorm_mode_32 3
.end_amdhsa_kernel
.p2align 6
.amdhsa_kernel wo1_kernel
  .amdhsa_next_free_vgpr 96
  .amdhsa_next_free_sgpr 80
  .amdhsa_accum_offset 96
  .amdhsa_group_segment_fixed_size 0
  .amdhsa_kernarg_size 88
  .amdhsa_user_sgpr_count 2
  .amdhsa_user_sgpr_kernarg_segment_ptr 1
  .amdhsa_system_sgpr_workgroup_id_x 1
  .amdhsa_float_denorm_mode_32 3
.end_amdhsa_kernel
.p2align 6
.amdhsa_kernel qkv2_kernel
  .amdhsa_next_free_vgpr 192
  .amdhsa_next_free_sgpr 72
  .amdhsa_accum_offset 192
  .amdhsa_group_segment_fixed_size 0
  .amdhsa_kernarg_size 88
  .amdhsa_user_sgpr_count 2
  .amdhsa_user_sgpr_kernarg_segment_ptr 1
  .amdhsa_system_sgpr_workgroup_id_x 1
  .amdhsa_float_denorm_mode_32 3
.end_amdhsa_kernel
.p2align 6
.amdhsa_kernel attn2_kernel
  .amdhsa_next_free_vgpr 128
  .amdhsa_next_free_sgpr 84
  .amdhsa_accum_offset 128
  .amdhsa_group_segment_fixed_size 0
  .amdhsa_kernarg_size 88
  .amdhsa_user_sgpr_count 2
  .amdhsa_user_sgpr_kernarg_segment_ptr 1
  .amdhsa_system_sgpr_workgroup_id_x 1
  .amdhsa_float_denorm_mode_32 3
.end_amdhsa_kernel
.p2align 6
.amdhsa_kernel wo2_kernel
  .amdhsa_next_free_vgpr 96
  .amdhsa_next_free_sgpr 80
  .amdhsa_accum_offset 96
  .amdhsa_group_segment_fixed_size 0
  .amdhsa_kernarg_size 88
  .amdhsa_user_sgpr_count 2
  .amdhsa_user_sgpr_kernarg_segment_ptr 1
  .amdhsa_system_sgpr_workgroup_id_x 1
  .amdhsa_float_denorm_mode_32 3
.end_amdhsa_kernel
.p2align 6
.amdhsa_kernel tail_kernel
  .amdhsa_next_free_vgpr 192
  .amdhsa_next_free_sgpr 72
  .amdhsa_accum_offset 192
  .amdhsa_group_segment_fixed_size 0
  .amdhsa_kernarg_size 88
  .amdhsa_user_sgpr_count 2
  .amdhsa_user_sgpr_kernarg_segment_ptr 1
  .amdhsa_system_sgpr_workgroup_id_x 1
  .amdhsa_float_denorm_mode_32 3
.end_amdhsa_kernel
.p2align 6
.amdhsa_kernel fin_kernel
  .amdhsa_next_free_vgpr 32
  .amdhsa_next_free_sgpr 72
  .amdhsa_accum_offset 32
  .amdhsa_group_segment_fixed_size 0
  .amdhsa_kernarg_size 88
  .amdhsa_user_sgpr_count 2
  .amdhsa_user_sgpr_kernarg_segment_ptr 1
  .amdhsa_system_sgpr_workgroup_id_x 1
  .amdhsa_float_denorm_mode_32 3
.end_amdhsa_kernel
```
